```python
import torch

def _softmax(x, axis=-1):
    return torch.softmax(x, dim=axis)
def _gelu(x):
    return torch.nn.functional.gelu(x, approximate="tanh")
def _silu(x):
    return torch.nn.functional.silu(x)
def _sigmoid(x):
    return torch.sigmoid(x)
def _layernorm(x, axis=-1, eps=1e-5):
    m = x.mean(dim=axis, keepdim=True)
    v = x.var(dim=axis, keepdim=True, unbiased=False)
    return (x - m) / torch.sqrt(v + eps)
def _scatter_add(tgt, idx, src, axis=0):
    return tgt.clone().index_add_(axis, idx, src)
def _segment_sum(src, seg, n):
    out = torch.zeros((n,) + src.shape[1:], dtype=src.dtype)
    return out.index_add_(0, seg, src)
def _pad(x, pw):
    flat = tuple(v for pair in reversed(pw) for v in pair)
    return torch.nn.functional.pad(x, flat)

kernel_name = 'interleave_layers__mha_block__dense_activation_silu__prompt'

def setup_inputs():

    _w = (lambda a: (lambda t: t.to(torch.bfloat16) if t.is_floating_point() else t)(torch.as_tensor(a)))
    def _A_setup():
        B, S, D, H = 1, 2048, 640, 32
        return {
            "x": _w((lambda *s: torch.randn(*s, dtype=torch.bfloat16) * 0.05)(B, S, D)),
            "wqkv": _w((lambda *s: torch.randn(*s, dtype=torch.bfloat16) * 0.05)(D, 3 * D)),
            "wo": _w((lambda *s: torch.randn(*s, dtype=torch.bfloat16) * 0.05)(D, D)),
        }
    _A_in = _A_setup()

    def _B_setup():
        B, S, D, F = 1, 2048, 640, 1728
        return {
            "x": _w((lambda *s: torch.randn(*s, dtype=torch.bfloat16) * 0.05)(B, S, D)),
            "w1": _w((lambda *s: torch.randn(*s, dtype=torch.bfloat16) * 0.8)(D, F) * (D ** -0.5)),
            "w2": _w((lambda *s: torch.randn(*s, dtype=torch.bfloat16) * 0.8)(F, D) * (F ** -0.5)),
        }
    _B_in = _B_setup()

    return {
        "A_x": _A_in["x"],
        "A_wqkv": _A_in["wqkv"],
        "A_wo": _A_in["wo"],
        "B_x": _B_in["x"],
        "B_w1": _B_in["w1"],
        "B_w2": _B_in["w2"],
    }

def reference(A_x, A_wqkv, A_wo, B_x, B_w1, B_w2):
    def _A_ref(x, wqkv, wo):
        B, S, D = x.shape
        H = 32
        Dh = D // H
        qkv = (lambda x, *d: x.permute(*d))((x @ wqkv).reshape(B, S, 3, H, Dh), 2, 0, 3, 1, 4)
        q, k, v = qkv[0], qkv[1], qkv[2]
        scores = torch.einsum("bhqd,bhkd->bhqk", q, k) * (Dh ** -0.5)
        p = _softmax(scores, axis=-1)
        o = torch.einsum("bhqk,bhkd->bhqd", p, v)
        return (lambda x, *d: x.permute(*d))(o, 0, 2, 1, 3).reshape(B, S, D) @ wo

    def _B_ref(x, w1, w2):
        h = torch.einsum("bsd,df->bsf", x, w1)
        h = _silu(h)
        out = torch.einsum("bsf,fd->bsd", h, w2)
        return out

    x = A_x
    x = x + _A_ref(_layernorm(x, axis=-1), A_wqkv, A_wo)
    x = x + _B_ref(_layernorm(x, axis=-1), B_w1, B_w2)
    x = x + _A_ref(_layernorm(x, axis=-1), A_wqkv, A_wo)
    x = x + _B_ref(_layernorm(x, axis=-1), B_w1, B_w2)
    return x
```

```asm
; @launch grid=(256,1,1) block=(256,1,1) lds=148992
.amdgcn_target "amdgcn-amd-amdhsa--gfx950"
.text
.globl interleave_layers__mha_block__dense_activation_silu__prompt_kernel
.p2align 8
.type interleave_layers__mha_block__dense_activation_silu__prompt_kernel,@function
interleave_layers__mha_block__dense_activation_silu__prompt_kernel:
    s_cmp_ge_u32 s2, 256
    s_cbranch_scc1 interleave_layers__mha_block__dense_activation_silu__prompt_kernel_end
    s_getpc_b64 s[20:21]
    s_and_b32 s20, s20, 0xffffff00
    s_and_b32 s21, s21, 0xffff
    s_mov_b32 s22, 43008
    s_mov_b32 s23, 0x20000
    s_lshr_b32 s24, s2, 3
    s_lshl_b32 s24, s24, 12
    v_lshlrev_b32 v2, 4, v0
    buffer_load_dwordx4 v[244:247], v2, s[20:23], s24 offen
    s_load_dwordx2 s[4:5], s[0:1], 0
    s_load_dwordx2 s[6:7], s[0:1], 64
    s_load_dwordx4 s[8:11], s[0:1], 48
    s_load_dwordx4 s[60:63], s[0:1], 8
    s_load_dwordx4 s[64:67], s[0:1], 32
    v_lshrrev_b32 v1, 6, v0
    s_and_b32 s12, s2, 7
    v_readfirstlane_b32 s16, v1
    s_lshr_b32 s13, s2, 3
    s_mov_b32 s14, 0
    s_mov_b32 s15, 0
    s_mov_b32 s97, 0
    s_mov_b32 s96, 0
    s_waitcnt lgkmcnt(0)
    s_add_u32 s98, s6, 10457088
    s_addc_u32 s99, s7, 0
    s_cmp_lt_u32 s2, 120
    s_cbranch_scc1 interleave_layers__mha_block__dense_activation_silu__prompt_kernel_p0_l1a
    s_cmp_lt_u32 s2, 248
    s_cbranch_scc1 interleave_layers__mha_block__dense_activation_silu__prompt_kernel_p0_l1c
    s_cmp_lg_u32 s2, 255
    s_cbranch_scc1 interleave_layers__mha_block__dense_activation_silu__prompt_kernel_p0_l2
    s_add_u32 s20, s6, 10457088
    s_addc_u32 s21, s7, 0
    s_and_b32 s21, s21, 0xffff
    s_mov_b32 s22, 32768
    s_mov_b32 s23, 0x20000
    v_mov_b32 v20, 0
    v_mov_b32 v21, 0
    v_mov_b32 v22, 0
    v_mov_b32 v23, 0
    v_lshlrev_b32 v5, 4, v0
    s_movk_i32 s36, 0
    buffer_store_dwordx4 v[20:23], v5, s[20:23], s36 offen sc1
    s_movk_i32 s36, 4096
    buffer_store_dwordx4 v[20:23], v5, s[20:23], s36 offen sc1
    s_movk_i32 s36, 8192
    buffer_store_dwordx4 v[20:23], v5, s[20:23], s36 offen sc1
    s_movk_i32 s36, 12288
    buffer_store_dwordx4 v[20:23], v5, s[20:23], s36 offen sc1
    s_movk_i32 s36, 16384
    buffer_store_dwordx4 v[20:23], v5, s[20:23], s36 offen sc1
    s_movk_i32 s36, 20480
    buffer_store_dwordx4 v[20:23], v5, s[20:23], s36 offen sc1
    s_movk_i32 s36, 24576
    buffer_store_dwordx4 v[20:23], v5, s[20:23], s36 offen sc1
    s_movk_i32 s36, 28672
    buffer_store_dwordx4 v[20:23], v5, s[20:23], s36 offen sc1
    s_waitcnt vmcnt(0)
    s_barrier
    v_mov_b32 v5, 0
    v_mov_b32 v6, 1
    s_mov_b64 exec, 1
    global_store_dword v5, v6, s[10:11] sc1
    s_mov_b64 exec, -1
    s_branch interleave_layers__mha_block__dense_activation_silu__prompt_kernel_p0_l2
interleave_layers__mha_block__dense_activation_silu__prompt_kernel_p0_l1a:
    s_mov_b32 s17, s2
    s_mov_b32 s20, s60
    s_and_b32 s21, s61, 0xffff
    s_mov_b32 s22, 2457600
    s_mov_b32 s23, 0x20000
    s_lshr_b32 s18, s17, 3
    s_and_b32 s19, s17, 7
    s_lshl_b32 s33, s18, 7
    s_cmp_ge_u32 s18, 5
    s_cselect_b32 s35, 5, 0
    s_sub_u32 s35, s18, s35
    s_cmp_eq_u32 s35, 3
    s_cselect_b32 s36, 8, 0
    s_cmp_eq_u32 s35, 4
    s_cselect_b32 s36, 16, s36
    s_cmp_ge_u32 s18, 10
    s_cselect_b32 s36, 0, s36
    s_sub_u32 s33, s33, s36
    v_lshrrev_b32 v4, 4, v0
    v_and_b32 v3, 15, v0
    v_mul_u32_u24 v9, 1920, v4
    v_lshl_add_u32 v9, v3, 3, v9
    v_add_u32 v9, s33, v9
    v_lshlrev_b32 v9, 1, v9
    s_mul_i32 s34, s19, 307200
    buffer_load_dwordx4 v[20:23], v9, s[20:23], s34 offen
    s_add_u32 s34, s34, 61440
    buffer_load_dwordx4 v[24:27], v9, s[20:23], s34 offen
    s_add_u32 s34, s34, 61440
    buffer_load_dwordx4 v[28:31], v9, s[20:23], s34 offen
    s_add_u32 s34, s34, 61440
    buffer_load_dwordx4 v[32:35], v9, s[20:23], s34 offen
    s_add_u32 s34, s34, 61440
    buffer_load_dwordx4 v[36:39], v9, s[20:23], s34 offen
    v_lshrrev_b32 v4, 1, v0
    v_and_b32 v3, 1, v0
    v_add_u32 v3, 16, v3
    v_mul_u32_u24 v9, 1920, v4
    v_lshl_add_u32 v9, v3, 3, v9
    v_add_u32 v9, s33, v9
    v_lshlrev_b32 v9, 1, v9
    v_mov_b32 v10, 0x7ffffff0
    v_mov_b32 v11, 160
    v_cmp_gt_u32 vcc, v11, v0
    s_mul_i32 s34, s19, 307200
    s_nop 0
    v_cndmask_b32 v9, v10, v9, vcc
    buffer_load_dwordx4 v[40:43], v9, s[20:23], s34 offen
    s_branch interleave_layers__mha_block__dense_activation_silu__prompt_kernel_p0_l2
interleave_layers__mha_block__dense_activation_silu__prompt_kernel_p0_l1c:
    s_sub_u32 s33, s2, 120
    s_lshl_b32 s33, s33, 4
    s_lshl_b32 s34, s16, 2
    s_add_u32 s34, s34, s33
    v_and_b32 v1, 63, v0
    v_lshrrev_b32 v3, 4, v1
    v_add_u32 v3, s34, v3
    v_and_b32 v4, 15, v1
    v_mul_u32_u24 v5, 1280, v3
    v_lshl_add_u32 v5, v4, 4, v5
    s_mov_b32 s20, s4
    s_and_b32 s21, s5, 0xffff
    s_mov_b32 s22, 2621440
    s_mov_b32 s23, 0x20000
    buffer_load_dwordx4 v[20:23], v5, s[20:23], 0 offen offset:0
    buffer_load_dwordx4 v[24:27], v5, s[20:23], 0 offen offset:256
    buffer_load_dwordx4 v[28:31], v5, s[20:23], 0 offen offset:512
    buffer_load_dwordx4 v[32:35], v5, s[20:23], 0 offen offset:768
    buffer_load_dwordx4 v[36:39], v5, s[20:23], 0 offen offset:1024
interleave_layers__mha_block__dense_activation_silu__prompt_kernel_p0_l2:
    s_cmp_lt_u32 s2, 112
    s_cbranch_scc0 interleave_layers__mha_block__dense_activation_silu__prompt_kernel_p0_l2b
    s_mov_b32 s17, s2
    s_mov_b32 s20, s64
    s_and_b32 s21, s65, 0xffff
    s_mov_b32 s22, 2211840
    s_mov_b32 s23, 0x20000
    s_lshr_b32 s18, s17, 3
    s_and_b32 s19, s17, 7
    s_lshl_b32 s33, s18, 7
    v_lshrrev_b32 v4, 4, v0
    v_and_b32 v3, 15, v0
    v_mul_u32_u24 v9, 1728, v4
    v_lshl_add_u32 v9, v3, 3, v9
    v_add_u32 v9, s33, v9
    v_lshlrev_b32 v9, 1, v9
    s_mul_i32 s34, s19, 276480
    buffer_load_dwordx4 v[44:47], v9, s[20:23], s34 offen
    s_add_u32 s34, s34, 55296
    buffer_load_dwordx4 v[48:51], v9, s[20:23], s34 offen
    s_add_u32 s34, s34, 55296
    buffer_load_dwordx4 v[52:55], v9, s[20:23], s34 offen
    s_add_u32 s34, s34, 55296
    buffer_load_dwordx4 v[56:59], v9, s[20:23], s34 offen
    s_add_u32 s34, s34, 55296
    buffer_load_dwordx4 v[60:63], v9, s[20:23], s34 offen
    s_branch interleave_layers__mha_block__dense_activation_silu__prompt_kernel_p0_p1
interleave_layers__mha_block__dense_activation_silu__prompt_kernel_p0_l2b:
    s_cmp_lt_u32 s2, 224
    s_cbranch_scc0 interleave_layers__mha_block__dense_activation_silu__prompt_kernel_p0_l2o
    s_sub_u32 s33, s2, 112
    s_mul_i32 s40, s33, 4682
    s_lshr_b32 s40, s40, 16
    s_mul_i32 s34, s40, 14
    s_sub_u32 s34, s33, s34
    s_lshl_b32 s41, s34, 7
    s_movk_i32 s42, 128
    s_mov_b32 s43, 0
    s_lshl_b32 s48, s34, 2
    s_movk_i32 s49, 54
    s_mov_b32 s44, s66
    s_and_b32 s45, s67, 0xffff
    s_mov_b32 s46, 2211840
    s_mov_b32 s47, 0x20000
    s_branch interleave_layers__mha_block__dense_activation_silu__prompt_kernel_p0_l2g
interleave_layers__mha_block__dense_activation_silu__prompt_kernel_p0_l2o:
    s_sub_u32 s33, s2, 224
    s_lshr_b32 s40, s33, 2
    s_and_b32 s34, s33, 3
    s_mul_i32 s41, s34, 160
    s_movk_i32 s42, 160
    s_mov_b32 s43, 1
    s_mul_i32 s48, s34, 5
    s_movk_i32 s49, 20
    s_mov_b32 s44, s62
    s_and_b32 s45, s63, 0xffff
    s_mov_b32 s46, 819200
    s_mov_b32 s47, 0x20000
interleave_layers__mha_block__dense_activation_silu__prompt_kernel_p0_l2g:
    s_mul_i32 s35, s40, 160
    v_mov_b32 v19, 0x7ffffff0
    v_add_u32 v3, 0, v0
    v_mul_u32_u24 v4, 6554, v3
    v_lshrrev_b32 v4, 16, v4
    v_mul_u32_u24 v5, 10, v4
    v_sub_u32 v5, v3, v5
    v_add_u32 v6, s41, v4
    s_cmp_eq_u32 s43, 0
    s_cbranch_scc1 interleave_layers__mha_block__dense_activation_silu__prompt_kernel_p0_b_row0
    v_lshrrev_b32 v7, 3, v6
    v_and_b32 v8, 7, v6
    v_mul_u32_u24 v9, 205, v7
    v_lshrrev_b32 v9, 10, v9
    v_mul_u32_u24 v10, 5, v9
    v_sub_u32 v10, v7, v10
    v_lshrrev_b32 v11, 1, v10
    v_and_b32 v12, 1, v10
    v_lshl_add_u32 v12, v12, 3, v8
    v_lshrrev_b32 v13, 2, v8
    v_and_b32 v14, 3, v8
    v_add_u32 v14, 16, v14
    v_cmp_eq_u32 vcc, 4, v10
    s_nop 1
    v_cndmask_b32 v11, v11, v13, vcc
    v_cndmask_b32 v12, v12, v14, vcc
    v_lshl_add_u32 v11, v9, 1, v11
    v_mul_u32_u24 v11, 20, v11
    v_add_u32 v6, v11, v12
interleave_layers__mha_block__dense_activation_silu__prompt_kernel_p0_b_row0:
    v_mul_u32_u24 v6, 1280, v6
    v_lshl_add_u32 v6, v5, 4, v6
    v_cmp_gt_u32 vcc, s42, v4
    s_nop 1
    v_cndmask_b32 v6, v19, v6, vcc
    buffer_load_dwordx4 v[44:47], v6, s[44:47], s35 offen
    v_add_u32 v3, 256, v0
    v_mul_u32_u24 v4, 6554, v3
    v_lshrrev_b32 v4, 16, v4
    v_mul_u32_u24 v5, 10, v4
    v_sub_u32 v5, v3, v5
    v_add_u32 v6, s41, v4
    s_cmp_eq_u32 s43, 0
    s_cbranch_scc1 interleave_layers__mha_block__dense_activation_silu__prompt_kernel_p0_b_row1
    v_lshrrev_b32 v7, 3, v6
    v_and_b32 v8, 7, v6
    v_mul_u32_u24 v9, 205, v7
    v_lshrrev_b32 v9, 10, v9
    v_mul_u32_u24 v10, 5, v9
    v_sub_u32 v10, v7, v10
    v_lshrrev_b32 v11, 1, v10
    v_and_b32 v12, 1, v10
    v_lshl_add_u32 v12, v12, 3, v8
    v_lshrrev_b32 v13, 2, v8
    v_and_b32 v14, 3, v8
    v_add_u32 v14, 16, v14
    v_cmp_eq_u32 vcc, 4, v10
    s_nop 1
    v_cndmask_b32 v11, v11, v13, vcc
    v_cndmask_b32 v12, v12, v14, vcc
    v_lshl_add_u32 v11, v9, 1, v11
    v_mul_u32_u24 v11, 20, v11
    v_add_u32 v6, v11, v12
interleave_layers__mha_block__dense_activation_silu__prompt_kernel_p0_b_row1:
    v_mul_u32_u24 v6, 1280, v6
    v_lshl_add_u32 v6, v5, 4, v6
    v_cmp_gt_u32 vcc, s42, v4
    s_nop 1
    v_cndmask_b32 v6, v19, v6, vcc
    buffer_load_dwordx4 v[48:51], v6, s[44:47], s35 offen
    v_add_u32 v3, 512, v0
    v_mul_u32_u24 v4, 6554, v3
    v_lshrrev_b32 v4, 16, v4
    v_mul_u32_u24 v5, 10, v4
    v_sub_u32 v5, v3, v5
    v_add_u32 v6, s41, v4
    s_cmp_eq_u32 s43, 0
    s_cbranch_scc1 interleave_layers__mha_block__dense_activation_silu__prompt_kernel_p0_b_row2
    v_lshrrev_b32 v7, 3, v6
    v_and_b32 v8, 7, v6
    v_mul_u32_u24 v9, 205, v7
    v_lshrrev_b32 v9, 10, v9
    v_mul_u32_u24 v10, 5, v9
    v_sub_u32 v10, v7, v10
    v_lshrrev_b32 v11, 1, v10
    v_and_b32 v12, 1, v10
    v_lshl_add_u32 v12, v12, 3, v8
    v_lshrrev_b32 v13, 2, v8
    v_and_b32 v14, 3, v8
    v_add_u32 v14, 16, v14
    v_cmp_eq_u32 vcc, 4, v10
    s_nop 1
    v_cndmask_b32 v11, v11, v13, vcc
    v_cndmask_b32 v12, v12, v14, vcc
    v_lshl_add_u32 v11, v9, 1, v11
    v_mul_u32_u24 v11, 20, v11
    v_add_u32 v6, v11, v12
interleave_layers__mha_block__dense_activation_silu__prompt_kernel_p0_b_row2:
    v_mul_u32_u24 v6, 1280, v6
    v_lshl_add_u32 v6, v5, 4, v6
    v_cmp_gt_u32 vcc, s42, v4
    s_nop 1
    v_cndmask_b32 v6, v19, v6, vcc
    buffer_load_dwordx4 v[52:55], v6, s[44:47], s35 offen
    v_add_u32 v3, 768, v0
    v_mul_u32_u24 v4, 6554, v3
    v_lshrrev_b32 v4, 16, v4
    v_mul_u32_u24 v5, 10, v4
    v_sub_u32 v5, v3, v5
    v_add_u32 v6, s41, v4
    s_cmp_eq_u32 s43, 0
    s_cbranch_scc1 interleave_layers__mha_block__dense_activation_silu__prompt_kernel_p0_b_row3
    v_lshrrev_b32 v7, 3, v6
    v_and_b32 v8, 7, v6
    v_mul_u32_u24 v9, 205, v7
    v_lshrrev_b32 v9, 10, v9
    v_mul_u32_u24 v10, 5, v9
    v_sub_u32 v10, v7, v10
    v_lshrrev_b32 v11, 1, v10
    v_and_b32 v12, 1, v10
    v_lshl_add_u32 v12, v12, 3, v8
    v_lshrrev_b32 v13, 2, v8
    v_and_b32 v14, 3, v8
    v_add_u32 v14, 16, v14
    v_cmp_eq_u32 vcc, 4, v10
    s_nop 1
    v_cndmask_b32 v11, v11, v13, vcc
    v_cndmask_b32 v12, v12, v14, vcc
    v_lshl_add_u32 v11, v9, 1, v11
    v_mul_u32_u24 v11, 20, v11
    v_add_u32 v6, v11, v12
interleave_layers__mha_block__dense_activation_silu__prompt_kernel_p0_b_row3:
    v_mul_u32_u24 v6, 1280, v6
    v_lshl_add_u32 v6, v5, 4, v6
    v_cmp_gt_u32 vcc, s42, v4
    s_nop 1
    v_cndmask_b32 v6, v19, v6, vcc
    buffer_load_dwordx4 v[56:59], v6, s[44:47], s35 offen
    v_add_u32 v3, 1024, v0
    v_mul_u32_u24 v4, 6554, v3
    v_lshrrev_b32 v4, 16, v4
    v_mul_u32_u24 v5, 10, v4
    v_sub_u32 v5, v3, v5
    v_add_u32 v6, s41, v4
    s_cmp_eq_u32 s43, 0
    s_cbranch_scc1 interleave_layers__mha_block__dense_activation_silu__prompt_kernel_p0_b_row4
    v_lshrrev_b32 v7, 3, v6
    v_and_b32 v8, 7, v6
    v_mul_u32_u24 v9, 205, v7
    v_lshrrev_b32 v9, 10, v9
    v_mul_u32_u24 v10, 5, v9
    v_sub_u32 v10, v7, v10
    v_lshrrev_b32 v11, 1, v10
    v_and_b32 v12, 1, v10
    v_lshl_add_u32 v12, v12, 3, v8
    v_lshrrev_b32 v13, 2, v8
    v_and_b32 v14, 3, v8
    v_add_u32 v14, 16, v14
    v_cmp_eq_u32 vcc, 4, v10
    s_nop 1
    v_cndmask_b32 v11, v11, v13, vcc
    v_cndmask_b32 v12, v12, v14, vcc
    v_lshl_add_u32 v11, v9, 1, v11
    v_mul_u32_u24 v11, 20, v11
    v_add_u32 v6, v11, v12
interleave_layers__mha_block__dense_activation_silu__prompt_kernel_p0_b_row4:
    v_mul_u32_u24 v6, 1280, v6
    v_lshl_add_u32 v6, v5, 4, v6
    v_cmp_gt_u32 vcc, s42, v4
    s_nop 1
    v_cndmask_b32 v6, v19, v6, vcc
    buffer_load_dwordx4 v[60:63], v6, s[44:47], s35 offen
    v_add_u32 v3, 1280, v0
    v_mul_u32_u24 v4, 6554, v3
    v_lshrrev_b32 v4, 16, v4
    v_mul_u32_u24 v5, 10, v4
    v_sub_u32 v5, v3, v5
    v_add_u32 v6, s41, v4
    s_cmp_eq_u32 s43, 0
    s_cbranch_scc1 interleave_layers__mha_block__dense_activation_silu__prompt_kernel_p0_b_row5
    v_lshrrev_b32 v7, 3, v6
    v_and_b32 v8, 7, v6
    v_mul_u32_u24 v9, 205, v7
    v_lshrrev_b32 v9, 10, v9
    v_mul_u32_u24 v10, 5, v9
    v_sub_u32 v10, v7, v10
    v_lshrrev_b32 v11, 1, v10
    v_and_b32 v12, 1, v10
    v_lshl_add_u32 v12, v12, 3, v8
    v_lshrrev_b32 v13, 2, v8
    v_and_b32 v14, 3, v8
    v_add_u32 v14, 16, v14
    v_cmp_eq_u32 vcc, 4, v10
    s_nop 1
    v_cndmask_b32 v11, v11, v13, vcc
    v_cndmask_b32 v12, v12, v14, vcc
    v_lshl_add_u32 v11, v9, 1, v11
    v_mul_u32_u24 v11, 20, v11
    v_add_u32 v6, v11, v12
interleave_layers__mha_block__dense_activation_silu__prompt_kernel_p0_b_row5:
    v_mul_u32_u24 v6, 1280, v6
    v_lshl_add_u32 v6, v5, 4, v6
    v_cmp_gt_u32 vcc, s42, v4
    s_nop 1
    v_cndmask_b32 v6, v19, v6, vcc
    buffer_load_dwordx4 v[64:67], v6, s[44:47], s35 offen
    v_add_u32 v3, 1536, v0
    v_mul_u32_u24 v4, 6554, v3
    v_lshrrev_b32 v4, 16, v4
    v_mul_u32_u24 v5, 10, v4
    v_sub_u32 v5, v3, v5
    v_add_u32 v6, s41, v4
    s_cmp_eq_u32 s43, 0
    s_cbranch_scc1 interleave_layers__mha_block__dense_activation_silu__prompt_kernel_p0_b_row6
    v_lshrrev_b32 v7, 3, v6
    v_and_b32 v8, 7, v6
    v_mul_u32_u24 v9, 205, v7
    v_lshrrev_b32 v9, 10, v9
    v_mul_u32_u24 v10, 5, v9
    v_sub_u32 v10, v7, v10
    v_lshrrev_b32 v11, 1, v10
    v_and_b32 v12, 1, v10
    v_lshl_add_u32 v12, v12, 3, v8
    v_lshrrev_b32 v13, 2, v8
    v_and_b32 v14, 3, v8
    v_add_u32 v14, 16, v14
    v_cmp_eq_u32 vcc, 4, v10
    s_nop 1
    v_cndmask_b32 v11, v11, v13, vcc
    v_cndmask_b32 v12, v12, v14, vcc
    v_lshl_add_u32 v11, v9, 1, v11
    v_mul_u32_u24 v11, 20, v11
    v_add_u32 v6, v11, v12
interleave_layers__mha_block__dense_activation_silu__prompt_kernel_p0_b_row6:
    v_mul_u32_u24 v6, 1280, v6
    v_lshl_add_u32 v6, v5, 4, v6
    v_cmp_gt_u32 vcc, s42, v4
    s_nop 1
    v_cndmask_b32 v6, v19, v6, vcc
    buffer_load_dwordx4 v[68:71], v6, s[44:47], s35 offen
interleave_layers__mha_block__dense_activation_silu__prompt_kernel_p0_p1:
    s_mov_b32 s72, s6
    s_and_b32 s73, s7, 0xffff
    s_mov_b32 s74, 7700480
    s_mov_b32 s75, 0x20000
    v_and_b32 v249, 63, v0
    v_lshlrev_b32 v249, 4, v249
    s_lshr_b32 s20, s12, 2
    s_lshl_b32 s21, s20, 3
    s_lshr_b32 s22, s13, 2
    s_add_u32 s21, s21, s22
    s_lshl_b32 s21, s21, 2
    s_add_u32 s21, s21, s16
    s_mul_i32 s76, s21, 40960
    s_lshl_b32 s21, s20, 2
    s_lshr_b32 s22, s13, 3
    s_add_u32 s21, s21, s22
    s_mul_i32 s79, s16, 5120
    s_mul_i32 s78, s21, 276480
    s_add_u32 s78, s78, s79
    s_add_u32 s78, s78, 5488640
    s_mul_i32 s77, s21, 102400
    s_mul_i32 s22, s16, 25600
    s_add_u32 s77, s77, s22
    s_add_u32 s77, s77, 4669440
    s_waitcnt vmcnt(5)
    s_cmp_lt_u32 s2, 120
    s_cbranch_scc1 interleave_layers__mha_block__dense_activation_silu__prompt_kernel_p0_p1a
    s_cmp_lt_u32 s2, 248
    s_cbranch_scc0 interleave_layers__mha_block__dense_activation_silu__prompt_kernel_p0_arr
    s_sub_u32 s33, s2, 120
    s_lshl_b32 s33, s33, 4
    v_and_b32 v1, 63, v0
    v_and_b32 v4, 15, v1
    v_lshrrev_b32 v3, 4, v0
    v_lshlrev_b32 v5, 8, v4
    v_lshl_add_u32 v5, v3, 4, v5
    v_add_u32 v5, 0, v5
    ds_write_b128 v5, v[20:23] offset:0
    ds_write_b128 v5, v[24:27] offset:4096
    ds_write_b128 v5, v[28:31] offset:8192
    ds_write_b128 v5, v[32:35] offset:12288
    ds_write_b128 v5, v[36:39] offset:16384
    s_add_u32 s24, s6, 7835648
    s_addc_u32 s25, s7, 0
    s_and_b32 s25, s25, 0xffff
    s_mov_b32 s26, 2621440
    s_mov_b32 s27, 0x20000
    s_add_u32 s28, s6, 7819264
    s_addc_u32 s29, s7, 0
    s_and_b32 s29, s29, 0xffff
    s_mov_b32 s30, 16384
    s_mov_b32 s31, 0x20000
    v_mov_b32 v6, 0
    v_mov_b32 v7, 0
    v_lshlrev_b32 v8, 16, v20
    v_and_b32 v9, 0xffff0000, v20
    v_add_f32 v6, v6, v8
    v_fmac_f32 v7, v8, v8
    v_add_f32 v6, v6, v9
    v_fmac_f32 v7, v9, v9
    v_lshlrev_b32 v8, 16, v21
    v_and_b32 v9, 0xffff0000, v21
    v_add_f32 v6, v6, v8
    v_fmac_f32 v7, v8, v8
    v_add_f32 v6, v6, v9
    v_fmac_f32 v7, v9, v9
    v_lshlrev_b32 v8, 16, v22
    v_and_b32 v9, 0xffff0000, v22
    v_add_f32 v6, v6, v8
    v_fmac_f32 v7, v8, v8
    v_add_f32 v6, v6, v9
    v_fmac_f32 v7, v9, v9
    v_lshlrev_b32 v8, 16, v23
    v_and_b32 v9, 0xffff0000, v23
    v_add_f32 v6, v6, v8
    v_fmac_f32 v7, v8, v8
    v_add_f32 v6, v6, v9
    v_fmac_f32 v7, v9, v9
    v_lshlrev_b32 v8, 16, v24
    v_and_b32 v9, 0xffff0000, v24
    v_add_f32 v6, v6, v8
    v_fmac_f32 v7, v8, v8
    v_add_f32 v6, v6, v9
    v_fmac_f32 v7, v9, v9
    v_lshlrev_b32 v8, 16, v25
    v_and_b32 v9, 0xffff0000, v25
    v_add_f32 v6, v6, v8
    v_fmac_f32 v7, v8, v8
    v_add_f32 v6, v6, v9
    v_fmac_f32 v7, v9, v9
    v_lshlrev_b32 v8, 16, v26
    v_and_b32 v9, 0xffff0000, v26
    v_add_f32 v6, v6, v8
    v_fmac_f32 v7, v8, v8
    v_add_f32 v6, v6, v9
    v_fmac_f32 v7, v9, v9
    v_lshlrev_b32 v8, 16, v27
    v_and_b32 v9, 0xffff0000, v27
    v_add_f32 v6, v6, v8
    v_fmac_f32 v7, v8, v8
    v_add_f32 v6, v6, v9
    v_fmac_f32 v7, v9, v9
    v_lshlrev_b32 v8, 16, v28
    v_and_b32 v9, 0xffff0000, v28
    v_add_f32 v6, v6, v8
    v_fmac_f32 v7, v8, v8
    v_add_f32 v6, v6, v9
    v_fmac_f32 v7, v9, v9
    v_lshlrev_b32 v8, 16, v29
    v_and_b32 v9, 0xffff0000, v29
    v_add_f32 v6, v6, v8
    v_fmac_f32 v7, v8, v8
    v_add_f32 v6, v6, v9
    v_fmac_f32 v7, v9, v9
    v_lshlrev_b32 v8, 16, v30
    v_and_b32 v9, 0xffff0000, v30
    v_add_f32 v6, v6, v8
    v_fmac_f32 v7, v8, v8
    v_add_f32 v6, v6, v9
    v_fmac_f32 v7, v9, v9
    v_lshlrev_b32 v8, 16, v31
    v_and_b32 v9, 0xffff0000, v31
    v_add_f32 v6, v6, v8
    v_fmac_f32 v7, v8, v8
    v_add_f32 v6, v6, v9
    v_fmac_f32 v7, v9, v9
    v_lshlrev_b32 v8, 16, v32
    v_and_b32 v9, 0xffff0000, v32
    v_add_f32 v6, v6, v8
    v_fmac_f32 v7, v8, v8
    v_add_f32 v6, v6, v9
    v_fmac_f32 v7, v9, v9
    v_lshlrev_b32 v8, 16, v33
    v_and_b32 v9, 0xffff0000, v33
    v_add_f32 v6, v6, v8
    v_fmac_f32 v7, v8, v8
    v_add_f32 v6, v6, v9
    v_fmac_f32 v7, v9, v9
    v_lshlrev_b32 v8, 16, v34
    v_and_b32 v9, 0xffff0000, v34
    v_add_f32 v6, v6, v8
    v_fmac_f32 v7, v8, v8
    v_add_f32 v6, v6, v9
    v_fmac_f32 v7, v9, v9
    v_lshlrev_b32 v8, 16, v35
    v_and_b32 v9, 0xffff0000, v35
    v_add_f32 v6, v6, v8
    v_fmac_f32 v7, v8, v8
    v_add_f32 v6, v6, v9
    v_fmac_f32 v7, v9, v9
    v_lshlrev_b32 v8, 16, v36
    v_and_b32 v9, 0xffff0000, v36
    v_add_f32 v6, v6, v8
    v_fmac_f32 v7, v8, v8
    v_add_f32 v6, v6, v9
    v_fmac_f32 v7, v9, v9
    v_lshlrev_b32 v8, 16, v37
    v_and_b32 v9, 0xffff0000, v37
    v_add_f32 v6, v6, v8
    v_fmac_f32 v7, v8, v8
    v_add_f32 v6, v6, v9
    v_fmac_f32 v7, v9, v9
    v_lshlrev_b32 v8, 16, v38
    v_and_b32 v9, 0xffff0000, v38
    v_add_f32 v6, v6, v8
    v_fmac_f32 v7, v8, v8
    v_add_f32 v6, v6, v9
    v_fmac_f32 v7, v9, v9
    v_lshlrev_b32 v8, 16, v39
    v_and_b32 v9, 0xffff0000, v39
    v_add_f32 v6, v6, v8
    v_fmac_f32 v7, v8, v8
    v_add_f32 v6, v6, v9
    v_fmac_f32 v7, v9, v9
    s_nop 1
    v_add_f32_dpp v6, v6, v6 row_ror:8 row_mask:0xf bank_mask:0xf
    v_add_f32_dpp v7, v7, v7 row_ror:8 row_mask:0xf bank_mask:0xf
    s_nop 1
    v_add_f32_dpp v6, v6, v6 row_ror:4 row_mask:0xf bank_mask:0xf
    v_add_f32_dpp v7, v7, v7 row_ror:4 row_mask:0xf bank_mask:0xf
    s_nop 1
    v_add_f32_dpp v6, v6, v6 row_ror:2 row_mask:0xf bank_mask:0xf
    v_add_f32_dpp v7, v7, v7 row_ror:2 row_mask:0xf bank_mask:0xf
    s_nop 1
    v_add_f32_dpp v6, v6, v6 row_ror:1 row_mask:0xf bank_mask:0xf
    v_add_f32_dpp v7, v7, v7 row_ror:1 row_mask:0xf bank_mask:0xf
    v_add_u32 v10, s33, v3
    v_lshlrev_b32 v10, 3, v10
    v_mov_b32 v11, 0x7ffffff0
    v_cmp_eq_u32 vcc, 0, v4
    v_lshlrev_b32 v12, 4, v0
    v_add_u32 v12, 0, v12
    v_cndmask_b32 v10, v11, v10, vcc
    buffer_store_dwordx2 v[6:7], v10, s[28:31], 0 offen sc1
    s_waitcnt lgkmcnt(0)
    s_barrier
    ds_read_b128 v[72:75], v12 offset:0
    ds_read_b128 v[76:79], v12 offset:4096
    ds_read_b128 v[80:83], v12 offset:8192
    ds_read_b128 v[84:87], v12 offset:12288
    ds_read_b128 v[88:91], v12 offset:16384
    v_lshrrev_b32 v13, 4, v0
    v_mul_u32_u24 v13, 32768, v13
    v_and_b32 v14, 15, v0
    v_add_u32 v14, s33, v14
    v_lshl_add_u32 v13, v14, 4, v13
    s_mov_b32 s34, 0
    s_waitcnt lgkmcnt(4)
    buffer_store_dwordx4 v[72:75], v13, s[24:27], s34 offen sc1
    s_add_u32 s34, s34, 524288
    s_waitcnt lgkmcnt(3)
    buffer_store_dwordx4 v[76:79], v13, s[24:27], s34 offen sc1
    s_add_u32 s34, s34, 524288
    s_waitcnt lgkmcnt(2)
    buffer_store_dwordx4 v[80:83], v13, s[24:27], s34 offen sc1
    s_add_u32 s34, s34, 524288
    s_waitcnt lgkmcnt(1)
    buffer_store_dwordx4 v[84:87], v13, s[24:27], s34 offen sc1
    s_add_u32 s34, s34, 524288
    s_waitcnt lgkmcnt(0)
    buffer_store_dwordx4 v[88:91], v13, s[24:27], s34 offen sc1
    s_branch interleave_layers__mha_block__dense_activation_silu__prompt_kernel_p0_arr
interleave_layers__mha_block__dense_activation_silu__prompt_kernel_p0_p1a:
    s_lshr_b32 s18, s2, 3
    s_and_b32 s19, s2, 7
    v_lshrrev_b32 v4, 4, v0
    v_and_b32 v3, 15, v0
    v_mul_u32_u24 v10, 288, v4
    v_lshl_add_u32 v10, v3, 4, v10
    v_add_u32 v10, 0, v10
    ds_write_b128 v10, v[20:23] offset:0
    ds_write_b128 v10, v[24:27] offset:4608
    ds_write_b128 v10, v[28:31] offset:9216
    ds_write_b128 v10, v[32:35] offset:13824
    ds_write_b128 v10, v[36:39] offset:18432
    v_lshrrev_b32 v4, 1, v0
    v_and_b32 v3, 1, v0
    v_mul_u32_u24 v10, 288, v4
    v_lshl_add_u32 v10, v3, 4, v10
    v_add_u32 v10, 256, v10
    v_mov_b32 v11, 160
    v_cmp_gt_u32 vcc, v11, v0
    s_and_saveexec_b64 s[34:35], vcc
    s_cbranch_execz interleave_layers__mha_block__dense_activation_silu__prompt_kernel_p0_pa1_x16
    ds_write_b128 v10, v[40:43]
interleave_layers__mha_block__dense_activation_silu__prompt_kernel_p0_pa1_x16:
    s_mov_b64 exec, s[34:35]
    s_mov_b32 s24, s6
    s_and_b32 s25, s7, 0xffff
    s_mov_b32 s26, 2457600
    s_mov_b32 s27, 0x20000
    s_add_u32 s28, s6, 7700480
    s_addc_u32 s29, s7, 0
    s_and_b32 s29, s29, 0xffff
    s_mov_b32 s30, 61440
    s_mov_b32 s31, 0x20000
    s_lshl_b32 s37, s18, 7
    s_cmp_ge_u32 s18, 5
    s_cselect_b32 s35, 5, 0
    s_sub_u32 s35, s18, s35
    s_cmp_eq_u32 s35, 3
    s_cselect_b32 s36, 8, 0
    s_cmp_eq_u32 s35, 4
    s_cselect_b32 s36, 16, s36
    s_cmp_ge_u32 s18, 10
    s_cselect_b32 s36, 0, s36
    s_sub_u32 s37, s37, s36
    v_and_b32 v1, 63, v0
    v_lshrrev_b32 v11, 4, v1
    v_bfe_u32 v12, v1, 2, 2
    v_and_b32 v13, 3, v1
    v_and_b32 v15, 1, v11
    v_lshl_add_u32 v6, v15, 2, v13
    s_lshl_b32 s33, s18, 2
    s_add_u32 s33, s33, s16
    s_cmp_ge_u32 s18, 10
    s_cbranch_scc1 interleave_layers__mha_block__dense_activation_silu__prompt_kernel_p0_pa1_vcol
    v_lshrrev_b32 v8, 2, v6
    v_lshlrev_b32 v8, 1, v8
    v_and_b32 v9, 1, v6
    v_add_u32 v8, v8, v9
    v_bfe_u32 v9, v6, 1, 1
    s_cmp_ge_u32 s33, 20
    s_cselect_b32 s34, 20, 0
    s_cselect_b32 s35, 640, 0
    s_sub_u32 s34, s33, s34
    s_lshl_b32 s34, s34, 2
    v_add_u32 v7, s34, v8
    v_mul_u32_u24 v2, 205, v7
    v_lshrrev_b32 v2, 10, v2
    v_mul_u32_u24 v3, 5, v2
    v_sub_u32 v3, v7, v3
    v_lshrrev_b32 v4, 1, v3
    v_and_b32 v5, 1, v3
    v_lshlrev_b32 v5, 3, v5
    v_lshl_add_u32 v5, v9, 2, v5
    v_cmp_eq_u32 vcc, 4, v3
    v_mov_b32 v8, 16
    s_nop 0
    v_cndmask_b32 v4, v4, v9, vcc
    v_cndmask_b32 v5, v5, v8, vcc
    v_lshl_add_u32 v4, v2, 1, v4
    v_mul_u32_u24 v4, 20, v4
    v_add_u32 v4, v4, v5
    v_add_u32 v8, s35, v4
    s_branch interleave_layers__mha_block__dense_activation_silu__prompt_kernel_p0_pa1_cgo
interleave_layers__mha_block__dense_activation_silu__prompt_kernel_p0_pa1_vcol:
    s_lshl_b32 s34, s33, 5
    v_lshl_add_u32 v8, v6, 2, s34
interleave_layers__mha_block__dense_activation_silu__prompt_kernel_p0_pa1_cgo:
    v_subrev_u32 v8, s37, v8
    v_lshrrev_b32 v14, 1, v11
    v_lshl_add_u32 v14, v14, 3, v12
    v_mul_u32_u24 v14, 288, v14
    v_lshl_add_u32 v14, v8, 1, v14
    v_add_u32 v14, 0, v14
    v_mov_b32 v16, 0x3f803f80
    v_mov_b32 v17, 0x3f803f80
    v_mov_b32 v18, 0x3f803f80
    v_mov_b32 v19, 0x3f803f80
    s_waitcnt lgkmcnt(0)
    s_barrier
    ds_read_b64_tr_b16 v[72:73], v14 offset:0
    ds_read_b64_tr_b16 v[74:75], v14 offset:1152
    ds_read_b64_tr_b16 v[76:77], v14 offset:4608
    ds_read_b64_tr_b16 v[78:79], v14 offset:5760
    ds_read_b64_tr_b16 v[80:81], v14 offset:9216
    ds_read_b64_tr_b16 v[82:83], v14 offset:10368
    ds_read_b64_tr_b16 v[84:85], v14 offset:13824
    ds_read_b64_tr_b16 v[86:87], v14 offset:14976
    ds_read_b64_tr_b16 v[88:89], v14 offset:18432
    ds_read_b64_tr_b16 v[90:91], v14 offset:19584
    s_lshl_b32 s33, s18, 2
    s_add_u32 s33, s33, s16
    s_mul_i32 s34, s33, 40
    s_mul_i32 s35, s19, 5
    s_add_u32 s34, s34, s35
    s_lshl_b32 s34, s34, 10
    v_lshlrev_b32 v10, 4, v1
    s_waitcnt lgkmcnt(8)
    buffer_store_dwordx4 v[72:75], v10, s[24:27], s34 offen sc1
    v_mfma_f32_32x32x16_bf16 v[96:111], v[16:19], v[72:75], 0
    s_add_u32 s34, s34, 1024
    s_waitcnt lgkmcnt(6)
    buffer_store_dwordx4 v[76:79], v10, s[24:27], s34 offen sc1
    v_mfma_f32_32x32x16_bf16 v[96:111], v[16:19], v[76:79], v[96:111]
    s_add_u32 s34, s34, 1024
    s_waitcnt lgkmcnt(4)
    buffer_store_dwordx4 v[80:83], v10, s[24:27], s34 offen sc1
    v_mfma_f32_32x32x16_bf16 v[96:111], v[16:19], v[80:83], v[96:111]
    s_add_u32 s34, s34, 1024
    s_waitcnt lgkmcnt(2)
    buffer_store_dwordx4 v[84:87], v10, s[24:27], s34 offen sc1
    v_mfma_f32_32x32x16_bf16 v[96:111], v[16:19], v[84:87], v[96:111]
    s_add_u32 s34, s34, 1024
    s_waitcnt lgkmcnt(0)
    buffer_store_dwordx4 v[88:91], v10, s[24:27], s34 offen sc1
    v_mfma_f32_32x32x16_bf16 v[96:111], v[16:19], v[88:91], v[96:111]
    v_and_b32 v11, 31, v1
    s_lshl_b32 s33, s33, 5
    v_add_u32 v11, s33, v11
    v_lshlrev_b32 v11, 2, v11
    v_mov_b32 v12, 0x7ffffff0
    s_mul_i32 s35, s19, 7680
    v_lshrrev_b32 v13, 2, v11
    v_mov_b32 v15, 1920
    v_cmp_gt_u32 vcc, v15, v13
    s_nop 7
    v_cndmask_b32 v11, v12, v11, vcc
    s_nop 3
    buffer_store_dword v96, v11, s[28:31], s35 offen sc1
interleave_layers__mha_block__dense_activation_silu__prompt_kernel_p0_arr:
    s_cmp_lg_u32 s16, 0
    s_cbranch_scc1 interleave_layers__mha_block__dense_activation_silu__prompt_kernel_p0_flag_ok
    v_mov_b32 v250, 0
    s_mov_b32 s101, 0
interleave_layers__mha_block__dense_activation_silu__prompt_kernel_p0_flag:
    global_load_dword v251, v250, s[10:11] sc1
    s_add_u32 s101, s101, 1
    s_waitcnt vmcnt(0)
    v_readfirstlane_b32 s100, v251
    s_cmp_ge_u32 s101, 262144
    s_cbranch_scc1 interleave_layers__mha_block__dense_activation_silu__prompt_kernel_p0_flag_ok
    s_cmp_lg_u32 s100, 0
    s_cbranch_scc1 interleave_layers__mha_block__dense_activation_silu__prompt_kernel_p0_flag_ok
    s_sleep 1
    s_branch interleave_layers__mha_block__dense_activation_silu__prompt_kernel_p0_flag
interleave_layers__mha_block__dense_activation_silu__prompt_kernel_p0_flag_ok:
    s_lshr_b32 s17, s2, 3
    s_sub_u32 s18, s2, 120
    s_lshr_b32 s18, s18, 3
    s_add_u32 s18, s18, 16
    s_cmp_lt_u32 s2, 120
    s_cselect_b32 s17, s17, s18
    s_cmp_lt_u32 s2, 248
    s_cselect_b32 s17, s17, 15
    s_waitcnt vmcnt(0) lgkmcnt(0)
    s_barrier
    s_cmp_lg_u32 s16, 0
    s_cbranch_scc1 arr_done_1
    s_add_u32 s100, s17, 224
    s_lshl_b32 s100, s100, 7
    s_add_u32 s100, s100, s97
    v_mov_b32 v250, s100
    v_mov_b32 v251, 1
    s_mov_b64 exec, 1
    global_atomic_add v250, v251, s[98:99] sc1
    s_mov_b64 exec, -1
arr_done_1:
    s_cmp_lt_u32 s2, 112
    s_cbranch_scc0 interleave_layers__mha_block__dense_activation_silu__prompt_kernel_p0_p2b
    s_lshr_b32 s18, s2, 3
    s_and_b32 s19, s2, 7
    v_lshrrev_b32 v4, 4, v0
    v_and_b32 v3, 15, v0
    v_mul_u32_u24 v10, 288, v4
    v_lshl_add_u32 v10, v3, 4, v10
    v_add_u32 v10, 32768, v10
    ds_write_b128 v10, v[44:47] offset:0
    ds_write_b128 v10, v[48:51] offset:4608
    ds_write_b128 v10, v[52:55] offset:9216
    ds_write_b128 v10, v[56:59] offset:13824
    ds_write_b128 v10, v[60:63] offset:18432
    s_add_u32 s24, s6, 2457600
    s_addc_u32 s25, s7, 0
    s_and_b32 s25, s25, 0xffff
    s_mov_b32 s26, 2211840
    s_mov_b32 s27, 0x20000
    s_add_u32 s28, s6, 7761920
    s_addc_u32 s29, s7, 0
    s_and_b32 s29, s29, 0xffff
    s_mov_b32 s30, 55296
    s_mov_b32 s31, 0x20000
    s_lshl_b32 s37, s18, 7
    v_and_b32 v1, 63, v0
    v_lshrrev_b32 v11, 4, v1
    v_bfe_u32 v12, v1, 2, 2
    v_and_b32 v13, 3, v1
    v_and_b32 v15, 1, v11
    v_lshl_add_u32 v6, v15, 2, v13
    s_lshl_b32 s33, s18, 2
    s_add_u32 s33, s33, s16
    s_lshl_b32 s34, s33, 5
    v_lshrrev_b32 v9, 2, v6
    v_lshl_add_u32 v8, v9, 4, s34
    v_and_b32 v9, 1, v6
    v_lshl_add_u32 v8, v9, 3, v8
    v_bfe_u32 v9, v6, 1, 1
    v_lshl_add_u32 v8, v9, 2, v8
    v_subrev_u32 v8, s37, v8
    v_lshrrev_b32 v14, 1, v11
    v_lshl_add_u32 v14, v14, 3, v12
    v_mul_u32_u24 v14, 288, v14
    v_lshl_add_u32 v14, v8, 1, v14
    v_add_u32 v14, 32768, v14
    v_mov_b32 v16, 0x3f803f80
    v_mov_b32 v17, 0x3f803f80
    v_mov_b32 v18, 0x3f803f80
    v_mov_b32 v19, 0x3f803f80
    s_waitcnt lgkmcnt(0)
    s_barrier
    ds_read_b64_tr_b16 v[72:73], v14 offset:0
    ds_read_b64_tr_b16 v[74:75], v14 offset:1152
    ds_read_b64_tr_b16 v[76:77], v14 offset:4608
    ds_read_b64_tr_b16 v[78:79], v14 offset:5760
    ds_read_b64_tr_b16 v[80:81], v14 offset:9216
    ds_read_b64_tr_b16 v[82:83], v14 offset:10368
    ds_read_b64_tr_b16 v[84:85], v14 offset:13824
    ds_read_b64_tr_b16 v[86:87], v14 offset:14976
    ds_read_b64_tr_b16 v[88:89], v14 offset:18432
    ds_read_b64_tr_b16 v[90:91], v14 offset:19584
    s_lshl_b32 s33, s18, 2
    s_add_u32 s33, s33, s16
    s_mul_i32 s34, s33, 40
    s_mul_i32 s35, s19, 5
    s_add_u32 s34, s34, s35
    s_lshl_b32 s34, s34, 10
    v_lshlrev_b32 v10, 4, v1
    s_waitcnt lgkmcnt(8)
    buffer_store_dwordx4 v[72:75], v10, s[24:27], s34 offen sc1
    v_mfma_f32_32x32x16_bf16 v[96:111], v[16:19], v[72:75], 0
    s_add_u32 s34, s34, 1024
    s_waitcnt lgkmcnt(6)
    buffer_store_dwordx4 v[76:79], v10, s[24:27], s34 offen sc1
    v_mfma_f32_32x32x16_bf16 v[96:111], v[16:19], v[76:79], v[96:111]
    s_add_u32 s34, s34, 1024
    s_waitcnt lgkmcnt(4)
    buffer_store_dwordx4 v[80:83], v10, s[24:27], s34 offen sc1
    v_mfma_f32_32x32x16_bf16 v[96:111], v[16:19], v[80:83], v[96:111]
    s_add_u32 s34, s34, 1024
    s_waitcnt lgkmcnt(2)
    buffer_store_dwordx4 v[84:87], v10, s[24:27], s34 offen sc1
    v_mfma_f32_32x32x16_bf16 v[96:111], v[16:19], v[84:87], v[96:111]
    s_add_u32 s34, s34, 1024
    s_waitcnt lgkmcnt(0)
    buffer_store_dwordx4 v[88:91], v10, s[24:27], s34 offen sc1
    v_mfma_f32_32x32x16_bf16 v[96:111], v[16:19], v[88:91], v[96:111]
    v_and_b32 v11, 31, v1
    s_lshl_b32 s33, s33, 5
    v_add_u32 v11, s33, v11
    v_lshlrev_b32 v11, 2, v11
    v_mov_b32 v12, 0x7ffffff0
    s_mul_i32 s35, s19, 6912
    v_lshrrev_b32 v13, 2, v11
    v_mov_b32 v15, 1728
    v_cmp_gt_u32 vcc, v15, v13
    s_nop 7
    v_cndmask_b32 v11, v12, v11, vcc
    s_nop 3
    buffer_store_dword v96, v11, s[28:31], s35 offen sc1
    s_branch interleave_layers__mha_block__dense_activation_silu__prompt_kernel_p0_p2d
interleave_layers__mha_block__dense_activation_silu__prompt_kernel_p0_p2b:
    s_add_u32 s24, s6, 5488640
    s_addc_u32 s25, s7, 0
    s_add_u32 s100, s6, 4669440
    s_addc_u32 s101, s7, 0
    s_cmp_eq_u32 s43, 0
    s_cselect_b32 s24, s24, s100
    s_cselect_b32 s25, s25, s101
    s_mov_b32 s26, 819200
    s_cselect_b32 s26, 2211840, s26
    s_and_b32 s25, s25, 0xffff
    s_mov_b32 s27, 0x20000
    v_lshlrev_b32 v10, 4, v0
    v_add_u32 v10, 32768, v10
    ds_write_b128 v10, v[44:47] offset:0
    ds_write_b128 v10, v[48:51] offset:4096
    ds_write_b128 v10, v[52:55] offset:8192
    ds_write_b128 v10, v[56:59] offset:12288
    ds_write_b128 v10, v[60:63] offset:16384
    ds_write_b128 v10, v[64:67] offset:20480
    ds_write_b128 v10, v[68:71] offset:24576
    v_and_b32 v1, 63, v0
    v_lshrrev_b32 v11, 4, v1
    v_bfe_u32 v12, v1, 2, 2
    v_and_b32 v13, 3, v1
    v_lshl_add_u32 v12, v11, 3, v12
    v_mul_u32_u24 v12, 160, v12
    v_add_u32 v12, 32768, v12
    v_lshl_add_u32 v14, v13, 4, v12
    v_lshl_add_u32 v15, v13, 3, v12
    v_lshlrev_b32 v10, 4, v1
    s_mov_b32 s50, s16
    s_waitcnt lgkmcnt(0)
    s_barrier
interleave_layers__mha_block__dense_activation_silu__prompt_kernel_p0_pb_ks:
    s_add_u32 s33, s48, s50
    s_cmp_ge_u32 s33, s49
    s_cbranch_scc1 interleave_layers__mha_block__dense_activation_silu__prompt_kernel_p0_pb_done
    s_mul_i32 s36, s50, 5120
    v_add_u32 v16, s36, v14
    v_add_u32 v17, s36, v15
    ds_read_b64_tr_b16 v[72:73], v16 offset:0
    ds_read_b64_tr_b16 v[74:75], v16 offset:640
    ds_read_b64_tr_b16 v[76:77], v16 offset:8
    ds_read_b64_tr_b16 v[78:79], v16 offset:648
    ds_read_b64_tr_b16 v[80:81], v16 offset:64
    ds_read_b64_tr_b16 v[82:83], v16 offset:704
    ds_read_b64_tr_b16 v[84:85], v16 offset:72
    ds_read_b64_tr_b16 v[86:87], v16 offset:712
    ds_read_b64_tr_b16 v[88:89], v17 offset:128
    ds_read_b64_tr_b16 v[90:91], v17 offset:768
    s_mul_i32 s34, s40, s49
    s_add_u32 s34, s34, s33
    s_mul_i32 s34, s34, 5120
    s_waitcnt lgkmcnt(8)
    buffer_store_dwordx4 v[72:75], v10, s[24:27], s34 offen sc1
    s_add_u32 s34, s34, 1024
    s_waitcnt lgkmcnt(6)
    buffer_store_dwordx4 v[76:79], v10, s[24:27], s34 offen sc1
    s_add_u32 s34, s34, 1024
    s_waitcnt lgkmcnt(4)
    buffer_store_dwordx4 v[80:83], v10, s[24:27], s34 offen sc1
    s_add_u32 s34, s34, 1024
    s_waitcnt lgkmcnt(2)
    buffer_store_dwordx4 v[84:87], v10, s[24:27], s34 offen sc1
    s_add_u32 s34, s34, 1024
    s_waitcnt lgkmcnt(0)
    buffer_store_dwordx4 v[88:91], v10, s[24:27], s34 offen sc1
    s_add_u32 s50, s50, 4
    s_mul_i32 s36, s50, 32
    s_cmp_lt_u32 s36, s42
    s_cbranch_scc1 interleave_layers__mha_block__dense_activation_silu__prompt_kernel_p0_pb_ks
interleave_layers__mha_block__dense_activation_silu__prompt_kernel_p0_pb_done:
interleave_layers__mha_block__dense_activation_silu__prompt_kernel_p0_p2d:
interleave_layers__mha_block__dense_activation_silu__prompt_kernel_layer:
    s_and_b32 s20, s12, 3
    s_lshl_b32 s20, s20, 2
    s_and_b32 s21, s13, 3
    s_add_u32 s17, s20, s21
    s_lshr_b32 s20, s12, 2
    s_lshl_b32 s20, s20, 3
    s_lshr_b32 s21, s13, 2
    s_add_u32 s18, s20, s21
    s_cmp_ge_u32 s18, 15
    s_cbranch_scc1 interleave_layers__mha_block__dense_activation_silu__prompt_kernel_qkv_idle
    s_lshl_b32 s19, s18, 2
    s_add_u32 s19, s19, s16
    v_and_b32 v1, 63, v0
    v_and_b32 v2, 31, v0
    v_lshlrev_b32 v6, 4, v1
    s_add_u32 s32, s6, 7700480
    s_addc_u32 s33, s7, 0
    s_and_b32 s33, s33, 0xffff
    s_mov_b32 s34, 61440
    s_mov_b32 s35, 0x20000
    v_bfe_u32 v3, v0, 5, 1
    s_lshl_b32 s37, s19, 5
    v_add_u32 v7, s37, v2
    v_lshlrev_b32 v7, 2, v7
    v_mul_u32_u24 v22, 30720, v3
    v_add_u32 v7, v7, v22
    s_movk_i32 s59, 7680
    s_movk_i32 s60, 15360
    s_movk_i32 s61, 23040
    s_cmp_eq_u32 s14, 0
    s_cbranch_scc1 interleave_layers__mha_block__dense_activation_silu__prompt_kernel_qkv_w_skip
    s_add_u32 s80, s76, 0
    buffer_load_dwordx4 a[96:99], v249, s[72:75], s80 offen offset:0 sc1
    buffer_load_dwordx4 a[100:103], v249, s[72:75], s80 offen offset:1024 sc1
    buffer_load_dwordx4 a[104:107], v249, s[72:75], s80 offen offset:2048 sc1
    buffer_load_dwordx4 a[108:111], v249, s[72:75], s80 offen offset:3072 sc1
    s_add_u32 s80, s76, 4096
    buffer_load_dwordx4 a[112:115], v249, s[72:75], s80 offen offset:0 sc1
    buffer_load_dwordx4 a[116:119], v249, s[72:75], s80 offen offset:1024 sc1
    buffer_load_dwordx4 a[120:123], v249, s[72:75], s80 offen offset:2048 sc1
    buffer_load_dwordx4 a[124:127], v249, s[72:75], s80 offen offset:3072 sc1
    s_add_u32 s80, s76, 8192
    buffer_load_dwordx4 a[128:131], v249, s[72:75], s80 offen offset:0 sc1
    buffer_load_dwordx4 a[132:135], v249, s[72:75], s80 offen offset:1024 sc1
    buffer_load_dwordx4 a[136:139], v249, s[72:75], s80 offen offset:2048 sc1
    buffer_load_dwordx4 a[140:143], v249, s[72:75], s80 offen offset:3072 sc1
    s_add_u32 s80, s76, 12288
    buffer_load_dwordx4 a[144:147], v249, s[72:75], s80 offen offset:0 sc1
    buffer_load_dwordx4 a[148:151], v249, s[72:75], s80 offen offset:1024 sc1
    buffer_load_dwordx4 a[152:155], v249, s[72:75], s80 offen offset:2048 sc1
    buffer_load_dwordx4 a[156:159], v249, s[72:75], s80 offen offset:3072 sc1
    buffer_load_dword v152, v7, s[32:35], 0 offen sc1
    buffer_load_dword v153, v7, s[32:35], s59 offen sc1
    buffer_load_dword v154, v7, s[32:35], s60 offen sc1
    buffer_load_dword v155, v7, s[32:35], s61 offen sc1
interleave_layers__mha_block__dense_activation_silu__prompt_kernel_qkv_w_skip:
    v_lshlrev_b32 v20, 11, v3
    v_lshl_add_u32 v8, v2, 4, v20
    v_add_u32 v9, 0x10000, v8
    v_add_u32 v10, 0x20000, v8
    s_cmp_eq_u32 s14, 0
    s_cbranch_scc1 skipw_2
    s_cmp_lg_u32 s16, 0
    s_cbranch_scc1 we_done_3
    s_add_u32 s100, s17, 56
    s_lshl_b32 s100, s100, 7
    s_add_u32 s100, s100, s97
    s_sub_u32 s100, s100, 14336
    v_mov_b32 v250, s100
    s_mov_b64 exec, 1
    global_load_dword v251, v250, s[98:99] sc1
    s_mov_b64 exec, -1
we_done_3:
skipw_2:
    s_add_u32 s20, s6, 38539264
    s_addc_u32 s21, s7, 0
    s_add_u32 s100, s6, 7835648
    s_addc_u32 s101, s7, 0
    s_cmp_eq_u32 s14, 0
    s_cselect_b32 s20, s100, s20
    s_cselect_b32 s21, s101, s21
    s_and_b32 s21, s21, 0xffff
    s_mov_b32 s22, 2621440
    s_mov_b32 s23, 0x20000
    s_add_u32 s28, s6, 41291776
    s_addc_u32 s29, s7, 0
    s_add_u32 s100, s6, 7819264
    s_addc_u32 s101, s7, 0
    s_cmp_eq_u32 s14, 0
    s_cselect_b32 s28, s100, s28
    s_cselect_b32 s29, s101, s29
    s_and_b32 s29, s29, 0xffff
    s_mov_b32 s30, 131072
    s_mov_b32 s31, 0x20000
    s_cmp_eq_u32 s14, 0
    s_cselect_b32 s30, 16384, s30
    s_lshl_b32 s36, s17, 7
    s_lshl_b32 s37, s16, 5
    s_add_u32 s36, s36, s37
    v_add_u32 v20, s36, v2
    v_lshlrev_b32 v20, 3, v20
    v_lshlrev_b32 v4, 16, v3
    v_add_u32 v4, v4, v20
    s_mul_i32 s38, s16, 65536
    s_lshl_b32 s37, s17, 11
    s_add_u32 s38, s38, s37
    s_lshl_b32 s40, s16, 12
    s_movk_i32 s56, 16384
    s_mov_b32 s57, 32768
    s_mov_b32 s58, 49152
    s_lshl_b32 s43, s16, 7
    v_lshl_add_u32 v28, v2, 2, s43
    v_add_u32 v28, 147456, v28
    v_lshlrev_b32 v29, 2, v2
    v_add_u32 v29, 147456, v29
    v_lshlrev_b32 v30, 4, v3
    v_add_u32 v31, 147456, v30
    v_add_u32 v30, s43, v30
    v_add_u32 v30, 148480, v30
    v_mov_b32 v168, 0
    v_mov_b32 v169, 0
    v_mov_b32 v170, 0
    v_mov_b32 v171, 0
    s_cmp_ge_u32 s18, 10
    s_cbranch_scc1 interleave_layers__mha_block__dense_activation_silu__prompt_kernel_qkv_adr_v
    s_cmp_ge_u32 s19, 20
    s_mov_b32 s44, 10489856
    s_cselect_b32 s44, 13111296, s44
    s_cselect_b32 s45, 20, 0
    s_cselect_b32 s46, 1.0, 0x3ea52b5c
    s_add_u32 s44, s44, s96
    s_add_u32 s48, s6, s44
    s_addc_u32 s49, s7, 0
    s_and_b32 s49, s49, 0xffff
    s_mov_b32 s50, 2621440
    s_mov_b32 s51, 0x20000
    s_sub_u32 s45, s19, s45
    s_lshl_b32 s45, s45, 2
    s_lshl_b32 s47, s17, 2
    v_add_u32 v21, s45, v3
    v_add_u32 v21, 0, v21
    v_mul_u32_u24 v22, 205, v21
    v_lshrrev_b32 v22, 10, v22
    v_mul_u32_u24 v23, 5, v22
    v_sub_u32 v23, v21, v23
    v_lshrrev_b32 v24, 1, v23
    v_lshl_add_u32 v24, v22, 1, v24
    v_lshlrev_b32 v24, 6, v24
    v_add_u32 v24, s47, v24
    v_lshlrev_b32 v24, 10, v24
    v_and_b32 v25, 1, v23
    v_lshl_add_u32 v24, v25, 9, v24
    v_lshl_add_u32 v24, v2, 4, v24
    v_lshlrev_b32 v25, 6, v22
    v_add_u32 v25, s47, v25
    v_lshlrev_b32 v25, 9, v25
    v_lshl_add_u32 v25, v2, 4, v25
    v_add_u32 v25, 2097152, v25
    v_cmp_eq_u32 vcc, 4, v23
    v_mov_b32 v26, 1024
    v_mov_b32 v27, 512
    v_cndmask_b32 v168, v24, v25, vcc
    v_cndmask_b32 v169, v26, v27, vcc
    v_add_u32 v21, s45, v3
    v_add_u32 v21, 2, v21
    v_mul_u32_u24 v22, 205, v21
    v_lshrrev_b32 v22, 10, v22
    v_mul_u32_u24 v23, 5, v22
    v_sub_u32 v23, v21, v23
    v_lshrrev_b32 v24, 1, v23
    v_lshl_add_u32 v24, v22, 1, v24
    v_lshlrev_b32 v24, 6, v24
    v_add_u32 v24, s47, v24
    v_lshlrev_b32 v24, 10, v24
    v_and_b32 v25, 1, v23
    v_lshl_add_u32 v24, v25, 9, v24
    v_lshl_add_u32 v24, v2, 4, v24
    v_lshlrev_b32 v25, 6, v22
    v_add_u32 v25, s47, v25
    v_lshlrev_b32 v25, 9, v25
    v_lshl_add_u32 v25, v2, 4, v25
    v_add_u32 v25, 2097152, v25
    v_cmp_eq_u32 vcc, 4, v23
    v_mov_b32 v26, 1024
    v_mov_b32 v27, 512
    v_cndmask_b32 v170, v24, v25, vcc
    v_cndmask_b32 v171, v26, v27, vcc
    s_branch interleave_layers__mha_block__dense_activation_silu__prompt_kernel_qkv_adr_done
interleave_layers__mha_block__dense_activation_silu__prompt_kernel_qkv_adr_v:
    s_add_u32 s48, s96, 15732736
    s_add_u32 s48, s48, s6
    s_addc_u32 s49, s7, 0
    s_and_b32 s49, s49, 0xffff
    s_mov_b32 s50, 2621440
    s_mov_b32 s51, 0x20000
    s_sub_u32 s45, s19, 40
    s_lshl_b32 s45, s45, 5
    v_add_u32 v20, s45, v2
    v_mul_u32_u24 v21, 3277, v20
    v_lshrrev_b32 v21, 16, v21
    v_mul_u32_u24 v22, 20, v21
    v_sub_u32 v22, v20, v22
    v_bfe_u32 v23, v22, 2, 1
    v_lshlrev_b32 v23, 3, v23
    v_bfe_u32 v24, v22, 3, 1
    v_lshl_add_u32 v23, v24, 2, v23
    v_and_b32 v24, 3, v22
    v_add_u32 v23, v23, v24
    v_cmp_le_u32 vcc, 16, v22
    s_lshl_b32 s47, s17, 2
    v_lshlrev_b32 v21, 6, v21
    v_cndmask_b32 v23, v23, v22, vcc
    v_add_u32 v21, s47, v21
    v_mul_u32_u24 v21, 1280, v21
    v_mul_u32_u24 v24, 320, v3
    v_add_u32 v21, v21, v24
    v_lshl_add_u32 v168, v23, 4, v21
interleave_layers__mha_block__dense_activation_silu__prompt_kernel_qkv_adr_done:
    s_cmp_eq_u32 s14, 0
    s_cbranch_scc1 skipw_4
    s_cmp_lg_u32 s16, 0
    s_cbranch_scc1 wt_done_5
    s_add_u32 s100, s17, 56
    s_lshl_b32 s100, s100, 7
    s_add_u32 s100, s100, s97
    s_sub_u32 s100, s100, 14336
    v_mov_b32 v250, s100
    s_mov_b32 s101, 0
    s_mov_b64 exec, 1
    s_waitcnt vmcnt(0)
    v_cmp_le_u32 vcc, 16, v251
    s_nop 0
    s_cmp_eq_u64 vcc, exec
    s_cbranch_scc1 wt_ok_5
wt_poll_5:
    global_load_dword v251, v250, s[98:99] sc1
    s_add_u32 s101, s101, 1
    s_waitcnt vmcnt(0)
    v_cmp_le_u32 vcc, 16, v251
    s_cmp_ge_u32 s101, 262144
    s_cbranch_scc1 wt_ok_5
    s_cmp_eq_u64 vcc, exec
    s_cbranch_scc1 wt_ok_5
    s_sleep 1
    s_branch wt_poll_5
wt_ok_5:
    s_mov_b64 exec, -1
wt_done_5:
    s_barrier
    s_branch skipw2_4
skipw_4:
    s_cmp_lg_u32 s16, 0
    s_cbranch_scc1 p0w_done_6
    s_cmp_ge_u32 s18, 15
    s_cbranch_scc1 p0w_done_6
    s_add_u32 s100, s18, 224
    s_lshl_b32 s100, s100, 7
    s_add_u32 s101, s17, 240
    s_lshl_b32 s101, s101, 7
    v_mov_b32 v250, s100
    v_mov_b32 v251, s101
    v_cmp_eq_u32 vcc, 0, v0
    s_mov_b32 s101, 0
    s_nop 0
    v_cndmask_b32 v250, v251, v250, vcc
    s_mov_b64 exec, 3
p0w_poll_6:
    global_load_dword v251, v250, s[98:99] sc1
    s_add_u32 s101, s101, 1
    s_waitcnt vmcnt(0)
    v_cmp_le_u32 vcc, 8, v251
    s_cmp_ge_u32 s101, 262144
    s_cbranch_scc1 p0w_ok_6
    s_cmp_eq_u64 vcc, exec
    s_cbranch_scc1 p0w_ok_6
    s_sleep 1
    s_branch p0w_poll_6
p0w_ok_6:
    s_mov_b64 exec, -1
p0w_done_6:
    s_barrier
skipw2_4:
    s_cmp_lg_u32 s14, 0
    s_cbranch_scc1 interleave_layers__mha_block__dense_activation_silu__prompt_kernel_qkv_post1
    s_add_u32 s80, s76, 0
    buffer_load_dwordx4 a[96:99], v249, s[72:75], s80 offen offset:0 sc1
    buffer_load_dwordx4 a[100:103], v249, s[72:75], s80 offen offset:1024 sc1
    buffer_load_dwordx4 a[104:107], v249, s[72:75], s80 offen offset:2048 sc1
    buffer_load_dwordx4 a[108:111], v249, s[72:75], s80 offen offset:3072 sc1
    s_add_u32 m0, s40, 0
    s_add_u32 s42, s38, 0
    buffer_load_dwordx4 v6, s[20:23], s42 offen offset:0 sc1 lds
    buffer_load_dwordx4 v6, s[20:23], s42 offen offset:1024 sc1 lds
    s_add_u32 m0, s40, 2048
    s_add_u32 s42, s38, 32768
    buffer_load_dwordx4 v6, s[20:23], s42 offen offset:0 sc1 lds
    buffer_load_dwordx4 v6, s[20:23], s42 offen offset:1024 sc1 lds
    buffer_load_dword v152, v7, s[32:35], 0 offen sc1
    buffer_load_dword v153, v7, s[32:35], s59 offen sc1
    buffer_load_dword v154, v7, s[32:35], s60 offen sc1
    buffer_load_dword v155, v7, s[32:35], s61 offen sc1
    buffer_load_dwordx2 v[144:145], v4, s[28:31], 0 offen sc1
    buffer_load_dwordx2 v[146:147], v4, s[28:31], s56 offen sc1
    buffer_load_dwordx2 v[148:149], v4, s[28:31], s57 offen sc1
    buffer_load_dwordx2 v[150:151], v4, s[28:31], s58 offen sc1
    s_add_u32 s80, s76, 4096
    buffer_load_dwordx4 a[112:115], v249, s[72:75], s80 offen offset:0 sc1
    buffer_load_dwordx4 a[116:119], v249, s[72:75], s80 offen offset:1024 sc1
    buffer_load_dwordx4 a[120:123], v249, s[72:75], s80 offen offset:2048 sc1
    buffer_load_dwordx4 a[124:127], v249, s[72:75], s80 offen offset:3072 sc1
    s_add_u32 m0, s40, 16384
    s_add_u32 s42, s38, 262144
    buffer_load_dwordx4 v6, s[20:23], s42 offen offset:0 sc1 lds
    buffer_load_dwordx4 v6, s[20:23], s42 offen offset:1024 sc1 lds
    s_add_u32 m0, s40, 18432
    s_add_u32 s42, s38, 294912
    buffer_load_dwordx4 v6, s[20:23], s42 offen offset:0 sc1 lds
    buffer_load_dwordx4 v6, s[20:23], s42 offen offset:1024 sc1 lds
    s_add_u32 s80, s76, 8192
    buffer_load_dwordx4 a[128:131], v249, s[72:75], s80 offen offset:0 sc1
    buffer_load_dwordx4 a[132:135], v249, s[72:75], s80 offen offset:1024 sc1
    buffer_load_dwordx4 a[136:139], v249, s[72:75], s80 offen offset:2048 sc1
    buffer_load_dwordx4 a[140:143], v249, s[72:75], s80 offen offset:3072 sc1
    s_add_u32 m0, s40, 32768
    s_add_u32 s42, s38, 524288
    buffer_load_dwordx4 v6, s[20:23], s42 offen offset:0 sc1 lds
    buffer_load_dwordx4 v6, s[20:23], s42 offen offset:1024 sc1 lds
    s_add_u32 m0, s40, 34816
    s_add_u32 s42, s38, 557056
    buffer_load_dwordx4 v6, s[20:23], s42 offen offset:0 sc1 lds
    buffer_load_dwordx4 v6, s[20:23], s42 offen offset:1024 sc1 lds
    s_add_u32 s80, s76, 12288
    buffer_load_dwordx4 a[144:147], v249, s[72:75], s80 offen offset:0 sc1
    buffer_load_dwordx4 a[148:151], v249, s[72:75], s80 offen offset:1024 sc1
    buffer_load_dwordx4 a[152:155], v249, s[72:75], s80 offen offset:2048 sc1
    buffer_load_dwordx4 a[156:159], v249, s[72:75], s80 offen offset:3072 sc1
    s_waitcnt vmcnt(28)
    s_branch interleave_layers__mha_block__dense_activation_silu__prompt_kernel_qkv_post2
interleave_layers__mha_block__dense_activation_silu__prompt_kernel_qkv_post1:
    s_add_u32 m0, s40, 0
    s_add_u32 s42, s38, 0
    buffer_load_dwordx4 v6, s[20:23], s42 offen offset:0 sc1 lds
    buffer_load_dwordx4 v6, s[20:23], s42 offen offset:1024 sc1 lds
    s_add_u32 m0, s40, 2048
    s_add_u32 s42, s38, 32768
    buffer_load_dwordx4 v6, s[20:23], s42 offen offset:0 sc1 lds
    buffer_load_dwordx4 v6, s[20:23], s42 offen offset:1024 sc1 lds
    buffer_load_dwordx2 v[144:145], v4, s[28:31], 0 offen sc1
    buffer_load_dwordx2 v[146:147], v4, s[28:31], s56 offen sc1
    buffer_load_dwordx2 v[148:149], v4, s[28:31], s57 offen sc1
    buffer_load_dwordx2 v[150:151], v4, s[28:31], s58 offen sc1
    s_add_u32 m0, s40, 16384
    s_add_u32 s42, s38, 262144
    buffer_load_dwordx4 v6, s[20:23], s42 offen offset:0 sc1 lds
    buffer_load_dwordx4 v6, s[20:23], s42 offen offset:1024 sc1 lds
    s_add_u32 m0, s40, 18432
    s_add_u32 s42, s38, 294912
    buffer_load_dwordx4 v6, s[20:23], s42 offen offset:0 sc1 lds
    buffer_load_dwordx4 v6, s[20:23], s42 offen offset:1024 sc1 lds
    s_add_u32 m0, s40, 32768
    s_add_u32 s42, s38, 524288
    buffer_load_dwordx4 v6, s[20:23], s42 offen offset:0 sc1 lds
    buffer_load_dwordx4 v6, s[20:23], s42 offen offset:1024 sc1 lds
    s_add_u32 m0, s40, 34816
    s_add_u32 s42, s38, 557056
    buffer_load_dwordx4 v6, s[20:23], s42 offen offset:0 sc1 lds
    buffer_load_dwordx4 v6, s[20:23], s42 offen offset:1024 sc1 lds
    s_waitcnt vmcnt(12)
interleave_layers__mha_block__dense_activation_silu__prompt_kernel_qkv_post2:
    s_barrier
    s_cmp_ge_u32 s18, 10
    s_cbranch_scc1 interleave_layers__mha_block__dense_activation_silu__prompt_kernel_qkv_loop_c
interleave_layers__mha_block__dense_activation_silu__prompt_kernel_qkv_loop_ct:
    ds_read_b128 v[32:35], v8 offset:0
    ds_read_b128 v[36:39], v8 offset:512
    ds_read_b128 v[40:43], v8 offset:1024
    ds_read_b128 v[44:47], v8 offset:1536
    ds_read_b128 v[48:51], v8 offset:4096
    ds_read_b128 v[52:55], v8 offset:4608
    ds_read_b128 v[56:59], v8 offset:5120
    ds_read_b128 v[60:63], v8 offset:5632
    s_waitcnt lgkmcnt(4)
    v_mfma_f32_32x32x16_bf16 v[80:95], a[96:99], v[32:35], 0
    ds_read_b128 v[64:67], v8 offset:8192
    s_add_u32 m0, s40, 49152
    s_add_u32 s42, s38, 786432
    buffer_load_dwordx4 v6, s[20:23], s42 offen offset:0 sc1 lds
    v_mfma_f32_32x32x16_bf16 v[96:111], a[96:99], v[36:39], 0
    ds_read_b128 v[68:71], v8 offset:8704
    v_mfma_f32_32x32x16_bf16 v[112:127], a[96:99], v[40:43], 0
    ds_read_b128 v[72:75], v8 offset:9216
    buffer_load_dwordx4 v6, s[20:23], s42 offen offset:1024 sc1 lds
    v_mfma_f32_32x32x16_bf16 v[128:143], a[96:99], v[44:47], 0
    ds_read_b128 v[76:79], v8 offset:9728
    s_waitcnt lgkmcnt(4)
    v_mfma_f32_32x32x16_bf16 v[80:95], a[100:103], v[48:51], v[80:95]
    ds_read_b128 v[32:35], v8 offset:12288
    s_add_u32 m0, s40, 51200
    s_add_u32 s42, s38, 819200
    buffer_load_dwordx4 v6, s[20:23], s42 offen offset:0 sc1 lds
    v_mfma_f32_32x32x16_bf16 v[96:111], a[100:103], v[52:55], v[96:111]
    ds_read_b128 v[36:39], v8 offset:12800
    v_mfma_f32_32x32x16_bf16 v[112:127], a[100:103], v[56:59], v[112:127]
    ds_read_b128 v[40:43], v8 offset:13312
    buffer_load_dwordx4 v6, s[20:23], s42 offen offset:1024 sc1 lds
    v_mfma_f32_32x32x16_bf16 v[128:143], a[100:103], v[60:63], v[128:143]
    ds_read_b128 v[44:47], v8 offset:13824
    s_waitcnt vmcnt(8)
    s_barrier
    s_waitcnt lgkmcnt(4)
    v_mfma_f32_32x32x16_bf16 v[80:95], a[104:107], v[64:67], v[80:95]
    ds_read_b128 v[48:51], v8 offset:16384
    s_add_u32 s80, s76, 16384
    buffer_load_dwordx4 a[160:163], v249, s[72:75], s80 offen offset:0 sc1
    v_mfma_f32_32x32x16_bf16 v[96:111], a[104:107], v[68:71], v[96:111]
    ds_read_b128 v[52:55], v8 offset:16896
    v_mfma_f32_32x32x16_bf16 v[112:127], a[104:107], v[72:75], v[112:127]
    ds_read_b128 v[56:59], v8 offset:17408
    buffer_load_dwordx4 a[164:167], v249, s[72:75], s80 offen offset:1024 sc1
    v_mfma_f32_32x32x16_bf16 v[128:143], a[104:107], v[76:79], v[128:143]
    ds_read_b128 v[60:63], v8 offset:17920
    s_waitcnt lgkmcnt(4)
    v_mfma_f32_32x32x16_bf16 v[80:95], a[108:111], v[32:35], v[80:95]
    ds_read_b128 v[64:67], v8 offset:20480
    buffer_load_dwordx4 a[168:171], v249, s[72:75], s80 offen offset:2048 sc1
    v_mfma_f32_32x32x16_bf16 v[96:111], a[108:111], v[36:39], v[96:111]
    ds_read_b128 v[68:71], v8 offset:20992
    v_add_f32 v144, v144, v146
    v_add_f32 v145, v145, v147
    v_add_f32 v148, v148, v150
    v_add_f32 v149, v149, v151
    v_mfma_f32_32x32x16_bf16 v[112:127], a[108:111], v[40:43], v[112:127]
    ds_read_b128 v[72:75], v8 offset:21504
    buffer_load_dwordx4 a[172:175], v249, s[72:75], s80 offen offset:3072 sc1
    v_mfma_f32_32x32x16_bf16 v[128:143], a[108:111], v[44:47], v[128:143]
    ds_read_b128 v[76:79], v8 offset:22016
    v_add_f32 v144, v144, v148
    v_add_f32 v145, v145, v149
    v_add_f32 v152, v152, v153
    v_add_f32 v154, v154, v155
    s_waitcnt lgkmcnt(4)
    v_mfma_f32_32x32x16_bf16 v[80:95], a[112:115], v[48:51], v[80:95]
    ds_read_b128 v[32:35], v8 offset:24576
    s_add_u32 m0, s40, 65536
    s_add_u32 s42, s38, 1048576
    buffer_load_dwordx4 v6, s[20:23], s42 offen offset:0 sc1 lds
    v_mfma_f32_32x32x16_bf16 v[96:111], a[112:115], v[52:55], v[96:111]
    ds_read_b128 v[36:39], v8 offset:25088
    v_mov_b32 v146, v144
    v_mov_b32 v147, v145
    v_add_f32 v156, v152, v154
    v_add_f32 v157, v152, v154
    v_mfma_f32_32x32x16_bf16 v[112:127], a[112:115], v[56:59], v[112:127]
    ds_read_b128 v[40:43], v8 offset:25600
    buffer_load_dwordx4 v6, s[20:23], s42 offen offset:1024 sc1 lds
    v_mfma_f32_32x32x16_bf16 v[128:143], a[112:115], v[60:63], v[128:143]
    ds_read_b128 v[44:47], v8 offset:26112
    s_nop 0
    v_permlane32_swap_b32 v144, v146
    v_permlane32_swap_b32 v145, v147
    v_permlane32_swap_b32 v156, v157
    s_waitcnt lgkmcnt(4)
    v_mfma_f32_32x32x16_bf16 v[80:95], a[116:119], v[64:67], v[80:95]
    ds_read_b128 v[48:51], v8 offset:28672
    s_add_u32 m0, s40, 67584
    s_add_u32 s42, s38, 1081344
    buffer_load_dwordx4 v6, s[20:23], s42 offen offset:0 sc1 lds
    v_mfma_f32_32x32x16_bf16 v[96:111], a[116:119], v[68:71], v[96:111]
    ds_read_b128 v[52:55], v8 offset:29184
    v_add_f32 v144, v144, v146
    v_add_f32 v145, v145, v147
    v_add_f32 v156, v156, v157
    v_mul_f32 v144, 0x3acccccd, v144
    v_mfma_f32_32x32x16_bf16 v[112:127], a[116:119], v[72:75], v[112:127]
    ds_read_b128 v[56:59], v8 offset:29696
    buffer_load_dwordx4 v6, s[20:23], s42 offen offset:1024 sc1 lds
    v_mfma_f32_32x32x16_bf16 v[128:143], a[116:119], v[76:79], v[128:143]
    ds_read_b128 v[60:63], v8 offset:30208
    v_mul_f32 v145, 0x3acccccd, v145
    v_fma_f32 v145, -v144, v144, v145
    v_max_f32 v145, 0, v145
    v_add_f32 v145, 0x3727c5ac, v145
    s_waitcnt vmcnt(12)
    s_barrier
    s_waitcnt lgkmcnt(4)
    v_mfma_f32_32x32x16_bf16 v[80:95], a[120:123], v[32:35], v[80:95]
    ds_read_b128 v[64:67], v8 offset:32768
    s_add_u32 s80, s76, 20480
    buffer_load_dwordx4 a[176:179], v249, s[72:75], s80 offen offset:0 sc1
    v_mfma_f32_32x32x16_bf16 v[96:111], a[120:123], v[36:39], v[96:111]
    ds_read_b128 v[68:71], v8 offset:33280
    v_rsq_f32 v145, v145
    s_nop 0
    v_mul_f32 v146, v144, v145
    v_mfma_f32_32x32x16_bf16 v[112:127], a[120:123], v[40:43], v[112:127]
    ds_read_b128 v[72:75], v8 offset:33792
    buffer_load_dwordx4 a[180:183], v249, s[72:75], s80 offen offset:1024 sc1
    v_mfma_f32_32x32x16_bf16 v[128:143], a[120:123], v[44:47], v[128:143]
    ds_read_b128 v[76:79], v8 offset:34304
    v_sub_f32 v146, 0, v146
    ds_write_b32 v28, v145
    ds_write_b32 v28, v146 offset:512
    ds_write_b32 v28, v156 offset:1024
    s_waitcnt lgkmcnt(7)
    v_mfma_f32_32x32x16_bf16 v[80:95], a[124:127], v[48:51], v[80:95]
    ds_read_b128 v[32:35], v8 offset:36864
    buffer_load_dwordx4 a[184:187], v249, s[72:75], s80 offen offset:2048 sc1
    v_mfma_f32_32x32x16_bf16 v[96:111], a[124:127], v[52:55], v[96:111]
    ds_read_b128 v[36:39], v8 offset:37376
    v_mfma_f32_32x32x16_bf16 v[112:127], a[124:127], v[56:59], v[112:127]
    ds_read_b128 v[40:43], v8 offset:37888
    buffer_load_dwordx4 a[188:191], v249, s[72:75], s80 offen offset:3072 sc1
    v_mfma_f32_32x32x16_bf16 v[128:143], a[124:127], v[60:63], v[128:143]
    ds_read_b128 v[44:47], v8 offset:38400
    s_waitcnt lgkmcnt(7)
    v_mfma_f32_32x32x16_bf16 v[80:95], a[128:131], v[64:67], v[80:95]
    ds_read_b128 v[48:51], v8 offset:40960
    s_add_u32 m0, s40, 81920
    s_add_u32 s42, s38, 1310720
    buffer_load_dwordx4 v6, s[20:23], s42 offen offset:0 sc1 lds
    v_mfma_f32_32x32x16_bf16 v[96:111], a[128:131], v[68:71], v[96:111]
    ds_read_b128 v[52:55], v8 offset:41472
    v_mfma_f32_32x32x16_bf16 v[112:127], a[128:131], v[72:75], v[112:127]
    ds_read_b128 v[56:59], v8 offset:41984
    buffer_load_dwordx4 v6, s[20:23], s42 offen offset:1024 sc1 lds
    v_mfma_f32_32x32x16_bf16 v[128:143], a[128:131], v[76:79], v[128:143]
    ds_read_b128 v[60:63], v8 offset:42496
    s_waitcnt lgkmcnt(4)
    v_mfma_f32_32x32x16_bf16 v[80:95], a[132:135], v[32:35], v[80:95]
    ds_read_b128 v[64:67], v8 offset:45056
    s_add_u32 m0, s40, 83968
    s_add_u32 s42, s38, 1343488
    buffer_load_dwordx4 v6, s[20:23], s42 offen offset:0 sc1 lds
    v_mfma_f32_32x32x16_bf16 v[96:111], a[132:135], v[36:39], v[96:111]
    ds_read_b128 v[68:71], v8 offset:45568
    v_mfma_f32_32x32x16_bf16 v[112:127], a[132:135], v[40:43], v[112:127]
    ds_read_b128 v[72:75], v8 offset:46080
    buffer_load_dwordx4 v6, s[20:23], s42 offen offset:1024 sc1 lds
    v_mfma_f32_32x32x16_bf16 v[128:143], a[132:135], v[44:47], v[128:143]
    ds_read_b128 v[76:79], v8 offset:46592
    s_waitcnt vmcnt(16)
    s_barrier
    s_waitcnt lgkmcnt(4)
    v_mfma_f32_32x32x16_bf16 v[80:95], a[136:139], v[48:51], v[80:95]
    ds_read_b128 v[32:35], v8 offset:49152
    s_add_u32 s80, s76, 24576
    buffer_load_dwordx4 a[192:195], v249, s[72:75], s80 offen offset:0 sc1
    v_mfma_f32_32x32x16_bf16 v[96:111], a[136:139], v[52:55], v[96:111]
    ds_read_b128 v[36:39], v8 offset:49664
    v_mfma_f32_32x32x16_bf16 v[112:127], a[136:139], v[56:59], v[112:127]
    ds_read_b128 v[40:43], v8 offset:50176
    buffer_load_dwordx4 a[196:199], v249, s[72:75], s80 offen offset:1024 sc1
    v_mfma_f32_32x32x16_bf16 v[128:143], a[136:139], v[60:63], v[128:143]
    ds_read_b128 v[44:47], v8 offset:50688
    s_waitcnt lgkmcnt(4)
    v_mfma_f32_32x32x16_bf16 v[80:95], a[140:143], v[64:67], v[80:95]
    ds_read_b128 v[48:51], v8 offset:53248
    buffer_load_dwordx4 a[200:203], v249, s[72:75], s80 offen offset:2048 sc1
    v_mfma_f32_32x32x16_bf16 v[96:111], a[140:143], v[68:71], v[96:111]
    ds_read_b128 v[52:55], v8 offset:53760
    v_mfma_f32_32x32x16_bf16 v[112:127], a[140:143], v[72:75], v[112:127]
    ds_read_b128 v[56:59], v8 offset:54272
    buffer_load_dwordx4 a[204:207], v249, s[72:75], s80 offen offset:3072 sc1
    v_mfma_f32_32x32x16_bf16 v[128:143], a[140:143], v[76:79], v[128:143]
    ds_read_b128 v[60:63], v8 offset:54784
    s_waitcnt lgkmcnt(4)
    v_mfma_f32_32x32x16_bf16 v[80:95], a[144:147], v[32:35], v[80:95]
    ds_read_b128 v[64:67], v8 offset:57344
    s_add_u32 m0, s40, 98304
    s_add_u32 s42, s38, 1572864
    buffer_load_dwordx4 v6, s[20:23], s42 offen offset:0 sc1 lds
    v_mfma_f32_32x32x16_bf16 v[96:111], a[144:147], v[36:39], v[96:111]
    ds_read_b128 v[68:71], v8 offset:57856
    v_mfma_f32_32x32x16_bf16 v[112:127], a[144:147], v[40:43], v[112:127]
    ds_read_b128 v[72:75], v8 offset:58368
    buffer_load_dwordx4 v6, s[20:23], s42 offen offset:1024 sc1 lds
    v_mfma_f32_32x32x16_bf16 v[128:143], a[144:147], v[44:47], v[128:143]
    ds_read_b128 v[76:79], v8 offset:58880
    s_waitcnt lgkmcnt(4)
    v_mfma_f32_32x32x16_bf16 v[80:95], a[148:151], v[48:51], v[80:95]
    ds_read_b128 v[32:35], v8 offset:61440
    s_add_u32 m0, s40, 100352
    s_add_u32 s42, s38, 1605632
    buffer_load_dwordx4 v6, s[20:23], s42 offen offset:0 sc1 lds
    v_mfma_f32_32x32x16_bf16 v[96:111], a[148:151], v[52:55], v[96:111]
    ds_read_b128 v[36:39], v8 offset:61952
    v_mfma_f32_32x32x16_bf16 v[112:127], a[148:151], v[56:59], v[112:127]
    ds_read_b128 v[40:43], v8 offset:62464
    buffer_load_dwordx4 v6, s[20:23], s42 offen offset:1024 sc1 lds
    v_mfma_f32_32x32x16_bf16 v[128:143], a[148:151], v[60:63], v[128:143]
    ds_read_b128 v[44:47], v8 offset:62976
    s_waitcnt vmcnt(16)
    s_barrier
    s_waitcnt lgkmcnt(4)
    v_mfma_f32_32x32x16_bf16 v[80:95], a[152:155], v[64:67], v[80:95]
    ds_read_b128 v[48:51], v9 offset:0
    s_add_u32 s80, s76, 28672
    buffer_load_dwordx4 a[208:211], v249, s[72:75], s80 offen offset:0 sc1
    v_mfma_f32_32x32x16_bf16 v[96:111], a[152:155], v[68:71], v[96:111]
    ds_read_b128 v[52:55], v9 offset:512
    v_mfma_f32_32x32x16_bf16 v[112:127], a[152:155], v[72:75], v[112:127]
    ds_read_b128 v[56:59], v9 offset:1024
    buffer_load_dwordx4 a[212:215], v249, s[72:75], s80 offen offset:1024 sc1
    v_mfma_f32_32x32x16_bf16 v[128:143], a[152:155], v[76:79], v[128:143]
    ds_read_b128 v[60:63], v9 offset:1536
    s_waitcnt lgkmcnt(4)
    v_mfma_f32_32x32x16_bf16 v[80:95], a[156:159], v[32:35], v[80:95]
    ds_read_b128 v[64:67], v9 offset:4096
    buffer_load_dwordx4 a[216:219], v249, s[72:75], s80 offen offset:2048 sc1
    v_mfma_f32_32x32x16_bf16 v[96:111], a[156:159], v[36:39], v[96:111]
    ds_read_b128 v[68:71], v9 offset:4608
    ds_read_b32 v144, v29 offset:0
    ds_read_b32 v145, v29 offset:512
    ds_read_b32 v146, v29 offset:128
    ds_read_b32 v147, v29 offset:640
    v_mfma_f32_32x32x16_bf16 v[112:127], a[156:159], v[40:43], v[112:127]
    ds_read_b128 v[72:75], v9 offset:5120
    buffer_load_dwordx4 a[220:223], v249, s[72:75], s80 offen offset:3072 sc1
    v_mfma_f32_32x32x16_bf16 v[128:143], a[156:159], v[44:47], v[128:143]
    ds_read_b128 v[76:79], v9 offset:5632
    ds_read_b32 v148, v29 offset:256
    ds_read_b32 v149, v29 offset:768
    ds_read_b32 v150, v29 offset:384
    ds_read_b32 v151, v29 offset:896
    s_waitcnt lgkmcnt(12)
    v_mfma_f32_32x32x16_bf16 v[80:95], a[160:163], v[48:51], v[80:95]
    ds_read_b128 v[32:35], v9 offset:8192
    s_add_u32 m0, s40, 114688
    s_add_u32 s42, s38, 1835008
    buffer_load_dwordx4 v6, s[20:23], s42 offen offset:0 sc1 lds
    v_mfma_f32_32x32x16_bf16 v[96:111], a[160:163], v[52:55], v[96:111]
    ds_read_b128 v[36:39], v9 offset:8704
    ds_read_b128 v[152:155], v30 offset:0
    ds_read_b128 v[156:159], v30 offset:32
    ds_read_b128 v[160:163], v30 offset:64
    ds_read_b128 v[164:167], v30 offset:96
    v_mfma_f32_32x32x16_bf16 v[112:127], a[160:163], v[56:59], v[112:127]
    ds_read_b128 v[40:43], v9 offset:9216
    buffer_load_dwordx4 v6, s[20:23], s42 offen offset:1024 sc1 lds
    v_mfma_f32_32x32x16_bf16 v[128:143], a[160:163], v[60:63], v[128:143]
    ds_read_b128 v[44:47], v9 offset:9728
    s_waitcnt lgkmcnt(12)
    v_mfma_f32_32x32x16_bf16 v[80:95], a[164:167], v[64:67], v[80:95]
    ds_read_b128 v[48:51], v9 offset:12288
    s_add_u32 m0, s40, 116736
    s_add_u32 s42, s38, 1867776
    buffer_load_dwordx4 v6, s[20:23], s42 offen offset:0 sc1 lds
    v_mfma_f32_32x32x16_bf16 v[96:111], a[164:167], v[68:71], v[96:111]
    ds_read_b128 v[52:55], v9 offset:12800
    s_waitcnt lgkmcnt(4)
    v_mul_f32 v144, s46, v144
    v_mul_f32 v145, s46, v145
    v_mul_f32 v146, s46, v146
    v_mfma_f32_32x32x16_bf16 v[112:127], a[164:167], v[72:75], v[112:127]
    ds_read_b128 v[56:59], v9 offset:13312
    buffer_load_dwordx4 v6, s[20:23], s42 offen offset:1024 sc1 lds
    v_mfma_f32_32x32x16_bf16 v[128:143], a[164:167], v[76:79], v[128:143]
    ds_read_b128 v[60:63], v9 offset:13824
    v_mul_f32 v147, s46, v147
    v_mul_f32 v148, s46, v148
    v_mul_f32 v149, s46, v149
    v_mul_f32 v150, s46, v150
    s_waitcnt vmcnt(16)
    s_barrier
    s_waitcnt lgkmcnt(4)
    v_mfma_f32_32x32x16_bf16 v[80:95], a[168:171], v[32:35], v[80:95]
    ds_read_b128 v[64:67], v9 offset:16384
    s_add_u32 s80, s76, 32768
    buffer_load_dwordx4 a[224:227], v249, s[72:75], s80 offen offset:0 sc1
    v_mfma_f32_32x32x16_bf16 v[96:111], a[168:171], v[36:39], v[96:111]
    ds_read_b128 v[68:71], v9 offset:16896
    v_mul_f32 v151, s46, v151
    v_mfma_f32_32x32x16_bf16 v[112:127], a[168:171], v[40:43], v[112:127]
    ds_read_b128 v[72:75], v9 offset:17408
    buffer_load_dwordx4 a[228:231], v249, s[72:75], s80 offen offset:1024 sc1
    v_mfma_f32_32x32x16_bf16 v[128:143], a[168:171], v[44:47], v[128:143]
    ds_read_b128 v[76:79], v9 offset:17920
    s_waitcnt lgkmcnt(4)
    v_mfma_f32_32x32x16_bf16 v[80:95], a[172:175], v[48:51], v[80:95]
    ds_read_b128 v[32:35], v9 offset:20480
    buffer_load_dwordx4 a[232:235], v249, s[72:75], s80 offen offset:2048 sc1
    v_mfma_f32_32x32x16_bf16 v[96:111], a[172:175], v[52:55], v[96:111]
    ds_read_b128 v[36:39], v9 offset:20992
    v_mfma_f32_32x32x16_bf16 v[112:127], a[172:175], v[56:59], v[112:127]
    ds_read_b128 v[40:43], v9 offset:21504
    buffer_load_dwordx4 a[236:239], v249, s[72:75], s80 offen offset:3072 sc1
    v_mfma_f32_32x32x16_bf16 v[128:143], a[172:175], v[60:63], v[128:143]
    ds_read_b128 v[44:47], v9 offset:22016
    s_waitcnt lgkmcnt(4)
    v_mfma_f32_32x32x16_bf16 v[80:95], a[176:179], v[64:67], v[80:95]
    ds_read_b128 v[48:51], v9 offset:24576
    s_add_u32 m0, s40, 131072
    s_add_u32 s42, s38, 2097152
    buffer_load_dwordx4 v6, s[20:23], s42 offen offset:0 sc1 lds
    v_mfma_f32_32x32x16_bf16 v[96:111], a[176:179], v[68:71], v[96:111]
    ds_read_b128 v[52:55], v9 offset:25088
    v_mfma_f32_32x32x16_bf16 v[112:127], a[176:179], v[72:75], v[112:127]
    ds_read_b128 v[56:59], v9 offset:25600
    buffer_load_dwordx4 v6, s[20:23], s42 offen offset:1024 sc1 lds
    v_mfma_f32_32x32x16_bf16 v[128:143], a[176:179], v[76:79], v[128:143]
    ds_read_b128 v[60:63], v9 offset:26112
    s_waitcnt lgkmcnt(4)
    v_mfma_f32_32x32x16_bf16 v[80:95], a[180:183], v[32:35], v[80:95]
    ds_read_b128 v[64:67], v9 offset:28672
    s_add_u32 m0, s40, 133120
    s_add_u32 s42, s38, 2129920
    buffer_load_dwordx4 v6, s[20:23], s42 offen offset:0 sc1 lds
    v_mfma_f32_32x32x16_bf16 v[96:111], a[180:183], v[36:39], v[96:111]
    ds_read_b128 v[68:71], v9 offset:29184
    v_mfma_f32_32x32x16_bf16 v[112:127], a[180:183], v[40:43], v[112:127]
    ds_read_b128 v[72:75], v9 offset:29696
    buffer_load_dwordx4 v6, s[20:23], s42 offen offset:1024 sc1 lds
    v_mfma_f32_32x32x16_bf16 v[128:143], a[180:183], v[44:47], v[128:143]
    ds_read_b128 v[76:79], v9 offset:30208
    s_waitcnt vmcnt(16)
    s_barrier
    s_waitcnt lgkmcnt(4)
    v_mfma_f32_32x32x16_bf16 v[80:95], a[184:187], v[48:51], v[80:95]
    ds_read_b128 v[32:35], v9 offset:32768
    s_add_u32 s80, s76, 36864
    buffer_load_dwordx4 a[240:243], v249, s[72:75], s80 offen offset:0 sc1
    v_mfma_f32_32x32x16_bf16 v[96:111], a[184:187], v[52:55], v[96:111]
    ds_read_b128 v[36:39], v9 offset:33280
    v_mfma_f32_32x32x16_bf16 v[112:127], a[184:187], v[56:59], v[112:127]
    ds_read_b128 v[40:43], v9 offset:33792
    buffer_load_dwordx4 a[244:247], v249, s[72:75], s80 offen offset:1024 sc1
    v_mfma_f32_32x32x16_bf16 v[128:143], a[184:187], v[60:63], v[128:143]
    ds_read_b128 v[44:47], v9 offset:34304
    s_waitcnt lgkmcnt(4)
    v_mfma_f32_32x32x16_bf16 v[80:95], a[188:191], v[64:67], v[80:95]
    ds_read_b128 v[48:51], v9 offset:36864
    buffer_load_dwordx4 a[248:251], v249, s[72:75], s80 offen offset:2048 sc1
    v_mfma_f32_32x32x16_bf16 v[96:111], a[188:191], v[68:71], v[96:111]
    ds_read_b128 v[52:55], v9 offset:37376
    v_mfma_f32_32x32x16_bf16 v[112:127], a[188:191], v[72:75], v[112:127]
    ds_read_b128 v[56:59], v9 offset:37888
    buffer_load_dwordx4 a[252:255], v249, s[72:75], s80 offen offset:3072 sc1
    v_mfma_f32_32x32x16_bf16 v[128:143], a[188:191], v[76:79], v[128:143]
    ds_read_b128 v[60:63], v9 offset:38400
    s_waitcnt lgkmcnt(4)
    v_mfma_f32_32x32x16_bf16 v[80:95], a[192:195], v[32:35], v[80:95]
    ds_read_b128 v[64:67], v9 offset:40960
    s_add_u32 m0, s40, 0
    s_add_u32 s42, s38, 2359296
    buffer_load_dwordx4 v6, s[20:23], s42 offen offset:0 sc1 lds
    v_mfma_f32_32x32x16_bf16 v[96:111], a[192:195], v[36:39], v[96:111]
    ds_read_b128 v[68:71], v9 offset:41472
    v_mfma_f32_32x32x16_bf16 v[112:127], a[192:195], v[40:43], v[112:127]
    ds_read_b128 v[72:75], v9 offset:41984
    buffer_load_dwordx4 v6, s[20:23], s42 offen offset:1024 sc1 lds
    v_mfma_f32_32x32x16_bf16 v[128:143], a[192:195], v[44:47], v[128:143]
    ds_read_b128 v[76:79], v9 offset:42496
    s_waitcnt lgkmcnt(4)
    v_mfma_f32_32x32x16_bf16 v[80:95], a[196:199], v[48:51], v[80:95]
    ds_read_b128 v[32:35], v9 offset:45056
    s_add_u32 m0, s40, 2048
    s_add_u32 s42, s38, 2392064
    buffer_load_dwordx4 v6, s[20:23], s42 offen offset:0 sc1 lds
    v_mfma_f32_32x32x16_bf16 v[96:111], a[196:199], v[52:55], v[96:111]
    ds_read_b128 v[36:39], v9 offset:45568
    v_mfma_f32_32x32x16_bf16 v[112:127], a[196:199], v[56:59], v[112:127]
    ds_read_b128 v[40:43], v9 offset:46080
    buffer_load_dwordx4 v6, s[20:23], s42 offen offset:1024 sc1 lds
    v_mfma_f32_32x32x16_bf16 v[128:143], a[196:199], v[60:63], v[128:143]
    ds_read_b128 v[44:47], v9 offset:46592
    s_waitcnt vmcnt(16)
    s_barrier
    s_waitcnt lgkmcnt(4)
    v_mfma_f32_32x32x16_bf16 v[80:95], a[200:203], v[64:67], v[80:95]
    ds_read_b128 v[48:51], v9 offset:49152
    v_mfma_f32_32x32x16_bf16 v[96:111], a[200:203], v[68:71], v[96:111]
    ds_read_b128 v[52:55], v9 offset:49664
    v_mfma_f32_32x32x16_bf16 v[112:127], a[200:203], v[72:75], v[112:127]
    ds_read_b128 v[56:59], v9 offset:50176
    v_mfma_f32_32x32x16_bf16 v[128:143], a[200:203], v[76:79], v[128:143]
    ds_read_b128 v[60:63], v9 offset:50688
    s_waitcnt lgkmcnt(4)
    v_mfma_f32_32x32x16_bf16 v[80:95], a[204:207], v[32:35], v[80:95]
    ds_read_b128 v[64:67], v9 offset:53248
    v_mfma_f32_32x32x16_bf16 v[96:111], a[204:207], v[36:39], v[96:111]
    ds_read_b128 v[68:71], v9 offset:53760
    v_mfma_f32_32x32x16_bf16 v[112:127], a[204:207], v[40:43], v[112:127]
    ds_read_b128 v[72:75], v9 offset:54272
    v_mfma_f32_32x32x16_bf16 v[128:143], a[204:207], v[44:47], v[128:143]
    ds_read_b128 v[76:79], v9 offset:54784
    s_waitcnt lgkmcnt(4)
    v_mfma_f32_32x32x16_bf16 v[80:95], a[208:211], v[48:51], v[80:95]
    ds_read_b128 v[32:35], v9 offset:57344
    v_mfma_f32_32x32x16_bf16 v[96:111], a[208:211], v[52:55], v[96:111]
    ds_read_b128 v[36:39], v9 offset:57856
    v_mfma_f32_32x32x16_bf16 v[112:127], a[208:211], v[56:59], v[112:127]
    ds_read_b128 v[40:43], v9 offset:58368
    v_mfma_f32_32x32x16_bf16 v[128:143], a[208:211], v[60:63], v[128:143]
    ds_read_b128 v[44:47], v9 offset:58880
    s_waitcnt lgkmcnt(4)
    v_mfma_f32_32x32x16_bf16 v[80:95], a[212:215], v[64:67], v[80:95]
    ds_read_b128 v[48:51], v9 offset:61440
    v_mfma_f32_32x32x16_bf16 v[96:111], a[212:215], v[68:71], v[96:111]
    ds_read_b128 v[52:55], v9 offset:61952
    v_mfma_f32_32x32x16_bf16 v[112:127], a[212:215], v[72:75], v[112:127]
    ds_read_b128 v[56:59], v9 offset:62464
    v_mfma_f32_32x32x16_bf16 v[128:143], a[212:215], v[76:79], v[128:143]
    ds_read_b128 v[60:63], v9 offset:62976
    s_waitcnt vmcnt(8)
    s_barrier
    s_waitcnt lgkmcnt(4)
    v_mfma_f32_32x32x16_bf16 v[80:95], a[216:219], v[32:35], v[80:95]
    ds_read_b128 v[64:67], v10 offset:0
    v_mfma_f32_32x32x16_bf16 v[96:111], a[216:219], v[36:39], v[96:111]
    ds_read_b128 v[68:71], v10 offset:4096
    v_mfma_f32_32x32x16_bf16 v[112:127], a[216:219], v[40:43], v[112:127]
    ds_read_b128 v[72:75], v10 offset:8192
    v_mfma_f32_32x32x16_bf16 v[128:143], a[216:219], v[44:47], v[128:143]
    ds_read_b128 v[76:79], v10 offset:12288
    s_waitcnt vmcnt(0)
    s_barrier
    s_waitcnt lgkmcnt(4)
    v_mfma_f32_32x32x16_bf16 v[80:95], a[220:223], v[48:51], v[80:95]
    ds_read_b128 v[32:35], v8 offset:0
    v_mfma_f32_32x32x16_bf16 v[96:111], a[220:223], v[52:55], v[96:111]
    ds_read_b128 v[36:39], v8 offset:4096
    v_mfma_f32_32x32x16_bf16 v[112:127], a[220:223], v[56:59], v[112:127]
    ds_read_b128 v[40:43], v8 offset:8192
    v_mfma_f32_32x32x16_bf16 v[128:143], a[220:223], v[60:63], v[128:143]
    ds_read_b128 v[44:47], v8 offset:12288
    s_waitcnt lgkmcnt(4)
    v_mfma_f32_32x32x16_bf16 v[80:95], a[224:227], v[64:67], v[80:95]
    ds_read_b128 v[48:51], v10 offset:512
    v_mfma_f32_32x32x16_bf16 v[80:95], a[228:231], v[68:71], v[80:95]
    ds_read_b128 v[52:55], v10 offset:4608
    v_mfma_f32_32x32x16_bf16 v[80:95], a[232:235], v[72:75], v[80:95]
    ds_read_b128 v[56:59], v10 offset:8704
    v_mfma_f32_32x32x16_bf16 v[80:95], a[236:239], v[76:79], v[80:95]
    ds_read_b128 v[60:63], v10 offset:12800
    s_waitcnt lgkmcnt(4)
    v_mfma_f32_32x32x16_bf16 v[80:95], a[240:243], v[32:35], v[80:95]
    ds_read_b128 v[64:67], v8 offset:512
    v_mfma_f32_32x32x16_bf16 v[80:95], a[244:247], v[36:39], v[80:95]
    ds_read_b128 v[68:71], v8 offset:4608
    v_mfma_f32_32x32x16_bf16 v[80:95], a[248:251], v[40:43], v[80:95]
    ds_read_b128 v[72:75], v8 offset:8704
    v_mfma_f32_32x32x16_bf16 v[80:95], a[252:255], v[44:47], v[80:95]
    ds_read_b128 v[76:79], v8 offset:12800
    s_waitcnt lgkmcnt(4)
    v_mfma_f32_32x32x16_bf16 v[96:111], a[224:227], v[48:51], v[96:111]
    ds_read_b128 v[32:35], v10 offset:1024
    v_mul_f32 v176, v152, v145
    v_mul_f32 v177, v153, v145
    v_mul_f32 v178, v154, v145
    v_mul_f32 v179, v155, v145
    v_mul_f32 v180, v156, v145
    v_mul_f32 v181, v157, v145
    v_mul_f32 v182, v158, v145
    v_mul_f32 v183, v159, v145
    v_mfma_f32_32x32x16_bf16 v[96:111], a[228:231], v[52:55], v[96:111]
    ds_read_b128 v[36:39], v10 offset:5120
    v_fmac_f32 v176, v80, v144
    v_fmac_f32 v177, v81, v144
    v_fmac_f32 v178, v82, v144
    v_fmac_f32 v179, v83, v144
    v_fmac_f32 v180, v84, v144
    v_fmac_f32 v181, v85, v144
    v_fmac_f32 v182, v86, v144
    v_fmac_f32 v183, v87, v144
    v_mfma_f32_32x32x16_bf16 v[96:111], a[232:235], v[56:59], v[96:111]
    ds_read_b128 v[40:43], v10 offset:9216
    v_cvt_pk_bf16_f32 v192, v176, v177
    v_cvt_pk_bf16_f32 v193, v178, v179
    v_cvt_pk_bf16_f32 v194, v180, v181
    v_cvt_pk_bf16_f32 v195, v182, v183
    buffer_store_dwordx4 v[192:195], v168, s[48:51], 0 offen sc1
    v_mfma_f32_32x32x16_bf16 v[96:111], a[236:239], v[60:63], v[96:111]
    ds_read_b128 v[44:47], v10 offset:13312
    v_add_u32 v168, v168, v169
    v_mul_f32 v176, v160, v145
    v_mul_f32 v177, v161, v145
    v_mul_f32 v178, v162, v145
    v_mul_f32 v179, v163, v145
    v_mul_f32 v180, v164, v145
    v_mul_f32 v181, v165, v145
    v_mul_f32 v182, v166, v145
    s_waitcnt lgkmcnt(4)
    v_mfma_f32_32x32x16_bf16 v[96:111], a[240:243], v[64:67], v[96:111]
    ds_read_b128 v[48:51], v8 offset:1024
    v_mul_f32 v183, v167, v145
    v_fmac_f32 v176, v88, v144
    v_fmac_f32 v177, v89, v144
    v_fmac_f32 v178, v90, v144
    v_fmac_f32 v179, v91, v144
    v_fmac_f32 v180, v92, v144
    v_fmac_f32 v181, v93, v144
    v_fmac_f32 v182, v94, v144
    v_mfma_f32_32x32x16_bf16 v[96:111], a[244:247], v[68:71], v[96:111]
    ds_read_b128 v[52:55], v8 offset:5120
    v_fmac_f32 v183, v95, v144
    v_cvt_pk_bf16_f32 v196, v176, v177
    v_cvt_pk_bf16_f32 v197, v178, v179
    v_cvt_pk_bf16_f32 v198, v180, v181
    v_cvt_pk_bf16_f32 v199, v182, v183
    buffer_store_dwordx4 v[196:199], v170, s[48:51], 0 offen sc1
    v_mfma_f32_32x32x16_bf16 v[96:111], a[248:251], v[72:75], v[96:111]
    ds_read_b128 v[56:59], v8 offset:9216
    v_add_u32 v170, v170, v171
    v_mfma_f32_32x32x16_bf16 v[96:111], a[252:255], v[76:79], v[96:111]
    ds_read_b128 v[60:63], v8 offset:13312
    s_waitcnt lgkmcnt(4)
    v_mfma_f32_32x32x16_bf16 v[112:127], a[224:227], v[32:35], v[112:127]
    ds_read_b128 v[64:67], v10 offset:1536
    v_mul_f32 v176, v152, v147
    v_mul_f32 v177, v153, v147
    v_mul_f32 v178, v154, v147
    v_mul_f32 v179, v155, v147
    v_mul_f32 v180, v156, v147
    v_mul_f32 v181, v157, v147
    v_mul_f32 v182, v158, v147
    v_mul_f32 v183, v159, v147
    v_mfma_f32_32x32x16_bf16 v[112:127], a[228:231], v[36:39], v[112:127]
    ds_read_b128 v[68:71], v10 offset:5632
    v_fmac_f32 v176, v96, v146
    v_fmac_f32 v177, v97, v146
    v_fmac_f32 v178, v98, v146
    v_fmac_f32 v179, v99, v146
    v_fmac_f32 v180, v100, v146
    v_fmac_f32 v181, v101, v146
    v_fmac_f32 v182, v102, v146
    v_fmac_f32 v183, v103, v146
    v_mfma_f32_32x32x16_bf16 v[112:127], a[232:235], v[40:43], v[112:127]
    ds_read_b128 v[72:75], v10 offset:9728
    v_cvt_pk_bf16_f32 v192, v176, v177
    v_cvt_pk_bf16_f32 v193, v178, v179
    v_cvt_pk_bf16_f32 v194, v180, v181
    v_cvt_pk_bf16_f32 v195, v182, v183
    buffer_store_dwordx4 v[192:195], v168, s[48:51], 0 offen sc1
    v_mfma_f32_32x32x16_bf16 v[112:127], a[236:239], v[44:47], v[112:127]
    ds_read_b128 v[76:79], v10 offset:13824
    v_add_u32 v168, v168, v169
    v_mul_f32 v176, v160, v147
    v_mul_f32 v177, v161, v147
    v_mul_f32 v178, v162, v147
    v_mul_f32 v179, v163, v147
    v_mul_f32 v180, v164, v147
    v_mul_f32 v181, v165, v147
    v_mul_f32 v182, v166, v147
    s_waitcnt lgkmcnt(4)
    v_mfma_f32_32x32x16_bf16 v[112:127], a[240:243], v[48:51], v[112:127]
    ds_read_b128 v[32:35], v8 offset:1536
    v_mul_f32 v183, v167, v147
    v_fmac_f32 v176, v104, v146
    v_fmac_f32 v177, v105, v146
    v_fmac_f32 v178, v106, v146
    v_fmac_f32 v179, v107, v146
    v_fmac_f32 v180, v108, v146
    v_fmac_f32 v181, v109, v146
    v_fmac_f32 v182, v110, v146
    v_mfma_f32_32x32x16_bf16 v[112:127], a[244:247], v[52:55], v[112:127]
    ds_read_b128 v[36:39], v8 offset:5632
    v_fmac_f32 v183, v111, v146
    v_cvt_pk_bf16_f32 v196, v176, v177
    v_cvt_pk_bf16_f32 v197, v178, v179
    v_cvt_pk_bf16_f32 v198, v180, v181
    v_cvt_pk_bf16_f32 v199, v182, v183
    buffer_store_dwordx4 v[196:199], v170, s[48:51], 0 offen sc1
    v_mfma_f32_32x32x16_bf16 v[112:127], a[248:251], v[56:59], v[112:127]
    ds_read_b128 v[40:43], v8 offset:9728
    v_add_u32 v170, v170, v171
    v_mfma_f32_32x32x16_bf16 v[112:127], a[252:255], v[60:63], v[112:127]
    ds_read_b128 v[44:47], v8 offset:13824
    s_waitcnt lgkmcnt(4)
    v_mfma_f32_32x32x16_bf16 v[128:143], a[224:227], v[64:67], v[128:143]
    v_mul_f32 v176, v152, v149
    v_mul_f32 v177, v153, v149
    v_mul_f32 v178, v154, v149
    v_mul_f32 v179, v155, v149
    v_mul_f32 v180, v156, v149
    v_mul_f32 v181, v157, v149
    v_mul_f32 v182, v158, v149
    v_mul_f32 v183, v159, v149
    v_mfma_f32_32x32x16_bf16 v[128:143], a[228:231], v[68:71], v[128:143]
    v_fmac_f32 v176, v112, v148
    v_fmac_f32 v177, v113, v148
    v_fmac_f32 v178, v114, v148
    v_fmac_f32 v179, v115, v148
    v_fmac_f32 v180, v116, v148
    v_fmac_f32 v181, v117, v148
    v_fmac_f32 v182, v118, v148
    v_fmac_f32 v183, v119, v148
    v_mfma_f32_32x32x16_bf16 v[128:143], a[232:235], v[72:75], v[128:143]
    v_cvt_pk_bf16_f32 v192, v176, v177
    v_cvt_pk_bf16_f32 v193, v178, v179
    v_cvt_pk_bf16_f32 v194, v180, v181
    v_cvt_pk_bf16_f32 v195, v182, v183
    buffer_store_dwordx4 v[192:195], v168, s[48:51], 0 offen sc1
    v_mfma_f32_32x32x16_bf16 v[128:143], a[236:239], v[76:79], v[128:143]
    v_add_u32 v168, v168, v169
    v_mul_f32 v176, v160, v149
    v_mul_f32 v177, v161, v149
    v_mul_f32 v178, v162, v149
    v_mul_f32 v179, v163, v149
    v_mul_f32 v180, v164, v149
    v_mul_f32 v181, v165, v149
    v_mul_f32 v182, v166, v149
    s_waitcnt lgkmcnt(0)
    v_mfma_f32_32x32x16_bf16 v[128:143], a[240:243], v[32:35], v[128:143]
    v_mul_f32 v183, v167, v149
    v_fmac_f32 v176, v120, v148
    v_fmac_f32 v177, v121, v148
    v_fmac_f32 v178, v122, v148
    v_fmac_f32 v179, v123, v148
    v_fmac_f32 v180, v124, v148
    v_fmac_f32 v181, v125, v148
    v_fmac_f32 v182, v126, v148
    v_mfma_f32_32x32x16_bf16 v[128:143], a[244:247], v[36:39], v[128:143]
    v_fmac_f32 v183, v127, v148
    v_cvt_pk_bf16_f32 v196, v176, v177
    v_cvt_pk_bf16_f32 v197, v178, v179
    v_cvt_pk_bf16_f32 v198, v180, v181
    v_cvt_pk_bf16_f32 v199, v182, v183
    buffer_store_dwordx4 v[196:199], v170, s[48:51], 0 offen sc1
    v_mfma_f32_32x32x16_bf16 v[128:143], a[248:251], v[40:43], v[128:143]
    v_add_u32 v170, v170, v171
    v_mfma_f32_32x32x16_bf16 v[128:143], a[252:255], v[44:47], v[128:143]
    v_pk_mul_f32 v[176:177], v[152:153], v[150:151] op_sel:[0,1] op_sel_hi:[1,1]
    v_pk_mul_f32 v[178:179], v[154:155], v[150:151] op_sel:[0,1] op_sel_hi:[1,1]
    v_pk_mul_f32 v[180:181], v[156:157], v[150:151] op_sel:[0,1] op_sel_hi:[1,1]
    v_pk_mul_f32 v[182:183], v[158:159], v[150:151] op_sel:[0,1] op_sel_hi:[1,1]
    s_nop 7
    v_pk_fma_f32 v[176:177], v[128:129], v[150:151], v[176:177] op_sel_hi:[1,0,1]
    v_pk_fma_f32 v[178:179], v[130:131], v[150:151], v[178:179] op_sel_hi:[1,0,1]
    v_pk_fma_f32 v[180:181], v[132:133], v[150:151], v[180:181] op_sel_hi:[1,0,1]
    v_pk_fma_f32 v[182:183], v[134:135], v[150:151], v[182:183] op_sel_hi:[1,0,1]
    v_cvt_pk_bf16_f32 v192, v176, v177
    v_cvt_pk_bf16_f32 v193, v178, v179
    v_cvt_pk_bf16_f32 v194, v180, v181
    v_cvt_pk_bf16_f32 v195, v182, v183
    buffer_store_dwordx4 v[192:195], v168, s[48:51], 0 offen sc1
    v_pk_mul_f32 v[176:177], v[160:161], v[150:151] op_sel:[0,1] op_sel_hi:[1,1]
    v_pk_mul_f32 v[178:179], v[162:163], v[150:151] op_sel:[0,1] op_sel_hi:[1,1]
    v_pk_mul_f32 v[180:181], v[164:165], v[150:151] op_sel:[0,1] op_sel_hi:[1,1]
    v_pk_mul_f32 v[182:183], v[166:167], v[150:151] op_sel:[0,1] op_sel_hi:[1,1]
    v_pk_fma_f32 v[176:177], v[136:137], v[150:151], v[176:177] op_sel_hi:[1,0,1]
    v_pk_fma_f32 v[178:179], v[138:139], v[150:151], v[178:179] op_sel_hi:[1,0,1]
    v_pk_fma_f32 v[180:181], v[140:141], v[150:151], v[180:181] op_sel_hi:[1,0,1]
    v_pk_fma_f32 v[182:183], v[142:143], v[150:151], v[182:183] op_sel_hi:[1,0,1]
    v_cvt_pk_bf16_f32 v196, v176, v177
    v_cvt_pk_bf16_f32 v197, v178, v179
    v_cvt_pk_bf16_f32 v198, v180, v181
    v_cvt_pk_bf16_f32 v199, v182, v183
    buffer_store_dwordx4 v[196:199], v170, s[48:51], 0 offen sc1
    s_branch interleave_layers__mha_block__dense_activation_silu__prompt_kernel_qkv_fin
interleave_layers__mha_block__dense_activation_silu__prompt_kernel_qkv_loop_c:
    ds_read_b128 v[32:35], v8 offset:0
    ds_read_b128 v[36:39], v8 offset:512
    ds_read_b128 v[40:43], v8 offset:1024
    ds_read_b128 v[44:47], v8 offset:1536
    ds_read_b128 v[48:51], v8 offset:4096
    ds_read_b128 v[52:55], v8 offset:4608
    ds_read_b128 v[56:59], v8 offset:5120
    ds_read_b128 v[60:63], v8 offset:5632
    s_waitcnt lgkmcnt(4)
    v_mfma_f32_32x32x16_bf16 v[80:95], v[32:35], a[96:99], 0
    ds_read_b128 v[64:67], v8 offset:8192
    s_add_u32 m0, s40, 49152
    s_add_u32 s42, s38, 786432
    buffer_load_dwordx4 v6, s[20:23], s42 offen offset:0 sc1 lds
    v_mfma_f32_32x32x16_bf16 v[96:111], v[36:39], a[96:99], 0
    ds_read_b128 v[68:71], v8 offset:8704
    v_mfma_f32_32x32x16_bf16 v[112:127], v[40:43], a[96:99], 0
    ds_read_b128 v[72:75], v8 offset:9216
    buffer_load_dwordx4 v6, s[20:23], s42 offen offset:1024 sc1 lds
    v_mfma_f32_32x32x16_bf16 v[128:143], v[44:47], a[96:99], 0
    ds_read_b128 v[76:79], v8 offset:9728
    s_waitcnt lgkmcnt(4)
    v_mfma_f32_32x32x16_bf16 v[80:95], v[48:51], a[100:103], v[80:95]
    ds_read_b128 v[32:35], v8 offset:12288
    s_add_u32 m0, s40, 51200
    s_add_u32 s42, s38, 819200
    buffer_load_dwordx4 v6, s[20:23], s42 offen offset:0 sc1 lds
    v_mfma_f32_32x32x16_bf16 v[96:111], v[52:55], a[100:103], v[96:111]
    ds_read_b128 v[36:39], v8 offset:12800
    v_mfma_f32_32x32x16_bf16 v[112:127], v[56:59], a[100:103], v[112:127]
    ds_read_b128 v[40:43], v8 offset:13312
    buffer_load_dwordx4 v6, s[20:23], s42 offen offset:1024 sc1 lds
    v_mfma_f32_32x32x16_bf16 v[128:143], v[60:63], a[100:103], v[128:143]
    ds_read_b128 v[44:47], v8 offset:13824
    s_waitcnt vmcnt(8)
    s_barrier
    s_waitcnt lgkmcnt(4)
    v_mfma_f32_32x32x16_bf16 v[80:95], v[64:67], a[104:107], v[80:95]
    ds_read_b128 v[48:51], v8 offset:16384
    s_add_u32 s80, s76, 16384
    buffer_load_dwordx4 a[160:163], v249, s[72:75], s80 offen offset:0 sc1
    v_mfma_f32_32x32x16_bf16 v[96:111], v[68:71], a[104:107], v[96:111]
    ds_read_b128 v[52:55], v8 offset:16896
    v_mfma_f32_32x32x16_bf16 v[112:127], v[72:75], a[104:107], v[112:127]
    ds_read_b128 v[56:59], v8 offset:17408
    buffer_load_dwordx4 a[164:167], v249, s[72:75], s80 offen offset:1024 sc1
    v_mfma_f32_32x32x16_bf16 v[128:143], v[76:79], a[104:107], v[128:143]
    ds_read_b128 v[60:63], v8 offset:17920
    s_waitcnt lgkmcnt(4)
    v_mfma_f32_32x32x16_bf16 v[80:95], v[32:35], a[108:111], v[80:95]
    ds_read_b128 v[64:67], v8 offset:20480
    buffer_load_dwordx4 a[168:171], v249, s[72:75], s80 offen offset:2048 sc1
    v_mfma_f32_32x32x16_bf16 v[96:111], v[36:39], a[108:111], v[96:111]
    ds_read_b128 v[68:71], v8 offset:20992
    v_add_f32 v144, v144, v146
    v_add_f32 v145, v145, v147
    v_add_f32 v148, v148, v150
    v_add_f32 v149, v149, v151
    v_mfma_f32_32x32x16_bf16 v[112:127], v[40:43], a[108:111], v[112:127]
    ds_read_b128 v[72:75], v8 offset:21504
    buffer_load_dwordx4 a[172:175], v249, s[72:75], s80 offen offset:3072 sc1
    v_mfma_f32_32x32x16_bf16 v[128:143], v[44:47], a[108:111], v[128:143]
    ds_read_b128 v[76:79], v8 offset:22016
    v_add_f32 v144, v144, v148
    v_add_f32 v145, v145, v149
    v_add_f32 v152, v152, v153
    v_add_f32 v154, v154, v155
    s_waitcnt lgkmcnt(4)
    v_mfma_f32_32x32x16_bf16 v[80:95], v[48:51], a[112:115], v[80:95]
    ds_read_b128 v[32:35], v8 offset:24576
    s_add_u32 m0, s40, 65536
    s_add_u32 s42, s38, 1048576
    buffer_load_dwordx4 v6, s[20:23], s42 offen offset:0 sc1 lds
    v_mfma_f32_32x32x16_bf16 v[96:111], v[52:55], a[112:115], v[96:111]
    ds_read_b128 v[36:39], v8 offset:25088
    v_mov_b32 v146, v144
    v_mov_b32 v147, v145
    v_add_f32 v156, v152, v154
    v_add_f32 v157, v152, v154
    v_mfma_f32_32x32x16_bf16 v[112:127], v[56:59], a[112:115], v[112:127]
    ds_read_b128 v[40:43], v8 offset:25600
    buffer_load_dwordx4 v6, s[20:23], s42 offen offset:1024 sc1 lds
    v_mfma_f32_32x32x16_bf16 v[128:143], v[60:63], a[112:115], v[128:143]
    ds_read_b128 v[44:47], v8 offset:26112
    s_nop 0
    v_permlane32_swap_b32 v144, v146
    v_permlane32_swap_b32 v145, v147
    v_permlane32_swap_b32 v156, v157
    s_waitcnt lgkmcnt(4)
    v_mfma_f32_32x32x16_bf16 v[80:95], v[64:67], a[116:119], v[80:95]
    ds_read_b128 v[48:51], v8 offset:28672
    s_add_u32 m0, s40, 67584
    s_add_u32 s42, s38, 1081344
    buffer_load_dwordx4 v6, s[20:23], s42 offen offset:0 sc1 lds
    v_mfma_f32_32x32x16_bf16 v[96:111], v[68:71], a[116:119], v[96:111]
    ds_read_b128 v[52:55], v8 offset:29184
    v_add_f32 v144, v144, v146
    v_add_f32 v145, v145, v147
    v_add_f32 v156, v156, v157
    v_mul_f32 v144, 0x3acccccd, v144
    v_mfma_f32_32x32x16_bf16 v[112:127], v[72:75], a[116:119], v[112:127]
    ds_read_b128 v[56:59], v8 offset:29696
    buffer_load_dwordx4 v6, s[20:23], s42 offen offset:1024 sc1 lds
    v_mfma_f32_32x32x16_bf16 v[128:143], v[76:79], a[116:119], v[128:143]
    ds_read_b128 v[60:63], v8 offset:30208
    v_mul_f32 v145, 0x3acccccd, v145
    v_fma_f32 v145, -v144, v144, v145
    v_max_f32 v145, 0, v145
    v_add_f32 v145, 0x3727c5ac, v145
    s_waitcnt vmcnt(12)
    s_barrier
    s_waitcnt lgkmcnt(4)
    v_mfma_f32_32x32x16_bf16 v[80:95], v[32:35], a[120:123], v[80:95]
    ds_read_b128 v[64:67], v8 offset:32768
    s_add_u32 s80, s76, 20480
    buffer_load_dwordx4 a[176:179], v249, s[72:75], s80 offen offset:0 sc1
    v_mfma_f32_32x32x16_bf16 v[96:111], v[36:39], a[120:123], v[96:111]
    ds_read_b128 v[68:71], v8 offset:33280
    v_rsq_f32 v145, v145
    s_nop 0
    v_mul_f32 v146, v144, v145
    v_mfma_f32_32x32x16_bf16 v[112:127], v[40:43], a[120:123], v[112:127]
    ds_read_b128 v[72:75], v8 offset:33792
    buffer_load_dwordx4 a[180:183], v249, s[72:75], s80 offen offset:1024 sc1
    v_mfma_f32_32x32x16_bf16 v[128:143], v[44:47], a[120:123], v[128:143]
    ds_read_b128 v[76:79], v8 offset:34304
    v_sub_f32 v146, 0, v146
    ds_write_b32 v28, v145
    ds_write_b32 v28, v146 offset:512
    ds_write_b32 v28, v156 offset:1024
    s_waitcnt lgkmcnt(7)
    v_mfma_f32_32x32x16_bf16 v[80:95], v[48:51], a[124:127], v[80:95]
    ds_read_b128 v[32:35], v8 offset:36864
    buffer_load_dwordx4 a[184:187], v249, s[72:75], s80 offen offset:2048 sc1
    v_mfma_f32_32x32x16_bf16 v[96:111], v[52:55], a[124:127], v[96:111]
    ds_read_b128 v[36:39], v8 offset:37376
    v_mfma_f32_32x32x16_bf16 v[112:127], v[56:59], a[124:127], v[112:127]
    ds_read_b128 v[40:43], v8 offset:37888
    buffer_load_dwordx4 a[188:191], v249, s[72:75], s80 offen offset:3072 sc1
    v_mfma_f32_32x32x16_bf16 v[128:143], v[60:63], a[124:127], v[128:143]
    ds_read_b128 v[44:47], v8 offset:38400
    s_waitcnt lgkmcnt(7)
    v_mfma_f32_32x32x16_bf16 v[80:95], v[64:67], a[128:131], v[80:95]
    ds_read_b128 v[48:51], v8 offset:40960
    s_add_u32 m0, s40, 81920
    s_add_u32 s42, s38, 1310720
    buffer_load_dwordx4 v6, s[20:23], s42 offen offset:0 sc1 lds
    v_mfma_f32_32x32x16_bf16 v[96:111], v[68:71], a[128:131], v[96:111]
    ds_read_b128 v[52:55], v8 offset:41472
    v_mfma_f32_32x32x16_bf16 v[112:127], v[72:75], a[128:131], v[112:127]
    ds_read_b128 v[56:59], v8 offset:41984
    buffer_load_dwordx4 v6, s[20:23], s42 offen offset:1024 sc1 lds
    v_mfma_f32_32x32x16_bf16 v[128:143], v[76:79], a[128:131], v[128:143]
    ds_read_b128 v[60:63], v8 offset:42496
    s_waitcnt lgkmcnt(4)
    v_mfma_f32_32x32x16_bf16 v[80:95], v[32:35], a[132:135], v[80:95]
    ds_read_b128 v[64:67], v8 offset:45056
    s_add_u32 m0, s40, 83968
    s_add_u32 s42, s38, 1343488
    buffer_load_dwordx4 v6, s[20:23], s42 offen offset:0 sc1 lds
    v_mfma_f32_32x32x16_bf16 v[96:111], v[36:39], a[132:135], v[96:111]
    ds_read_b128 v[68:71], v8 offset:45568
    v_mfma_f32_32x32x16_bf16 v[112:127], v[40:43], a[132:135], v[112:127]
    ds_read_b128 v[72:75], v8 offset:46080
    buffer_load_dwordx4 v6, s[20:23], s42 offen offset:1024 sc1 lds
    v_mfma_f32_32x32x16_bf16 v[128:143], v[44:47], a[132:135], v[128:143]
    ds_read_b128 v[76:79], v8 offset:46592
    s_waitcnt vmcnt(16)
    s_barrier
    s_waitcnt lgkmcnt(4)
    v_mfma_f32_32x32x16_bf16 v[80:95], v[48:51], a[136:139], v[80:95]
    ds_read_b128 v[32:35], v8 offset:49152
    s_add_u32 s80, s76, 24576
    buffer_load_dwordx4 a[192:195], v249, s[72:75], s80 offen offset:0 sc1
    v_mfma_f32_32x32x16_bf16 v[96:111], v[52:55], a[136:139], v[96:111]
    ds_read_b128 v[36:39], v8 offset:49664
    v_mfma_f32_32x32x16_bf16 v[112:127], v[56:59], a[136:139], v[112:127]
    ds_read_b128 v[40:43], v8 offset:50176
    buffer_load_dwordx4 a[196:199], v249, s[72:75], s80 offen offset:1024 sc1
    v_mfma_f32_32x32x16_bf16 v[128:143], v[60:63], a[136:139], v[128:143]
    ds_read_b128 v[44:47], v8 offset:50688
    s_waitcnt lgkmcnt(4)
    v_mfma_f32_32x32x16_bf16 v[80:95], v[64:67], a[140:143], v[80:95]
    ds_read_b128 v[48:51], v8 offset:53248
    buffer_load_dwordx4 a[200:203], v249, s[72:75], s80 offen offset:2048 sc1
    v_mfma_f32_32x32x16_bf16 v[96:111], v[68:71], a[140:143], v[96:111]
    ds_read_b128 v[52:55], v8 offset:53760
    v_mfma_f32_32x32x16_bf16 v[112:127], v[72:75], a[140:143], v[112:127]
    ds_read_b128 v[56:59], v8 offset:54272
    buffer_load_dwordx4 a[204:207], v249, s[72:75], s80 offen offset:3072 sc1
    v_mfma_f32_32x32x16_bf16 v[128:143], v[76:79], a[140:143], v[128:143]
    ds_read_b128 v[60:63], v8 offset:54784
    s_waitcnt lgkmcnt(4)
    v_mfma_f32_32x32x16_bf16 v[80:95], v[32:35], a[144:147], v[80:95]
    ds_read_b128 v[64:67], v8 offset:57344
    s_add_u32 m0, s40, 98304
    s_add_u32 s42, s38, 1572864
    buffer_load_dwordx4 v6, s[20:23], s42 offen offset:0 sc1 lds
    v_mfma_f32_32x32x16_bf16 v[96:111], v[36:39], a[144:147], v[96:111]
    ds_read_b128 v[68:71], v8 offset:57856
    v_mfma_f32_32x32x16_bf16 v[112:127], v[40:43], a[144:147], v[112:127]
    ds_read_b128 v[72:75], v8 offset:58368
    buffer_load_dwordx4 v6, s[20:23], s42 offen offset:1024 sc1 lds
    v_mfma_f32_32x32x16_bf16 v[128:143], v[44:47], a[144:147], v[128:143]
    ds_read_b128 v[76:79], v8 offset:58880
    s_waitcnt lgkmcnt(4)
    v_mfma_f32_32x32x16_bf16 v[80:95], v[48:51], a[148:151], v[80:95]
    ds_read_b128 v[32:35], v8 offset:61440
    s_add_u32 m0, s40, 100352
    s_add_u32 s42, s38, 1605632
    buffer_load_dwordx4 v6, s[20:23], s42 offen offset:0 sc1 lds
    v_mfma_f32_32x32x16_bf16 v[96:111], v[52:55], a[148:151], v[96:111]
    ds_read_b128 v[36:39], v8 offset:61952
    v_mfma_f32_32x32x16_bf16 v[112:127], v[56:59], a[148:151], v[112:127]
    ds_read_b128 v[40:43], v8 offset:62464
    buffer_load_dwordx4 v6, s[20:23], s42 offen offset:1024 sc1 lds
    v_mfma_f32_32x32x16_bf16 v[128:143], v[60:63], a[148:151], v[128:143]
    ds_read_b128 v[44:47], v8 offset:62976
    s_waitcnt vmcnt(16)
    s_barrier
    s_waitcnt lgkmcnt(4)
    v_mfma_f32_32x32x16_bf16 v[80:95], v[64:67], a[152:155], v[80:95]
    ds_read_b128 v[48:51], v9 offset:0
    s_add_u32 s80, s76, 28672
    buffer_load_dwordx4 a[208:211], v249, s[72:75], s80 offen offset:0 sc1
    v_mfma_f32_32x32x16_bf16 v[96:111], v[68:71], a[152:155], v[96:111]
    ds_read_b128 v[52:55], v9 offset:512
    v_mfma_f32_32x32x16_bf16 v[112:127], v[72:75], a[152:155], v[112:127]
    ds_read_b128 v[56:59], v9 offset:1024
    buffer_load_dwordx4 a[212:215], v249, s[72:75], s80 offen offset:1024 sc1
    v_mfma_f32_32x32x16_bf16 v[128:143], v[76:79], a[152:155], v[128:143]
    ds_read_b128 v[60:63], v9 offset:1536
    s_waitcnt lgkmcnt(4)
    v_mfma_f32_32x32x16_bf16 v[80:95], v[32:35], a[156:159], v[80:95]
    ds_read_b128 v[64:67], v9 offset:4096
    buffer_load_dwordx4 a[216:219], v249, s[72:75], s80 offen offset:2048 sc1
    v_mfma_f32_32x32x16_bf16 v[96:111], v[36:39], a[156:159], v[96:111]
    ds_read_b128 v[68:71], v9 offset:4608
    v_lshl_add_u32 v200, v2, 2, s43
    v_add_u32 v200, 148480, v200
    ds_read_b32 v170, v200
    v_mfma_f32_32x32x16_bf16 v[112:127], v[40:43], a[156:159], v[112:127]
    ds_read_b128 v[72:75], v9 offset:5120
    buffer_load_dwordx4 a[220:223], v249, s[72:75], s80 offen offset:3072 sc1
    v_mfma_f32_32x32x16_bf16 v[128:143], v[44:47], a[156:159], v[128:143]
    ds_read_b128 v[76:79], v9 offset:5632
    s_waitcnt lgkmcnt(5)
    v_mfma_f32_32x32x16_bf16 v[80:95], v[48:51], a[160:163], v[80:95]
    ds_read_b128 v[32:35], v9 offset:8192
    s_add_u32 m0, s40, 114688
    s_add_u32 s42, s38, 1835008
    buffer_load_dwordx4 v6, s[20:23], s42 offen offset:0 sc1 lds
    v_mfma_f32_32x32x16_bf16 v[96:111], v[52:55], a[160:163], v[96:111]
    ds_read_b128 v[36:39], v9 offset:8704
    v_mfma_f32_32x32x16_bf16 v[112:127], v[56:59], a[160:163], v[112:127]
    ds_read_b128 v[40:43], v9 offset:9216
    buffer_load_dwordx4 v6, s[20:23], s42 offen offset:1024 sc1 lds
    v_mfma_f32_32x32x16_bf16 v[128:143], v[60:63], a[160:163], v[128:143]
    ds_read_b128 v[44:47], v9 offset:9728
    s_waitcnt lgkmcnt(4)
    v_mfma_f32_32x32x16_bf16 v[80:95], v[64:67], a[164:167], v[80:95]
    ds_read_b128 v[48:51], v9 offset:12288
    s_add_u32 m0, s40, 116736
    s_add_u32 s42, s38, 1867776
    buffer_load_dwordx4 v6, s[20:23], s42 offen offset:0 sc1 lds
    v_mfma_f32_32x32x16_bf16 v[96:111], v[68:71], a[164:167], v[96:111]
    ds_read_b128 v[52:55], v9 offset:12800
    s_waitcnt lgkmcnt(8)
    v_mfma_f32_32x32x16_bf16 v[112:127], v[72:75], a[164:167], v[112:127]
    ds_read_b128 v[56:59], v9 offset:13312
    buffer_load_dwordx4 v6, s[20:23], s42 offen offset:1024 sc1 lds
    v_mfma_f32_32x32x16_bf16 v[128:143], v[76:79], a[164:167], v[128:143]
    ds_read_b128 v[60:63], v9 offset:13824
    s_waitcnt vmcnt(16)
    s_barrier
    s_waitcnt lgkmcnt(4)
    v_mfma_f32_32x32x16_bf16 v[80:95], v[32:35], a[168:171], v[80:95]
    ds_read_b128 v[64:67], v9 offset:16384
    s_add_u32 s80, s76, 32768
    buffer_load_dwordx4 a[224:227], v249, s[72:75], s80 offen offset:0 sc1
    v_mfma_f32_32x32x16_bf16 v[96:111], v[36:39], a[168:171], v[96:111]
    ds_read_b128 v[68:71], v9 offset:16896
    v_mfma_f32_32x32x16_bf16 v[112:127], v[40:43], a[168:171], v[112:127]
    ds_read_b128 v[72:75], v9 offset:17408
    buffer_load_dwordx4 a[228:231], v249, s[72:75], s80 offen offset:1024 sc1
    v_mfma_f32_32x32x16_bf16 v[128:143], v[44:47], a[168:171], v[128:143]
    ds_read_b128 v[76:79], v9 offset:17920
    s_waitcnt lgkmcnt(4)
    v_mfma_f32_32x32x16_bf16 v[80:95], v[48:51], a[172:175], v[80:95]
    ds_read_b128 v[32:35], v9 offset:20480
    buffer_load_dwordx4 a[232:235], v249, s[72:75], s80 offen offset:2048 sc1
    v_mfma_f32_32x32x16_bf16 v[96:111], v[52:55], a[172:175], v[96:111]
    ds_read_b128 v[36:39], v9 offset:20992
    v_mfma_f32_32x32x16_bf16 v[112:127], v[56:59], a[172:175], v[112:127]
    ds_read_b128 v[40:43], v9 offset:21504
    buffer_load_dwordx4 a[236:239], v249, s[72:75], s80 offen offset:3072 sc1
    v_mfma_f32_32x32x16_bf16 v[128:143], v[60:63], a[172:175], v[128:143]
    ds_read_b128 v[44:47], v9 offset:22016
    s_waitcnt lgkmcnt(4)
    v_mfma_f32_32x32x16_bf16 v[80:95], v[64:67], a[176:179], v[80:95]
    ds_read_b128 v[48:51], v9 offset:24576
    s_add_u32 m0, s40, 131072
    s_add_u32 s42, s38, 2097152
    buffer_load_dwordx4 v6, s[20:23], s42 offen offset:0 sc1 lds
    v_mfma_f32_32x32x16_bf16 v[96:111], v[68:71], a[176:179], v[96:111]
    ds_read_b128 v[52:55], v9 offset:25088
    v_mfma_f32_32x32x16_bf16 v[112:127], v[72:75], a[176:179], v[112:127]
    ds_read_b128 v[56:59], v9 offset:25600
    buffer_load_dwordx4 v6, s[20:23], s42 offen offset:1024 sc1 lds
    v_mfma_f32_32x32x16_bf16 v[128:143], v[76:79], a[176:179], v[128:143]
    ds_read_b128 v[60:63], v9 offset:26112
    s_waitcnt lgkmcnt(4)
    v_mfma_f32_32x32x16_bf16 v[80:95], v[32:35], a[180:183], v[80:95]
    ds_read_b128 v[64:67], v9 offset:28672
    s_add_u32 m0, s40, 133120
    s_add_u32 s42, s38, 2129920
    buffer_load_dwordx4 v6, s[20:23], s42 offen offset:0 sc1 lds
    v_mfma_f32_32x32x16_bf16 v[96:111], v[36:39], a[180:183], v[96:111]
    ds_read_b128 v[68:71], v9 offset:29184
    v_mfma_f32_32x32x16_bf16 v[112:127], v[40:43], a[180:183], v[112:127]
    ds_read_b128 v[72:75], v9 offset:29696
    buffer_load_dwordx4 v6, s[20:23], s42 offen offset:1024 sc1 lds
    v_mfma_f32_32x32x16_bf16 v[128:143], v[44:47], a[180:183], v[128:143]
    ds_read_b128 v[76:79], v9 offset:30208
    s_waitcnt vmcnt(16)
    s_barrier
    s_waitcnt lgkmcnt(4)
    v_mfma_f32_32x32x16_bf16 v[80:95], v[48:51], a[184:187], v[80:95]
    ds_read_b128 v[32:35], v9 offset:32768
    s_add_u32 s80, s76, 36864
    buffer_load_dwordx4 a[240:243], v249, s[72:75], s80 offen offset:0 sc1
    v_mfma_f32_32x32x16_bf16 v[96:111], v[52:55], a[184:187], v[96:111]
    ds_read_b128 v[36:39], v9 offset:33280
    v_mfma_f32_32x32x16_bf16 v[112:127], v[56:59], a[184:187], v[112:127]
    ds_read_b128 v[40:43], v9 offset:33792
    buffer_load_dwordx4 a[244:247], v249, s[72:75], s80 offen offset:1024 sc1
    v_mfma_f32_32x32x16_bf16 v[128:143], v[60:63], a[184:187], v[128:143]
    ds_read_b128 v[44:47], v9 offset:34304
    s_waitcnt lgkmcnt(4)
    v_mfma_f32_32x32x16_bf16 v[80:95], v[64:67], a[188:191], v[80:95]
    ds_read_b128 v[48:51], v9 offset:36864
    buffer_load_dwordx4 a[248:251], v249, s[72:75], s80 offen offset:2048 sc1
    v_mfma_f32_32x32x16_bf16 v[96:111], v[68:71], a[188:191], v[96:111]
    ds_read_b128 v[52:55], v9 offset:37376
    v_mfma_f32_32x32x16_bf16 v[112:127], v[72:75], a[188:191], v[112:127]
    ds_read_b128 v[56:59], v9 offset:37888
    buffer_load_dwordx4 a[252:255], v249, s[72:75], s80 offen offset:3072 sc1
    v_mfma_f32_32x32x16_bf16 v[128:143], v[76:79], a[188:191], v[128:143]
    ds_read_b128 v[60:63], v9 offset:38400
    s_waitcnt lgkmcnt(4)
    v_mfma_f32_32x32x16_bf16 v[80:95], v[32:35], a[192:195], v[80:95]
    ds_read_b128 v[64:67], v9 offset:40960
    s_add_u32 m0, s40, 0
    s_add_u32 s42, s38, 2359296
    buffer_load_dwordx4 v6, s[20:23], s42 offen offset:0 sc1 lds
    v_mfma_f32_32x32x16_bf16 v[96:111], v[36:39], a[192:195], v[96:111]
    ds_read_b128 v[68:71], v9 offset:41472
    v_mfma_f32_32x32x16_bf16 v[112:127], v[40:43], a[192:195], v[112:127]
    ds_read_b128 v[72:75], v9 offset:41984
    buffer_load_dwordx4 v6, s[20:23], s42 offen offset:1024 sc1 lds
    v_mfma_f32_32x32x16_bf16 v[128:143], v[44:47], a[192:195], v[128:143]
    ds_read_b128 v[76:79], v9 offset:42496
    s_waitcnt lgkmcnt(4)
    v_mfma_f32_32x32x16_bf16 v[80:95], v[48:51], a[196:199], v[80:95]
    ds_read_b128 v[32:35], v9 offset:45056
    s_add_u32 m0, s40, 2048
    s_add_u32 s42, s38, 2392064
    buffer_load_dwordx4 v6, s[20:23], s42 offen offset:0 sc1 lds
    v_mfma_f32_32x32x16_bf16 v[96:111], v[52:55], a[196:199], v[96:111]
    ds_read_b128 v[36:39], v9 offset:45568
    v_mfma_f32_32x32x16_bf16 v[112:127], v[56:59], a[196:199], v[112:127]
    ds_read_b128 v[40:43], v9 offset:46080
    buffer_load_dwordx4 v6, s[20:23], s42 offen offset:1024 sc1 lds
    v_mfma_f32_32x32x16_bf16 v[128:143], v[60:63], a[196:199], v[128:143]
    ds_read_b128 v[44:47], v9 offset:46592
    s_waitcnt vmcnt(16)
    s_barrier
    s_waitcnt lgkmcnt(4)
    v_mfma_f32_32x32x16_bf16 v[80:95], v[64:67], a[200:203], v[80:95]
    ds_read_b128 v[48:51], v9 offset:49152
    v_mfma_f32_32x32x16_bf16 v[96:111], v[68:71], a[200:203], v[96:111]
    ds_read_b128 v[52:55], v9 offset:49664
    v_mfma_f32_32x32x16_bf16 v[112:127], v[72:75], a[200:203], v[112:127]
    ds_read_b128 v[56:59], v9 offset:50176
    v_mfma_f32_32x32x16_bf16 v[128:143], v[76:79], a[200:203], v[128:143]
    ds_read_b128 v[60:63], v9 offset:50688
    s_waitcnt lgkmcnt(4)
    v_mfma_f32_32x32x16_bf16 v[80:95], v[32:35], a[204:207], v[80:95]
    ds_read_b128 v[64:67], v9 offset:53248
    v_mfma_f32_32x32x16_bf16 v[96:111], v[36:39], a[204:207], v[96:111]
    ds_read_b128 v[68:71], v9 offset:53760
    v_mfma_f32_32x32x16_bf16 v[112:127], v[40:43], a[204:207], v[112:127]
    ds_read_b128 v[72:75], v9 offset:54272
    v_mfma_f32_32x32x16_bf16 v[128:143], v[44:47], a[204:207], v[128:143]
    ds_read_b128 v[76:79], v9 offset:54784
    s_waitcnt lgkmcnt(4)
    v_mfma_f32_32x32x16_bf16 v[80:95], v[48:51], a[208:211], v[80:95]
    ds_read_b128 v[32:35], v9 offset:57344
    v_mfma_f32_32x32x16_bf16 v[96:111], v[52:55], a[208:211], v[96:111]
    ds_read_b128 v[36:39], v9 offset:57856
    v_mfma_f32_32x32x16_bf16 v[112:127], v[56:59], a[208:211], v[112:127]
    ds_read_b128 v[40:43], v9 offset:58368
    v_mfma_f32_32x32x16_bf16 v[128:143], v[60:63], a[208:211], v[128:143]
    ds_read_b128 v[44:47], v9 offset:58880
    s_waitcnt lgkmcnt(4)
    v_mfma_f32_32x32x16_bf16 v[80:95], v[64:67], a[212:215], v[80:95]
    ds_read_b128 v[48:51], v9 offset:61440
    v_mfma_f32_32x32x16_bf16 v[96:111], v[68:71], a[212:215], v[96:111]
    ds_read_b128 v[52:55], v9 offset:61952
    v_mfma_f32_32x32x16_bf16 v[112:127], v[72:75], a[212:215], v[112:127]
    ds_read_b128 v[56:59], v9 offset:62464
    v_mfma_f32_32x32x16_bf16 v[128:143], v[76:79], a[212:215], v[128:143]
    ds_read_b128 v[60:63], v9 offset:62976
    s_waitcnt vmcnt(8)
    s_barrier
    s_waitcnt lgkmcnt(4)
    v_mfma_f32_32x32x16_bf16 v[80:95], v[32:35], a[216:219], v[80:95]
    ds_read_b128 v[64:67], v10 offset:0
    v_mfma_f32_32x32x16_bf16 v[96:111], v[36:39], a[216:219], v[96:111]
    ds_read_b128 v[68:71], v10 offset:4096
    v_mfma_f32_32x32x16_bf16 v[112:127], v[40:43], a[216:219], v[112:127]
    ds_read_b128 v[72:75], v10 offset:8192
    v_mfma_f32_32x32x16_bf16 v[128:143], v[44:47], a[216:219], v[128:143]
    ds_read_b128 v[76:79], v10 offset:12288
    s_waitcnt vmcnt(0)
    s_barrier
    s_waitcnt lgkmcnt(4)
    v_mfma_f32_32x32x16_bf16 v[80:95], v[48:51], a[220:223], v[80:95]
    ds_read_b128 v[32:35], v8 offset:0
    v_mfma_f32_32x32x16_bf16 v[96:111], v[52:55], a[220:223], v[96:111]
    ds_read_b128 v[36:39], v8 offset:4096
    v_mfma_f32_32x32x16_bf16 v[112:127], v[56:59], a[220:223], v[112:127]
    ds_read_b128 v[40:43], v8 offset:8192
    v_mfma_f32_32x32x16_bf16 v[128:143], v[60:63], a[220:223], v[128:143]
    ds_read_b128 v[44:47], v8 offset:12288
    s_waitcnt lgkmcnt(4)
    v_mfma_f32_32x32x16_bf16 v[80:95], v[64:67], a[224:227], v[80:95]
    ds_read_b128 v[48:51], v10 offset:512
    v_mfma_f32_32x32x16_bf16 v[80:95], v[68:71], a[228:231], v[80:95]
    ds_read_b128 v[52:55], v10 offset:4608
    v_mfma_f32_32x32x16_bf16 v[80:95], v[72:75], a[232:235], v[80:95]
    ds_read_b128 v[56:59], v10 offset:8704
    v_mfma_f32_32x32x16_bf16 v[80:95], v[76:79], a[236:239], v[80:95]
    ds_read_b128 v[60:63], v10 offset:12800
    s_waitcnt lgkmcnt(4)
    v_mfma_f32_32x32x16_bf16 v[80:95], v[32:35], a[240:243], v[80:95]
    ds_read_b128 v[64:67], v8 offset:512
    v_mfma_f32_32x32x16_bf16 v[80:95], v[36:39], a[244:247], v[80:95]
    ds_read_b128 v[68:71], v8 offset:4608
    v_mfma_f32_32x32x16_bf16 v[80:95], v[40:43], a[248:251], v[80:95]
    ds_read_b128 v[72:75], v8 offset:8704
    v_mfma_f32_32x32x16_bf16 v[80:95], v[44:47], a[252:255], v[80:95]
    ds_read_b128 v[76:79], v8 offset:12800
    s_waitcnt lgkmcnt(4)
    v_mfma_f32_32x32x16_bf16 v[96:111], v[48:51], a[224:227], v[96:111]
    ds_read_b128 v[32:35], v10 offset:1024
    ds_read_b128 v[200:203], v31 offset:0
    ds_read_b128 v[208:211], v31 offset:512
    ds_read_b128 v[204:207], v31 offset:32
    ds_read_b128 v[212:215], v31 offset:544
    s_waitcnt lgkmcnt(0)
    v_mul_f32 v176, v208, v170
    v_mul_f32 v177, v209, v170
    v_mul_f32 v178, v210, v170
    v_mul_f32 v179, v211, v170
    v_mfma_f32_32x32x16_bf16 v[96:111], v[52:55], a[228:231], v[96:111]
    ds_read_b128 v[36:39], v10 offset:5120
    v_mul_f32 v180, v212, v170
    v_mul_f32 v181, v213, v170
    v_mul_f32 v182, v214, v170
    v_mul_f32 v183, v215, v170
    v_fmac_f32 v176, v80, v200
    v_fmac_f32 v177, v81, v201
    v_fmac_f32 v178, v82, v202
    v_fmac_f32 v179, v83, v203
    v_fmac_f32 v180, v84, v204
    v_mfma_f32_32x32x16_bf16 v[96:111], v[56:59], a[232:235], v[96:111]
    ds_read_b128 v[40:43], v10 offset:9216
    v_fmac_f32 v181, v85, v205
    v_fmac_f32 v182, v86, v206
    v_fmac_f32 v183, v87, v207
    v_cvt_pk_bf16_f32 v192, v176, v177
    v_cvt_pk_bf16_f32 v193, v178, v179
    v_cvt_pk_bf16_f32 v194, v180, v181
    v_cvt_pk_bf16_f32 v195, v182, v183
    s_movk_i32 s52, 0
    buffer_store_dwordx4 v[192:195], v168, s[48:51], s52 offen offset:0 sc1
    v_mfma_f32_32x32x16_bf16 v[96:111], v[60:63], a[236:239], v[96:111]
    ds_read_b128 v[44:47], v10 offset:13312
    ds_read_b128 v[200:203], v31 offset:64
    ds_read_b128 v[208:211], v31 offset:576
    ds_read_b128 v[204:207], v31 offset:96
    ds_read_b128 v[212:215], v31 offset:608
    s_waitcnt lgkmcnt(0)
    v_mul_f32 v176, v208, v170
    v_mul_f32 v177, v209, v170
    v_mul_f32 v178, v210, v170
    v_mul_f32 v179, v211, v170
    s_waitcnt lgkmcnt(12)
    v_mfma_f32_32x32x16_bf16 v[96:111], v[64:67], a[240:243], v[96:111]
    ds_read_b128 v[48:51], v8 offset:1024
    v_mul_f32 v180, v212, v170
    v_mul_f32 v181, v213, v170
    v_mul_f32 v182, v214, v170
    v_mul_f32 v183, v215, v170
    v_fmac_f32 v176, v88, v200
    v_fmac_f32 v177, v89, v201
    v_fmac_f32 v178, v90, v202
    v_fmac_f32 v179, v91, v203
    v_fmac_f32 v180, v92, v204
    v_mfma_f32_32x32x16_bf16 v[96:111], v[68:71], a[244:247], v[96:111]
    ds_read_b128 v[52:55], v8 offset:5120
    v_fmac_f32 v181, v93, v205
    v_fmac_f32 v182, v94, v206
    v_fmac_f32 v183, v95, v207
    v_cvt_pk_bf16_f32 v196, v176, v177
    v_cvt_pk_bf16_f32 v197, v178, v179
    v_cvt_pk_bf16_f32 v198, v180, v181
    v_cvt_pk_bf16_f32 v199, v182, v183
    buffer_store_dwordx4 v[196:199], v168, s[48:51], s52 offen offset:640 sc1
    v_mfma_f32_32x32x16_bf16 v[96:111], v[72:75], a[248:251], v[96:111]
    ds_read_b128 v[56:59], v8 offset:9216
    v_mfma_f32_32x32x16_bf16 v[96:111], v[76:79], a[252:255], v[96:111]
    ds_read_b128 v[60:63], v8 offset:13312
    s_waitcnt lgkmcnt(8)
    v_mfma_f32_32x32x16_bf16 v[112:127], v[32:35], a[224:227], v[112:127]
    ds_read_b128 v[64:67], v10 offset:1536
    ds_read_b128 v[200:203], v31 offset:128
    ds_read_b128 v[208:211], v31 offset:640
    ds_read_b128 v[204:207], v31 offset:160
    ds_read_b128 v[212:215], v31 offset:672
    s_waitcnt lgkmcnt(0)
    v_mul_f32 v176, v208, v170
    v_mul_f32 v177, v209, v170
    v_mul_f32 v178, v210, v170
    v_mul_f32 v179, v211, v170
    v_mfma_f32_32x32x16_bf16 v[112:127], v[36:39], a[228:231], v[112:127]
    ds_read_b128 v[68:71], v10 offset:5632
    v_mul_f32 v180, v212, v170
    v_mul_f32 v181, v213, v170
    v_mul_f32 v182, v214, v170
    v_mul_f32 v183, v215, v170
    v_fmac_f32 v176, v96, v200
    v_fmac_f32 v177, v97, v201
    v_fmac_f32 v178, v98, v202
    v_fmac_f32 v179, v99, v203
    v_fmac_f32 v180, v100, v204
    v_mfma_f32_32x32x16_bf16 v[112:127], v[40:43], a[232:235], v[112:127]
    ds_read_b128 v[72:75], v10 offset:9728
    v_fmac_f32 v181, v101, v205
    v_fmac_f32 v182, v102, v206
    v_fmac_f32 v183, v103, v207
    v_cvt_pk_bf16_f32 v192, v176, v177
    v_cvt_pk_bf16_f32 v193, v178, v179
    v_cvt_pk_bf16_f32 v194, v180, v181
    v_cvt_pk_bf16_f32 v195, v182, v183
    s_movk_i32 s52, 1280
    buffer_store_dwordx4 v[192:195], v168, s[48:51], s52 offen offset:0 sc1
    v_mfma_f32_32x32x16_bf16 v[112:127], v[44:47], a[236:239], v[112:127]
    ds_read_b128 v[76:79], v10 offset:13824
    ds_read_b128 v[200:203], v31 offset:192
    ds_read_b128 v[208:211], v31 offset:704
    ds_read_b128 v[204:207], v31 offset:224
    ds_read_b128 v[212:215], v31 offset:736
    s_waitcnt lgkmcnt(0)
    v_mul_f32 v176, v208, v170
    v_mul_f32 v177, v209, v170
    v_mul_f32 v178, v210, v170
    v_mul_f32 v179, v211, v170
    s_waitcnt lgkmcnt(12)
    v_mfma_f32_32x32x16_bf16 v[112:127], v[48:51], a[240:243], v[112:127]
    ds_read_b128 v[32:35], v8 offset:1536
    v_mul_f32 v180, v212, v170
    v_mul_f32 v181, v213, v170
    v_mul_f32 v182, v214, v170
    v_mul_f32 v183, v215, v170
    v_fmac_f32 v176, v104, v200
    v_fmac_f32 v177, v105, v201
    v_fmac_f32 v178, v106, v202
    v_fmac_f32 v179, v107, v203
    v_fmac_f32 v180, v108, v204
    v_mfma_f32_32x32x16_bf16 v[112:127], v[52:55], a[244:247], v[112:127]
    ds_read_b128 v[36:39], v8 offset:5632
    v_fmac_f32 v181, v109, v205
    v_fmac_f32 v182, v110, v206
    v_fmac_f32 v183, v111, v207
    v_cvt_pk_bf16_f32 v196, v176, v177
    v_cvt_pk_bf16_f32 v197, v178, v179
    v_cvt_pk_bf16_f32 v198, v180, v181
    v_cvt_pk_bf16_f32 v199, v182, v183
    buffer_store_dwordx4 v[196:199], v168, s[48:51], s52 offen offset:640 sc1
    v_mfma_f32_32x32x16_bf16 v[112:127], v[56:59], a[248:251], v[112:127]
    ds_read_b128 v[40:43], v8 offset:9728
    v_mfma_f32_32x32x16_bf16 v[112:127], v[60:63], a[252:255], v[112:127]
    ds_read_b128 v[44:47], v8 offset:13824
    s_waitcnt lgkmcnt(8)
    v_mfma_f32_32x32x16_bf16 v[128:143], v[64:67], a[224:227], v[128:143]
    ds_read_b128 v[200:203], v31 offset:256
    ds_read_b128 v[208:211], v31 offset:768
    ds_read_b128 v[204:207], v31 offset:288
    ds_read_b128 v[212:215], v31 offset:800
    s_waitcnt lgkmcnt(0)
    v_mul_f32 v176, v208, v170
    v_mul_f32 v177, v209, v170
    v_mul_f32 v178, v210, v170
    v_mul_f32 v179, v211, v170
    v_mfma_f32_32x32x16_bf16 v[128:143], v[68:71], a[228:231], v[128:143]
    v_mul_f32 v180, v212, v170
    v_mul_f32 v181, v213, v170
    v_mul_f32 v182, v214, v170
    v_mul_f32 v183, v215, v170
    v_fmac_f32 v176, v112, v200
    v_fmac_f32 v177, v113, v201
    v_fmac_f32 v178, v114, v202
    v_fmac_f32 v179, v115, v203
    v_fmac_f32 v180, v116, v204
    v_mfma_f32_32x32x16_bf16 v[128:143], v[72:75], a[232:235], v[128:143]
    v_fmac_f32 v181, v117, v205
    v_fmac_f32 v182, v118, v206
    v_fmac_f32 v183, v119, v207
    v_cvt_pk_bf16_f32 v192, v176, v177
    v_cvt_pk_bf16_f32 v193, v178, v179
    v_cvt_pk_bf16_f32 v194, v180, v181
    v_cvt_pk_bf16_f32 v195, v182, v183
    s_movk_i32 s52, 2560
    buffer_store_dwordx4 v[192:195], v168, s[48:51], s52 offen offset:0 sc1
    v_mfma_f32_32x32x16_bf16 v[128:143], v[76:79], a[236:239], v[128:143]
    ds_read_b128 v[200:203], v31 offset:320
    ds_read_b128 v[208:211], v31 offset:832
    ds_read_b128 v[204:207], v31 offset:352
    ds_read_b128 v[212:215], v31 offset:864
    s_waitcnt lgkmcnt(0)
    v_mul_f32 v176, v208, v170
    v_mul_f32 v177, v209, v170
    v_mul_f32 v178, v210, v170
    v_mul_f32 v179, v211, v170
    s_waitcnt lgkmcnt(8)
    v_mfma_f32_32x32x16_bf16 v[128:143], v[32:35], a[240:243], v[128:143]
    v_mul_f32 v180, v212, v170
    v_mul_f32 v181, v213, v170
    v_mul_f32 v182, v214, v170
    v_mul_f32 v183, v215, v170
    v_fmac_f32 v176, v120, v200
    v_fmac_f32 v177, v121, v201
    v_fmac_f32 v178, v122, v202
    v_fmac_f32 v179, v123, v203
    v_fmac_f32 v180, v124, v204
    v_mfma_f32_32x32x16_bf16 v[128:143], v[36:39], a[244:247], v[128:143]
    v_fmac_f32 v181, v125, v205
    v_fmac_f32 v182, v126, v206
    v_fmac_f32 v183, v127, v207
    v_cvt_pk_bf16_f32 v196, v176, v177
    v_cvt_pk_bf16_f32 v197, v178, v179
    v_cvt_pk_bf16_f32 v198, v180, v181
    v_cvt_pk_bf16_f32 v199, v182, v183
    buffer_store_dwordx4 v[196:199], v168, s[48:51], s52 offen offset:640 sc1
    v_mfma_f32_32x32x16_bf16 v[128:143], v[40:43], a[248:251], v[128:143]
    v_mfma_f32_32x32x16_bf16 v[128:143], v[44:47], a[252:255], v[128:143]
    ds_read_b128 v[200:203], v31 offset:384
    ds_read_b128 v[208:211], v31 offset:896
    ds_read_b128 v[204:207], v31 offset:416
    ds_read_b128 v[212:215], v31 offset:928
    s_waitcnt lgkmcnt(0)
    v_pk_mul_f32 v[176:177], v[208:209], v[170:171] op_sel_hi:[1,0]
    v_pk_mul_f32 v[178:179], v[210:211], v[170:171] op_sel_hi:[1,0]
    v_pk_mul_f32 v[180:181], v[212:213], v[170:171] op_sel_hi:[1,0]
    v_pk_mul_f32 v[182:183], v[214:215], v[170:171] op_sel_hi:[1,0]
    s_nop 2
    v_pk_fma_f32 v[176:177], v[128:129], v[200:201], v[176:177]
    v_pk_fma_f32 v[178:179], v[130:131], v[202:203], v[178:179]
    v_pk_fma_f32 v[180:181], v[132:133], v[204:205], v[180:181]
    v_pk_fma_f32 v[182:183], v[134:135], v[206:207], v[182:183]
    v_cvt_pk_bf16_f32 v192, v176, v177
    v_cvt_pk_bf16_f32 v193, v178, v179
    v_cvt_pk_bf16_f32 v194, v180, v181
    v_cvt_pk_bf16_f32 v195, v182, v183
    s_movk_i32 s52, 3840
    buffer_store_dwordx4 v[192:195], v168, s[48:51], s52 offen offset:0 sc1
    ds_read_b128 v[200:203], v31 offset:448
    ds_read_b128 v[208:211], v31 offset:960
    ds_read_b128 v[204:207], v31 offset:480
    ds_read_b128 v[212:215], v31 offset:992
    s_waitcnt lgkmcnt(0)
    v_pk_mul_f32 v[176:177], v[208:209], v[170:171] op_sel_hi:[1,0]
    v_pk_mul_f32 v[178:179], v[210:211], v[170:171] op_sel_hi:[1,0]
    v_pk_mul_f32 v[180:181], v[212:213], v[170:171] op_sel_hi:[1,0]
    v_pk_mul_f32 v[182:183], v[214:215], v[170:171] op_sel_hi:[1,0]
    v_pk_fma_f32 v[176:177], v[136:137], v[200:201], v[176:177]
    v_pk_fma_f32 v[178:179], v[138:139], v[202:203], v[178:179]
    v_pk_fma_f32 v[180:181], v[140:141], v[204:205], v[180:181]
    v_pk_fma_f32 v[182:183], v[142:143], v[206:207], v[182:183]
    v_cvt_pk_bf16_f32 v196, v176, v177
    v_cvt_pk_bf16_f32 v197, v178, v179
    v_cvt_pk_bf16_f32 v198, v180, v181
    v_cvt_pk_bf16_f32 v199, v182, v183
    buffer_store_dwordx4 v[196:199], v168, s[48:51], s52 offen offset:640 sc1
interleave_layers__mha_block__dense_activation_silu__prompt_kernel_qkv_idle:
interleave_layers__mha_block__dense_activation_silu__prompt_kernel_qkv_fin:
    s_waitcnt vmcnt(0) lgkmcnt(0)
    s_barrier
    s_cmp_lg_u32 s16, 0
    s_cbranch_scc1 qarr_done_7
    s_lshr_b32 s20, s2, 3
    s_add_u32 s20, s20, 88
    s_sub_u32 s21, s2, 112
    s_mul_i32 s21, s21, 4682
    s_lshr_b32 s21, s21, 16
    s_add_u32 s21, s21, 80
    s_sub_u32 s22, s2, 224
    s_lshr_b32 s22, s22, 2
    s_add_u32 s22, s22, 72
    s_cmp_lt_u32 s2, 224
    s_cselect_b32 s21, s21, s22
    s_cmp_lt_u32 s2, 112
    s_cselect_b32 s20, s20, s21
    s_lshl_b32 s20, s20, 7
    s_add_u32 s100, s18, 0
    s_lshl_b32 s100, s100, 7
    s_add_u32 s100, s100, s97
    v_mov_b32 v250, s20
    v_mov_b32 v251, s100
    v_cmp_eq_u32 vcc, 0, v0
    s_cmp_eq_u32 s14, 0
    s_cselect_b32 s20, 3, 1
    s_mov_b32 s21, 0
    v_cndmask_b32 v250, v250, v251, vcc
    v_mov_b32 v251, 1
    s_mov_b64 exec, s[20:21]
    global_atomic_add v250, v251, s[98:99] sc1
    s_mov_b64 exec, -1
qarr_done_7:
    s_and_b32 s22, s2, 7
    s_lshr_b32 s23, s2, 3
    s_and_b32 s24, s23, 3
    s_lshl_b32 s24, s24, 3
    s_add_u32 s17, s22, s24
    s_lshr_b32 s18, s2, 5
    s_lshr_b32 s19, s17, 1
    s_and_b32 s20, s17, 1
    v_and_b32 v1, 63, v0
    v_and_b32 v2, 31, v0
    v_bfe_u32 v3, v0, 5, 1
    v_lshlrev_b32 v4, 4, v1
    v_lshlrev_b32 v5, 4, v2
    s_lshl_b32 s23, s20, 3
    v_add_u32 v5, s23, v5
    v_mul_u32_u24 v6, 320, v3
    v_lshl_add_u32 v6, v2, 4, v6
    s_mov_b32 s24, 0xffffffff
    s_mov_b32 s25, 0
    s_mov_b32 s26, 0x000fffff
    s_mov_b32 s27, 0x000fffff
    s_add_u32 s28, s96, 10489856
    s_add_u32 s28, s28, s6
    s_addc_u32 s29, s7, 0
    s_and_b32 s29, s29, 0xffff
    s_mov_b32 s30, 2621440
    s_mov_b32 s31, 0x20000
    s_add_u32 s32, s96, 13111296
    s_add_u32 s32, s32, s6
    s_addc_u32 s33, s7, 0
    s_and_b32 s33, s33, 0xffff
    s_mov_b32 s34, 2621440
    s_mov_b32 s35, 0x20000
    s_add_u32 s36, s96, 15732736
    s_add_u32 s36, s36, s6
    s_addc_u32 s37, s7, 0
    s_and_b32 s37, s37, 0xffff
    s_mov_b32 s38, 2621440
    s_mov_b32 s39, 0x20000
    s_add_u32 s40, s15, 26218496
    s_add_u32 s40, s40, s6
    s_addc_u32 s41, s7, 0
    s_and_b32 s41, s41, 0xffff
    s_mov_b32 s42, 2621440
    s_mov_b32 s43, 0x20000
    s_and_b32 s68, s16, 1
    s_lshr_b32 s69, s16, 1
    s_lshl_b32 s44, s17, 6
    s_lshl_b32 s45, s18, 3
    s_lshl_b32 s46, s68, 2
    s_add_u32 s45, s45, s46
    s_add_u32 s46, s44, s45
    s_lshl_b32 s46, s46, 10
    s_lshl_b32 s47, s19, 6
    s_add_u32 s47, s47, s45
    s_lshl_b32 s47, s47, 9
    s_add_u32 s47, s47, 2097152
    s_lshl_b32 s48, s69, 5
    s_add_u32 s49, s44, s48
    s_lshl_b32 s50, s49, 10
    s_mul_i32 s51, s49, 1280
    s_lshl_b32 s52, s19, 6
    s_add_u32 s52, s52, s48
    s_lshl_b32 s52, s52, 9
    s_add_u32 s52, s52, 2097152
    s_mov_b32 s21, 0
    v_mov_b32 v8, 0
    v_mov_b32 v9, 0x3f803f80
    v_mov_b32 v10, 0x00003f80
    v_cmp_eq_u32 vcc, 20, v2
    s_nop 1
    v_cndmask_b32 v11, 0, v9, vcc
    v_accvgpr_write_b32 a4, v8
    v_accvgpr_write_b32 a5, v8
    v_accvgpr_write_b32 a10, v8
    v_accvgpr_write_b32 a11, v8
    v_accvgpr_write_b32 a16, v8
    v_accvgpr_write_b32 a17, v8
    v_accvgpr_write_b32 a22, v8
    v_accvgpr_write_b32 a23, v8
    v_accvgpr_write_b32 a92, v9
    v_accvgpr_write_b32 a93, v10
    v_accvgpr_write_b32 a112, v11
    v_accvgpr_write_b32 a113, v11
    v_accvgpr_write_b32 a114, v11
    v_accvgpr_write_b32 a115, v11
    v_accvgpr_write_b32 a116, v11
    v_accvgpr_write_b32 a117, v11
    v_accvgpr_write_b32 a118, v11
    v_accvgpr_write_b32 a119, v11
    v_accvgpr_write_b32 a98, v9
    v_accvgpr_write_b32 a99, v10
    v_accvgpr_write_b32 a120, v11
    v_accvgpr_write_b32 a121, v11
    v_accvgpr_write_b32 a122, v11
    v_accvgpr_write_b32 a123, v11
    v_accvgpr_write_b32 a124, v11
    v_accvgpr_write_b32 a125, v11
    v_accvgpr_write_b32 a126, v11
    v_accvgpr_write_b32 a127, v11
    v_accvgpr_write_b32 a104, v9
    v_accvgpr_write_b32 a105, v10
    v_accvgpr_write_b32 a128, v11
    v_accvgpr_write_b32 a129, v11
    v_accvgpr_write_b32 a130, v11
    v_accvgpr_write_b32 a131, v11
    v_accvgpr_write_b32 a132, v11
    v_accvgpr_write_b32 a133, v11
    v_accvgpr_write_b32 a134, v11
    v_accvgpr_write_b32 a135, v11
    v_accvgpr_write_b32 a110, v9
    v_accvgpr_write_b32 a111, v10
    v_accvgpr_write_b32 a136, v11
    v_accvgpr_write_b32 a137, v11
    v_accvgpr_write_b32 a138, v11
    v_accvgpr_write_b32 a139, v11
    v_accvgpr_write_b32 a140, v11
    v_accvgpr_write_b32 a141, v11
    v_accvgpr_write_b32 a142, v11
    v_accvgpr_write_b32 a143, v11
    v_mov_b32 v8, 0
    v_accvgpr_write_b32 a24, v8
    v_accvgpr_write_b32 a25, v8
    v_accvgpr_write_b32 a26, v8
    v_accvgpr_write_b32 a27, v8
    v_accvgpr_write_b32 a28, v8
    v_accvgpr_write_b32 a29, v8
    v_accvgpr_write_b32 a30, v8
    v_accvgpr_write_b32 a31, v8
    v_accvgpr_write_b32 a32, v8
    v_accvgpr_write_b32 a33, v8
    v_accvgpr_write_b32 a34, v8
    v_accvgpr_write_b32 a35, v8
    v_accvgpr_write_b32 a36, v8
    v_accvgpr_write_b32 a37, v8
    v_accvgpr_write_b32 a38, v8
    v_accvgpr_write_b32 a39, v8
    v_accvgpr_write_b32 a40, v8
    v_accvgpr_write_b32 a41, v8
    v_accvgpr_write_b32 a42, v8
    v_accvgpr_write_b32 a43, v8
    v_accvgpr_write_b32 a44, v8
    v_accvgpr_write_b32 a45, v8
    v_accvgpr_write_b32 a46, v8
    v_accvgpr_write_b32 a47, v8
    v_accvgpr_write_b32 a48, v8
    v_accvgpr_write_b32 a49, v8
    v_accvgpr_write_b32 a50, v8
    v_accvgpr_write_b32 a51, v8
    v_accvgpr_write_b32 a52, v8
    v_accvgpr_write_b32 a53, v8
    v_accvgpr_write_b32 a54, v8
    v_accvgpr_write_b32 a55, v8
    v_accvgpr_write_b32 a56, v8
    v_accvgpr_write_b32 a57, v8
    v_accvgpr_write_b32 a58, v8
    v_accvgpr_write_b32 a59, v8
    v_accvgpr_write_b32 a60, v8
    v_accvgpr_write_b32 a61, v8
    v_accvgpr_write_b32 a62, v8
    v_accvgpr_write_b32 a63, v8
    v_accvgpr_write_b32 a64, v8
    v_accvgpr_write_b32 a65, v8
    v_accvgpr_write_b32 a66, v8
    v_accvgpr_write_b32 a67, v8
    v_accvgpr_write_b32 a68, v8
    v_accvgpr_write_b32 a69, v8
    v_accvgpr_write_b32 a70, v8
    v_accvgpr_write_b32 a71, v8
    v_accvgpr_write_b32 a72, v8
    v_accvgpr_write_b32 a73, v8
    v_accvgpr_write_b32 a74, v8
    v_accvgpr_write_b32 a75, v8
    v_accvgpr_write_b32 a76, v8
    v_accvgpr_write_b32 a77, v8
    v_accvgpr_write_b32 a78, v8
    v_accvgpr_write_b32 a79, v8
    v_accvgpr_write_b32 a80, v8
    v_accvgpr_write_b32 a81, v8
    v_accvgpr_write_b32 a82, v8
    v_accvgpr_write_b32 a83, v8
    v_accvgpr_write_b32 a84, v8
    v_accvgpr_write_b32 a85, v8
    v_accvgpr_write_b32 a86, v8
    v_accvgpr_write_b32 a87, v8
    v_mov_b32 v52, 0
    v_mov_b32 v53, 0
    v_mov_b32 v54, 0
    v_mov_b32 v55, 0
    s_add_u32 s82, s77, 1024
    s_mul_i32 s83, s16, 25600
    s_add_u32 s83, s83, 1024
    s_cmp_lg_u32 s16, 0
    s_cbranch_scc1 wa_done_8
    s_mul_i32 s84, s19, 5
    s_lshr_b32 s85, s84, 4
    s_add_u32 s84, s84, 4
    s_lshr_b32 s84, s84, 4
    s_mul_i32 s86, s17, 20
    s_lshr_b32 s87, s86, 7
    s_add_u32 s87, s87, 10
    s_add_u32 s86, s86, 19
    s_lshr_b32 s86, s86, 7
    s_add_u32 s86, s86, 10
    v_mov_b32 v250, s85
    v_writelane_b32 v250, s84, 1
    s_add_u32 s85, s85, 5
    s_add_u32 s84, s84, 5
    v_writelane_b32 v250, s85, 2
    v_writelane_b32 v250, s84, 3
    v_writelane_b32 v250, s87, 4
    v_writelane_b32 v250, s86, 5
    v_mov_b32 v252, 16
    v_lshlrev_b32 v250, 7, v250
    v_add_u32 v250, s97, v250
    s_lshr_b32 s84, s12, 2
    s_lshl_b32 s85, s84, 2
    s_lshr_b32 s86, s13, 3
    s_add_u32 s85, s85, s86
    s_lshl_b32 s84, s84, 3
    s_lshr_b32 s86, s13, 2
    s_add_u32 s84, s84, s86
    s_add_u32 s86, s85, 72
    s_lshl_b32 s86, s86, 7
    v_writelane_b32 v250, s86, 6
    s_add_u32 s86, s85, 80
    s_lshl_b32 s86, s86, 7
    v_writelane_b32 v250, s86, 7
    s_add_u32 s86, s84, 88
    s_lshl_b32 s86, s86, 7
    v_writelane_b32 v250, s86, 8
    v_writelane_b32 v252, 4, 6
    v_writelane_b32 v252, 14, 7
    s_cmp_lt_u32 s84, 14
    s_cselect_b32 s86, 8, 0
    v_writelane_b32 v252, s86, 8
    s_cmp_eq_u32 s14, 0
    s_mov_b32 s86, 0x3f
    s_cselect_b32 s86, 0x1ff, s86
    s_mov_b32 s87, 0
    s_mov_b32 s101, 0
    s_mov_b64 exec, s[86:87]
wa_poll_8:
    global_load_dword v251, v250, s[98:99] sc1
    s_add_u32 s101, s101, 1
    s_waitcnt vmcnt(0)
    v_cmp_le_u32 vcc, v252, v251
    s_cmp_ge_u32 s101, 262144
    s_cbranch_scc1 wa_ok_8
    s_cmp_eq_u64 vcc, exec
    s_cbranch_scc1 wa_ok_8
    s_sleep 1
    s_branch wa_poll_8
wa_ok_8:
    s_mov_b64 exec, -1
wa_done_8:
    s_barrier
    s_mov_b32 s53, s50
    s_mov_b32 s54, s51
    s_mov_b32 s55, s52
    buffer_load_dwordx4 a[88:91], v4, s[32:35], s53 offen sc1
    s_mov_b64 exec, s[24:25]
    buffer_load_dwordx2 a[92:93], v5, s[32:35], s55 offen sc1
    s_mov_b64 exec, -1
    buffer_load_dwordx4 a[0:3], v4, s[28:31], s46 offen offset:0 sc1
    s_mov_b64 exec, s[24:25]
    buffer_load_dwordx2 a[4:5], v5, s[28:31], s47 offen offset:0 sc1
    s_mov_b64 exec, -1
    buffer_load_dwordx4 a[6:9], v4, s[28:31], s46 offen offset:1024 sc1
    s_mov_b64 exec, s[24:25]
    buffer_load_dwordx2 a[10:11], v5, s[28:31], s47 offen offset:512 sc1
    s_mov_b64 exec, -1
    s_mov_b64 exec, s[26:27]
    buffer_load_dwordx4 a[112:115], v6, s[36:39], s54 offen sc1
    buffer_load_dwordx4 a[116:119], v6, s[36:39], s54 offen offset:640 sc1
    s_mov_b64 exec, -1
    buffer_load_dwordx4 a[12:15], v4, s[28:31], s46 offen offset:2048 sc1
    s_mov_b64 exec, s[24:25]
    buffer_load_dwordx2 a[16:17], v5, s[28:31], s47 offen offset:1024 sc1
    s_mov_b64 exec, -1
    buffer_load_dwordx4 a[18:21], v4, s[28:31], s46 offen offset:3072 sc1
    s_mov_b64 exec, s[24:25]
    buffer_load_dwordx2 a[22:23], v5, s[28:31], s47 offen offset:1536 sc1
    s_mov_b64 exec, -1
    s_add_u32 s53, s53, 1024
    s_add_u32 s54, s54, 1280
    s_add_u32 s55, s55, 512
    buffer_load_dwordx4 a[94:97], v4, s[32:35], s53 offen sc1
    s_mov_b64 exec, s[24:25]
    buffer_load_dwordx2 a[98:99], v5, s[32:35], s55 offen sc1
    s_mov_b64 exec, -1
    s_mov_b64 exec, s[26:27]
    buffer_load_dwordx4 a[120:123], v6, s[36:39], s54 offen sc1
    buffer_load_dwordx4 a[124:127], v6, s[36:39], s54 offen offset:640 sc1
    s_mov_b64 exec, -1
    s_add_u32 s53, s53, 1024
    s_add_u32 s54, s54, 1280
    s_add_u32 s55, s55, 512
    s_mul_i32 m0, s16, 25600
    s_mov_b32 s80, s77
    buffer_load_dwordx4 v249, s[72:75], s80 offen offset:0 sc1 lds
    s_waitcnt vmcnt(13)
    s_branch interleave_layers__mha_block__dense_activation_silu__prompt_kernel_att_go
interleave_layers__mha_block__dense_activation_silu__prompt_kernel_att_main:
    s_mov_b32 s53, s50
    s_mov_b32 s54, s51
    s_mov_b32 s55, s52
    buffer_load_dwordx4 a[88:91], v4, s[32:35], s53 offen sc1
    s_mov_b64 exec, s[24:25]
    buffer_load_dwordx2 a[92:93], v5, s[32:35], s55 offen sc1
    s_mov_b64 exec, -1
    s_mov_b64 exec, s[26:27]
    buffer_load_dwordx4 a[112:115], v6, s[36:39], s54 offen sc1
    buffer_load_dwordx4 a[116:119], v6, s[36:39], s54 offen offset:640 sc1
    s_mov_b64 exec, -1
    s_add_u32 s53, s53, 1024
    s_add_u32 s54, s54, 1280
    s_add_u32 s55, s55, 512
    buffer_load_dwordx4 a[94:97], v4, s[32:35], s53 offen sc1
    s_mov_b64 exec, s[24:25]
    buffer_load_dwordx2 a[98:99], v5, s[32:35], s55 offen sc1
    s_mov_b64 exec, -1
    s_mov_b64 exec, s[26:27]
    buffer_load_dwordx4 a[120:123], v6, s[36:39], s54 offen sc1
    buffer_load_dwordx4 a[124:127], v6, s[36:39], s54 offen offset:640 sc1
    s_mov_b64 exec, -1
    s_add_u32 s53, s53, 1024
    s_add_u32 s54, s54, 1280
    s_add_u32 s55, s55, 512
    v_mov_b32 v8, 0
    v_accvgpr_write_b32 a24, v8
    v_accvgpr_write_b32 a25, v8
    v_accvgpr_write_b32 a26, v8
    v_accvgpr_write_b32 a27, v8
    v_accvgpr_write_b32 a28, v8
    v_accvgpr_write_b32 a29, v8
    v_accvgpr_write_b32 a30, v8
    v_accvgpr_write_b32 a31, v8
    v_accvgpr_write_b32 a32, v8
    v_accvgpr_write_b32 a33, v8
    v_accvgpr_write_b32 a34, v8
    v_accvgpr_write_b32 a35, v8
    v_accvgpr_write_b32 a36, v8
    v_accvgpr_write_b32 a37, v8
    v_accvgpr_write_b32 a38, v8
    v_accvgpr_write_b32 a39, v8
    v_accvgpr_write_b32 a40, v8
    v_accvgpr_write_b32 a41, v8
    v_accvgpr_write_b32 a42, v8
    v_accvgpr_write_b32 a43, v8
    v_accvgpr_write_b32 a44, v8
    v_accvgpr_write_b32 a45, v8
    v_accvgpr_write_b32 a46, v8
    v_accvgpr_write_b32 a47, v8
    v_accvgpr_write_b32 a48, v8
    v_accvgpr_write_b32 a49, v8
    v_accvgpr_write_b32 a50, v8
    v_accvgpr_write_b32 a51, v8
    v_accvgpr_write_b32 a52, v8
    v_accvgpr_write_b32 a53, v8
    v_accvgpr_write_b32 a54, v8
    v_accvgpr_write_b32 a55, v8
    v_accvgpr_write_b32 a56, v8
    v_accvgpr_write_b32 a57, v8
    v_accvgpr_write_b32 a58, v8
    v_accvgpr_write_b32 a59, v8
    v_accvgpr_write_b32 a60, v8
    v_accvgpr_write_b32 a61, v8
    v_accvgpr_write_b32 a62, v8
    v_accvgpr_write_b32 a63, v8
    v_accvgpr_write_b32 a64, v8
    v_accvgpr_write_b32 a65, v8
    v_accvgpr_write_b32 a66, v8
    v_accvgpr_write_b32 a67, v8
    v_accvgpr_write_b32 a68, v8
    v_accvgpr_write_b32 a69, v8
    v_accvgpr_write_b32 a70, v8
    v_accvgpr_write_b32 a71, v8
    v_accvgpr_write_b32 a72, v8
    v_accvgpr_write_b32 a73, v8
    v_accvgpr_write_b32 a74, v8
    v_accvgpr_write_b32 a75, v8
    v_accvgpr_write_b32 a76, v8
    v_accvgpr_write_b32 a77, v8
    v_accvgpr_write_b32 a78, v8
    v_accvgpr_write_b32 a79, v8
    v_accvgpr_write_b32 a80, v8
    v_accvgpr_write_b32 a81, v8
    v_accvgpr_write_b32 a82, v8
    v_accvgpr_write_b32 a83, v8
    v_accvgpr_write_b32 a84, v8
    v_accvgpr_write_b32 a85, v8
    v_accvgpr_write_b32 a86, v8
    v_accvgpr_write_b32 a87, v8
    v_mov_b32 v52, 0
    v_mov_b32 v53, 0
    v_mov_b32 v54, 0
    v_mov_b32 v55, 0
    s_add_u32 s82, s77, 1024
    s_mul_i32 s83, s16, 25600
    s_add_u32 s83, s83, 1024
    s_waitcnt vmcnt(4)
interleave_layers__mha_block__dense_activation_silu__prompt_kernel_att_go:
    v_mfma_f32_32x32x16_bf16 v[16:31], a[88:91], a[0:3], 0
    v_mfma_f32_32x32x8_bf16 v[16:31], a[92:93], a[4:5], v[16:31]
    s_waitcnt vmcnt(5)
    s_mov_b32 s56, 8
    s_nop 7
    s_nop 2
.p2align 6
interleave_layers__mha_block__dense_activation_silu__prompt_kernel_att_loop:
    v_mfma_f32_32x32x16_bf16 v[32:47], a[88:91], a[6:9], 0
    buffer_load_dwordx4 a[100:103], v4, s[32:35], s53 offen sc1
    v_exp_f32 v16, v16
    v_exp_f32 v17, v17
    v_exp_f32 v18, v18
    v_exp_f32 v19, v19
    v_cvt_pk_bf16_f32 v48, v16, v17
    v_cvt_pk_bf16_f32 v49, v18, v19
    v_mfma_f32_32x32x8_bf16 v[32:47], a[92:93], a[10:11], v[32:47]
    s_mov_b64 exec, s[24:25]
    buffer_load_dwordx2 a[104:105], v5, s[32:35], s55 offen sc1
    s_mov_b64 exec, -1
    v_exp_f32 v20, v20
    v_exp_f32 v21, v21
    v_exp_f32 v22, v22
    v_exp_f32 v23, v23
    v_cvt_pk_bf16_f32 v50, v20, v21
    v_cvt_pk_bf16_f32 v51, v22, v23
    v_mfma_f32_32x32x16_bf16 a[72:87], a[140:143], v[52:55], a[72:87]
    s_mov_b64 exec, s[26:27]
    buffer_load_dwordx4 a[128:131], v6, s[36:39], s54 offen sc1
    buffer_load_dwordx4 a[132:135], v6, s[36:39], s54 offen offset:640 sc1
    s_mov_b64 exec, -1
    v_exp_f32 v24, v24
    v_exp_f32 v25, v25
    v_exp_f32 v26, v26
    v_exp_f32 v27, v27
    v_cvt_pk_bf16_f32 v52, v24, v25
    v_cvt_pk_bf16_f32 v53, v26, v27
    v_mfma_f32_32x32x16_bf16 a[24:39], a[112:115], v[48:51], a[24:39]
    s_add_u32 s53, s53, 1024
    v_exp_f32 v28, v28
    v_exp_f32 v29, v29
    v_exp_f32 v30, v30
    v_exp_f32 v31, v31
    v_cvt_pk_bf16_f32 v54, v28, v29
    v_cvt_pk_bf16_f32 v55, v30, v31
    v_mfma_f32_32x32x16_bf16 v[16:31], a[88:91], a[12:15], 0
    s_add_u32 s54, s54, 1280
    v_exp_f32 v32, v32
    v_exp_f32 v33, v33
    v_exp_f32 v34, v34
    v_exp_f32 v35, v35
    v_cvt_pk_bf16_f32 v48, v32, v33
    v_cvt_pk_bf16_f32 v49, v34, v35
    v_mfma_f32_32x32x8_bf16 v[16:31], a[92:93], a[16:17], v[16:31]
    s_add_u32 s55, s55, 512
    v_exp_f32 v36, v36
    v_exp_f32 v37, v37
    v_exp_f32 v38, v38
    v_exp_f32 v39, v39
    v_cvt_pk_bf16_f32 v50, v36, v37
    v_cvt_pk_bf16_f32 v51, v38, v39
    v_mfma_f32_32x32x16_bf16 a[24:39], a[116:119], v[52:55], a[24:39]
    v_exp_f32 v40, v40
    v_exp_f32 v41, v41
    v_exp_f32 v42, v42
    v_exp_f32 v43, v43
    v_cvt_pk_bf16_f32 v52, v40, v41
    v_cvt_pk_bf16_f32 v53, v42, v43
    v_mfma_f32_32x32x16_bf16 a[40:55], a[112:115], v[48:51], a[40:55]
    v_exp_f32 v44, v44
    v_exp_f32 v45, v45
    v_exp_f32 v46, v46
    v_exp_f32 v47, v47
    v_cvt_pk_bf16_f32 v54, v44, v45
    v_cvt_pk_bf16_f32 v55, v46, v47
    v_mfma_f32_32x32x16_bf16 v[32:47], a[88:91], a[18:21], 0
    v_exp_f32 v16, v16
    v_exp_f32 v17, v17
    v_exp_f32 v18, v18
    v_exp_f32 v19, v19
    v_cvt_pk_bf16_f32 v48, v16, v17
    v_cvt_pk_bf16_f32 v49, v18, v19
    v_mfma_f32_32x32x8_bf16 v[32:47], a[92:93], a[22:23], v[32:47]
    v_exp_f32 v20, v20
    v_exp_f32 v21, v21
    v_exp_f32 v22, v22
    v_exp_f32 v23, v23
    v_cvt_pk_bf16_f32 v50, v20, v21
    v_cvt_pk_bf16_f32 v51, v22, v23
    v_mfma_f32_32x32x16_bf16 a[40:55], a[116:119], v[52:55], a[40:55]
    v_exp_f32 v24, v24
    v_exp_f32 v25, v25
    v_exp_f32 v26, v26
    v_exp_f32 v27, v27
    v_cvt_pk_bf16_f32 v52, v24, v25
    v_cvt_pk_bf16_f32 v53, v26, v27
    v_mfma_f32_32x32x16_bf16 a[56:71], a[112:115], v[48:51], a[56:71]
    s_waitcnt vmcnt(4)
    v_exp_f32 v28, v28
    v_exp_f32 v29, v29
    v_exp_f32 v30, v30
    v_exp_f32 v31, v31
    v_cvt_pk_bf16_f32 v54, v28, v29
    v_cvt_pk_bf16_f32 v55, v30, v31
    v_mfma_f32_32x32x16_bf16 v[16:31], a[94:97], a[0:3], 0
    v_exp_f32 v32, v32
    v_exp_f32 v33, v33
    v_exp_f32 v34, v34
    v_exp_f32 v35, v35
    v_cvt_pk_bf16_f32 v48, v32, v33
    v_cvt_pk_bf16_f32 v49, v34, v35
    v_mfma_f32_32x32x8_bf16 v[16:31], a[98:99], a[4:5], v[16:31]
    v_exp_f32 v36, v36
    v_exp_f32 v37, v37
    v_exp_f32 v38, v38
    v_exp_f32 v39, v39
    v_cvt_pk_bf16_f32 v50, v36, v37
    v_cvt_pk_bf16_f32 v51, v38, v39
    v_mfma_f32_32x32x16_bf16 a[56:71], a[116:119], v[52:55], a[56:71]
    v_exp_f32 v40, v40
    v_exp_f32 v41, v41
    v_exp_f32 v42, v42
    v_exp_f32 v43, v43
    v_cvt_pk_bf16_f32 v52, v40, v41
    v_cvt_pk_bf16_f32 v53, v42, v43
    v_mfma_f32_32x32x16_bf16 a[72:87], a[112:115], v[48:51], a[72:87]
    v_exp_f32 v44, v44
    v_exp_f32 v45, v45
    v_exp_f32 v46, v46
    v_exp_f32 v47, v47
    v_cvt_pk_bf16_f32 v54, v44, v45
    v_cvt_pk_bf16_f32 v55, v46, v47
    v_mfma_f32_32x32x16_bf16 v[32:47], a[94:97], a[6:9], 0
    buffer_load_dwordx4 a[106:109], v4, s[32:35], s53 offen sc1
    v_exp_f32 v16, v16
    v_exp_f32 v17, v17
    v_exp_f32 v18, v18
    v_exp_f32 v19, v19
    v_cvt_pk_bf16_f32 v48, v16, v17
    v_cvt_pk_bf16_f32 v49, v18, v19
    v_mfma_f32_32x32x8_bf16 v[32:47], a[98:99], a[10:11], v[32:47]
    s_mov_b64 exec, s[24:25]
    buffer_load_dwordx2 a[110:111], v5, s[32:35], s55 offen sc1
    s_mov_b64 exec, -1
    v_exp_f32 v20, v20
    v_exp_f32 v21, v21
    v_exp_f32 v22, v22
    v_exp_f32 v23, v23
    v_cvt_pk_bf16_f32 v50, v20, v21
    v_cvt_pk_bf16_f32 v51, v22, v23
    v_mfma_f32_32x32x16_bf16 a[72:87], a[116:119], v[52:55], a[72:87]
    s_mov_b64 exec, s[26:27]
    buffer_load_dwordx4 a[136:139], v6, s[36:39], s54 offen sc1
    buffer_load_dwordx4 a[140:143], v6, s[36:39], s54 offen offset:640 sc1
    s_mov_b64 exec, -1
    v_exp_f32 v24, v24
    v_exp_f32 v25, v25
    v_exp_f32 v26, v26
    v_exp_f32 v27, v27
    v_cvt_pk_bf16_f32 v52, v24, v25
    v_cvt_pk_bf16_f32 v53, v26, v27
    v_mfma_f32_32x32x16_bf16 a[24:39], a[120:123], v[48:51], a[24:39]
    s_add_u32 s53, s53, 1024
    v_exp_f32 v28, v28
    v_exp_f32 v29, v29
    v_exp_f32 v30, v30
    v_exp_f32 v31, v31
    v_cvt_pk_bf16_f32 v54, v28, v29
    v_cvt_pk_bf16_f32 v55, v30, v31
    v_mfma_f32_32x32x16_bf16 v[16:31], a[94:97], a[12:15], 0
    s_add_u32 s54, s54, 1280
    v_exp_f32 v32, v32
    v_exp_f32 v33, v33
    v_exp_f32 v34, v34
    v_exp_f32 v35, v35
    v_cvt_pk_bf16_f32 v48, v32, v33
    v_cvt_pk_bf16_f32 v49, v34, v35
    v_mfma_f32_32x32x8_bf16 v[16:31], a[98:99], a[16:17], v[16:31]
    s_add_u32 s55, s55, 512
    v_exp_f32 v36, v36
    v_exp_f32 v37, v37
    v_exp_f32 v38, v38
    v_exp_f32 v39, v39
    v_cvt_pk_bf16_f32 v50, v36, v37
    v_cvt_pk_bf16_f32 v51, v38, v39
    v_mfma_f32_32x32x16_bf16 a[24:39], a[124:127], v[52:55], a[24:39]
    s_mov_b32 m0, s83
    v_exp_f32 v40, v40
    v_exp_f32 v41, v41
    v_exp_f32 v42, v42
    v_exp_f32 v43, v43
    v_cvt_pk_bf16_f32 v52, v40, v41
    v_cvt_pk_bf16_f32 v53, v42, v43
    v_mfma_f32_32x32x16_bf16 a[40:55], a[120:123], v[48:51], a[40:55]
    buffer_load_dwordx4 v249, s[72:75], s82 offen offset:0 sc1 lds
    v_exp_f32 v44, v44
    v_exp_f32 v45, v45
    v_exp_f32 v46, v46
    v_exp_f32 v47, v47
    v_cvt_pk_bf16_f32 v54, v44, v45
    v_cvt_pk_bf16_f32 v55, v46, v47
    v_mfma_f32_32x32x16_bf16 v[32:47], a[94:97], a[18:21], 0
    buffer_load_dwordx4 v249, s[72:75], s82 offen offset:1024 sc1 lds
    v_exp_f32 v16, v16
    v_exp_f32 v17, v17
    v_exp_f32 v18, v18
    v_exp_f32 v19, v19
    v_cvt_pk_bf16_f32 v48, v16, v17
    v_cvt_pk_bf16_f32 v49, v18, v19
    v_mfma_f32_32x32x8_bf16 v[32:47], a[98:99], a[22:23], v[32:47]
    buffer_load_dwordx4 v249, s[72:75], s82 offen offset:2048 sc1 lds
    v_exp_f32 v20, v20
    v_exp_f32 v21, v21
    v_exp_f32 v22, v22
    v_exp_f32 v23, v23
    v_cvt_pk_bf16_f32 v50, v20, v21
    v_cvt_pk_bf16_f32 v51, v22, v23
    v_mfma_f32_32x32x16_bf16 a[40:55], a[124:127], v[52:55], a[40:55]
    v_exp_f32 v24, v24
    v_exp_f32 v25, v25
    v_exp_f32 v26, v26
    v_exp_f32 v27, v27
    v_cvt_pk_bf16_f32 v52, v24, v25
    v_cvt_pk_bf16_f32 v53, v26, v27
    v_mfma_f32_32x32x16_bf16 a[56:71], a[120:123], v[48:51], a[56:71]
    s_waitcnt vmcnt(7)
    v_exp_f32 v28, v28
    v_exp_f32 v29, v29
    v_exp_f32 v30, v30
    v_exp_f32 v31, v31
    v_cvt_pk_bf16_f32 v54, v28, v29
    v_cvt_pk_bf16_f32 v55, v30, v31
    v_mfma_f32_32x32x16_bf16 v[16:31], a[100:103], a[0:3], 0
    s_add_u32 s82, s82, 3072
    v_exp_f32 v32, v32
    v_exp_f32 v33, v33
    v_exp_f32 v34, v34
    v_exp_f32 v35, v35
    v_cvt_pk_bf16_f32 v48, v32, v33
    v_cvt_pk_bf16_f32 v49, v34, v35
    v_mfma_f32_32x32x8_bf16 v[16:31], a[104:105], a[4:5], v[16:31]
    s_add_u32 s83, s83, 3072
    v_exp_f32 v36, v36
    v_exp_f32 v37, v37
    v_exp_f32 v38, v38
    v_exp_f32 v39, v39
    v_cvt_pk_bf16_f32 v50, v36, v37
    v_cvt_pk_bf16_f32 v51, v38, v39
    v_mfma_f32_32x32x16_bf16 a[56:71], a[124:127], v[52:55], a[56:71]
    v_exp_f32 v40, v40
    v_exp_f32 v41, v41
    v_exp_f32 v42, v42
    v_exp_f32 v43, v43
    v_cvt_pk_bf16_f32 v52, v40, v41
    v_cvt_pk_bf16_f32 v53, v42, v43
    v_mfma_f32_32x32x16_bf16 a[72:87], a[120:123], v[48:51], a[72:87]
    v_exp_f32 v44, v44
    v_exp_f32 v45, v45
    v_exp_f32 v46, v46
    v_exp_f32 v47, v47
    v_cvt_pk_bf16_f32 v54, v44, v45
    v_cvt_pk_bf16_f32 v55, v46, v47
    v_mfma_f32_32x32x16_bf16 v[32:47], a[100:103], a[6:9], 0
    buffer_load_dwordx4 a[88:91], v4, s[32:35], s53 offen sc1
    v_exp_f32 v16, v16
    v_exp_f32 v17, v17
    v_exp_f32 v18, v18
    v_exp_f32 v19, v19
    v_cvt_pk_bf16_f32 v48, v16, v17
    v_cvt_pk_bf16_f32 v49, v18, v19
    v_mfma_f32_32x32x8_bf16 v[32:47], a[104:105], a[10:11], v[32:47]
    s_mov_b64 exec, s[24:25]
    buffer_load_dwordx2 a[92:93], v5, s[32:35], s55 offen sc1
    s_mov_b64 exec, -1
    v_exp_f32 v20, v20
    v_exp_f32 v21, v21
    v_exp_f32 v22, v22
    v_exp_f32 v23, v23
    v_cvt_pk_bf16_f32 v50, v20, v21
    v_cvt_pk_bf16_f32 v51, v22, v23
    v_mfma_f32_32x32x16_bf16 a[72:87], a[124:127], v[52:55], a[72:87]
    s_mov_b64 exec, s[26:27]
    buffer_load_dwordx4 a[112:115], v6, s[36:39], s54 offen sc1
    buffer_load_dwordx4 a[116:119], v6, s[36:39], s54 offen offset:640 sc1
    s_mov_b64 exec, -1
    v_exp_f32 v24, v24
    v_exp_f32 v25, v25
    v_exp_f32 v26, v26
    v_exp_f32 v27, v27
    v_cvt_pk_bf16_f32 v52, v24, v25
    v_cvt_pk_bf16_f32 v53, v26, v27
    v_mfma_f32_32x32x16_bf16 a[24:39], a[128:131], v[48:51], a[24:39]
    s_add_u32 s53, s53, 1024
    v_exp_f32 v28, v28
    v_exp_f32 v29, v29
    v_exp_f32 v30, v30
    v_exp_f32 v31, v31
    v_cvt_pk_bf16_f32 v54, v28, v29
    v_cvt_pk_bf16_f32 v55, v30, v31
    v_mfma_f32_32x32x16_bf16 v[16:31], a[100:103], a[12:15], 0
    s_add_u32 s54, s54, 1280
    v_exp_f32 v32, v32
    v_exp_f32 v33, v33
    v_exp_f32 v34, v34
    v_exp_f32 v35, v35
    v_cvt_pk_bf16_f32 v48, v32, v33
    v_cvt_pk_bf16_f32 v49, v34, v35
    v_mfma_f32_32x32x8_bf16 v[16:31], a[104:105], a[16:17], v[16:31]
    s_add_u32 s55, s55, 512
    v_exp_f32 v36, v36
    v_exp_f32 v37, v37
    v_exp_f32 v38, v38
    v_exp_f32 v39, v39
    v_cvt_pk_bf16_f32 v50, v36, v37
    v_cvt_pk_bf16_f32 v51, v38, v39
    v_mfma_f32_32x32x16_bf16 a[24:39], a[132:135], v[52:55], a[24:39]
    v_exp_f32 v40, v40
    v_exp_f32 v41, v41
    v_exp_f32 v42, v42
    v_exp_f32 v43, v43
    v_cvt_pk_bf16_f32 v52, v40, v41
    v_cvt_pk_bf16_f32 v53, v42, v43
    v_mfma_f32_32x32x16_bf16 a[40:55], a[128:131], v[48:51], a[40:55]
    v_exp_f32 v44, v44
    v_exp_f32 v45, v45
    v_exp_f32 v46, v46
    v_exp_f32 v47, v47
    v_cvt_pk_bf16_f32 v54, v44, v45
    v_cvt_pk_bf16_f32 v55, v46, v47
    v_mfma_f32_32x32x16_bf16 v[32:47], a[100:103], a[18:21], 0
    v_exp_f32 v16, v16
    v_exp_f32 v17, v17
    v_exp_f32 v18, v18
    v_exp_f32 v19, v19
    v_cvt_pk_bf16_f32 v48, v16, v17
    v_cvt_pk_bf16_f32 v49, v18, v19
    v_mfma_f32_32x32x8_bf16 v[32:47], a[104:105], a[22:23], v[32:47]
    v_exp_f32 v20, v20
    v_exp_f32 v21, v21
    v_exp_f32 v22, v22
    v_exp_f32 v23, v23
    v_cvt_pk_bf16_f32 v50, v20, v21
    v_cvt_pk_bf16_f32 v51, v22, v23
    v_mfma_f32_32x32x16_bf16 a[40:55], a[132:135], v[52:55], a[40:55]
    v_exp_f32 v24, v24
    v_exp_f32 v25, v25
    v_exp_f32 v26, v26
    v_exp_f32 v27, v27
    v_cvt_pk_bf16_f32 v52, v24, v25
    v_cvt_pk_bf16_f32 v53, v26, v27
    v_mfma_f32_32x32x16_bf16 a[56:71], a[128:131], v[48:51], a[56:71]
    s_waitcnt vmcnt(7)
    v_exp_f32 v28, v28
    v_exp_f32 v29, v29
    v_exp_f32 v30, v30
    v_exp_f32 v31, v31
    v_cvt_pk_bf16_f32 v54, v28, v29
    v_cvt_pk_bf16_f32 v55, v30, v31
    v_mfma_f32_32x32x16_bf16 v[16:31], a[106:109], a[0:3], 0
    v_exp_f32 v32, v32
    v_exp_f32 v33, v33
    v_exp_f32 v34, v34
    v_exp_f32 v35, v35
    v_cvt_pk_bf16_f32 v48, v32, v33
    v_cvt_pk_bf16_f32 v49, v34, v35
    v_mfma_f32_32x32x8_bf16 v[16:31], a[110:111], a[4:5], v[16:31]
    v_exp_f32 v36, v36
    v_exp_f32 v37, v37
    v_exp_f32 v38, v38
    v_exp_f32 v39, v39
    v_cvt_pk_bf16_f32 v50, v36, v37
    v_cvt_pk_bf16_f32 v51, v38, v39
    v_mfma_f32_32x32x16_bf16 a[56:71], a[132:135], v[52:55], a[56:71]
    v_exp_f32 v40, v40
    v_exp_f32 v41, v41
    v_exp_f32 v42, v42
    v_exp_f32 v43, v43
    v_cvt_pk_bf16_f32 v52, v40, v41
    v_cvt_pk_bf16_f32 v53, v42, v43
    v_mfma_f32_32x32x16_bf16 a[72:87], a[128:131], v[48:51], a[72:87]
    v_exp_f32 v44, v44
    v_exp_f32 v45, v45
    v_exp_f32 v46, v46
    v_exp_f32 v47, v47
    v_cvt_pk_bf16_f32 v54, v44, v45
    v_cvt_pk_bf16_f32 v55, v46, v47
    v_mfma_f32_32x32x16_bf16 v[32:47], a[106:109], a[6:9], 0
    buffer_load_dwordx4 a[94:97], v4, s[32:35], s53 offen sc1
    v_exp_f32 v16, v16
    v_exp_f32 v17, v17
    v_exp_f32 v18, v18
    v_exp_f32 v19, v19
    v_cvt_pk_bf16_f32 v48, v16, v17
    v_cvt_pk_bf16_f32 v49, v18, v19
    v_mfma_f32_32x32x8_bf16 v[32:47], a[110:111], a[10:11], v[32:47]
    s_mov_b64 exec, s[24:25]
    buffer_load_dwordx2 a[98:99], v5, s[32:35], s55 offen sc1
    s_mov_b64 exec, -1
    v_exp_f32 v20, v20
    v_exp_f32 v21, v21
    v_exp_f32 v22, v22
    v_exp_f32 v23, v23
    v_cvt_pk_bf16_f32 v50, v20, v21
    v_cvt_pk_bf16_f32 v51, v22, v23
    v_mfma_f32_32x32x16_bf16 a[72:87], a[132:135], v[52:55], a[72:87]
    s_mov_b64 exec, s[26:27]
    buffer_load_dwordx4 a[120:123], v6, s[36:39], s54 offen sc1
    buffer_load_dwordx4 a[124:127], v6, s[36:39], s54 offen offset:640 sc1
    s_mov_b64 exec, -1
    v_exp_f32 v24, v24
    v_exp_f32 v25, v25
    v_exp_f32 v26, v26
    v_exp_f32 v27, v27
    v_cvt_pk_bf16_f32 v52, v24, v25
    v_cvt_pk_bf16_f32 v53, v26, v27
    v_mfma_f32_32x32x16_bf16 a[24:39], a[136:139], v[48:51], a[24:39]
    s_add_u32 s53, s53, 1024
    v_exp_f32 v28, v28
    v_exp_f32 v29, v29
    v_exp_f32 v30, v30
    v_exp_f32 v31, v31
    v_cvt_pk_bf16_f32 v54, v28, v29
    v_cvt_pk_bf16_f32 v55, v30, v31
    v_mfma_f32_32x32x16_bf16 v[16:31], a[106:109], a[12:15], 0
    s_add_u32 s54, s54, 1280
    v_exp_f32 v32, v32
    v_exp_f32 v33, v33
    v_exp_f32 v34, v34
    v_exp_f32 v35, v35
    v_cvt_pk_bf16_f32 v48, v32, v33
    v_cvt_pk_bf16_f32 v49, v34, v35
    v_mfma_f32_32x32x8_bf16 v[16:31], a[110:111], a[16:17], v[16:31]
    s_add_u32 s55, s55, 512
    v_exp_f32 v36, v36
    v_exp_f32 v37, v37
    v_exp_f32 v38, v38
    v_exp_f32 v39, v39
    v_cvt_pk_bf16_f32 v50, v36, v37
    v_cvt_pk_bf16_f32 v51, v38, v39
    v_mfma_f32_32x32x16_bf16 a[24:39], a[140:143], v[52:55], a[24:39]
    v_exp_f32 v40, v40
    v_exp_f32 v41, v41
    v_exp_f32 v42, v42
    v_exp_f32 v43, v43
    v_cvt_pk_bf16_f32 v52, v40, v41
    v_cvt_pk_bf16_f32 v53, v42, v43
    v_mfma_f32_32x32x16_bf16 a[40:55], a[136:139], v[48:51], a[40:55]
    v_exp_f32 v44, v44
    v_exp_f32 v45, v45
    v_exp_f32 v46, v46
    v_exp_f32 v47, v47
    v_cvt_pk_bf16_f32 v54, v44, v45
    v_cvt_pk_bf16_f32 v55, v46, v47
    v_mfma_f32_32x32x16_bf16 v[32:47], a[106:109], a[18:21], 0
    v_exp_f32 v16, v16
    v_exp_f32 v17, v17
    v_exp_f32 v18, v18
    v_exp_f32 v19, v19
    v_cvt_pk_bf16_f32 v48, v16, v17
    v_cvt_pk_bf16_f32 v49, v18, v19
    v_mfma_f32_32x32x8_bf16 v[32:47], a[110:111], a[22:23], v[32:47]
    v_exp_f32 v20, v20
    v_exp_f32 v21, v21
    v_exp_f32 v22, v22
    v_exp_f32 v23, v23
    v_cvt_pk_bf16_f32 v50, v20, v21
    v_cvt_pk_bf16_f32 v51, v22, v23
    v_mfma_f32_32x32x16_bf16 a[40:55], a[140:143], v[52:55], a[40:55]
    v_exp_f32 v24, v24
    v_exp_f32 v25, v25
    v_exp_f32 v26, v26
    v_exp_f32 v27, v27
    v_cvt_pk_bf16_f32 v52, v24, v25
    v_cvt_pk_bf16_f32 v53, v26, v27
    v_mfma_f32_32x32x16_bf16 a[56:71], a[136:139], v[48:51], a[56:71]
    s_waitcnt vmcnt(4)
    v_exp_f32 v28, v28
    v_exp_f32 v29, v29
    v_exp_f32 v30, v30
    v_exp_f32 v31, v31
    v_cvt_pk_bf16_f32 v54, v28, v29
    v_cvt_pk_bf16_f32 v55, v30, v31
    v_mfma_f32_32x32x16_bf16 v[16:31], a[88:91], a[0:3], 0
    s_sub_u32 s56, s56, 1
    v_exp_f32 v32, v32
    v_exp_f32 v33, v33
    v_exp_f32 v34, v34
    v_exp_f32 v35, v35
    v_cvt_pk_bf16_f32 v48, v32, v33
    v_cvt_pk_bf16_f32 v49, v34, v35
    v_mfma_f32_32x32x8_bf16 v[16:31], a[92:93], a[4:5], v[16:31]
    v_exp_f32 v36, v36
    v_exp_f32 v37, v37
    v_exp_f32 v38, v38
    v_exp_f32 v39, v39
    v_cvt_pk_bf16_f32 v50, v36, v37
    v_cvt_pk_bf16_f32 v51, v38, v39
    v_mfma_f32_32x32x16_bf16 a[56:71], a[140:143], v[52:55], a[56:71]
    v_exp_f32 v40, v40
    v_exp_f32 v41, v41
    v_exp_f32 v42, v42
    v_exp_f32 v43, v43
    v_cvt_pk_bf16_f32 v52, v40, v41
    v_cvt_pk_bf16_f32 v53, v42, v43
    v_mfma_f32_32x32x16_bf16 a[72:87], a[136:139], v[48:51], a[72:87]
    s_cmp_lg_u32 s56, 0
    v_exp_f32 v44, v44
    v_exp_f32 v45, v45
    v_exp_f32 v46, v46
    v_exp_f32 v47, v47
    v_cvt_pk_bf16_f32 v54, v44, v45
    v_cvt_pk_bf16_f32 v55, v46, v47
    s_cbranch_scc1 interleave_layers__mha_block__dense_activation_silu__prompt_kernel_att_loop
    s_nop 1
    v_mfma_f32_32x32x16_bf16 a[72:87], a[140:143], v[52:55], a[72:87]
    s_mul_i32 s57, s16, 6144
    s_add_u32 s57, s57, 102400
    v_add_u32 v8, s57, v4
    s_xor_b32 s58, s16, 2
    s_mul_i32 s58, s58, 6144
    s_add_u32 s58, s58, 102400
    v_add_u32 v9, s58, v4
    s_cmp_eq_u32 s69, 0
    s_nop 7
    s_cbranch_scc1 interleave_layers__mha_block__dense_activation_silu__prompt_kernel_att_x0
    ds_write_b128 v8, a[24:27] offset:0
    ds_write_b128 v8, a[28:31] offset:1024
    ds_write_b128 v8, a[32:35] offset:2048
    ds_write_b128 v8, a[40:43] offset:3072
    ds_write_b128 v8, a[44:47] offset:4096
    ds_write_b128 v8, a[48:51] offset:5120
    v_accvgpr_read_b32 v56, a56
    v_accvgpr_read_b32 v57, a57
    v_accvgpr_read_b32 v58, a58
    v_accvgpr_read_b32 v59, a59
    v_accvgpr_read_b32 v60, a60
    v_accvgpr_read_b32 v61, a61
    v_accvgpr_read_b32 v62, a62
    v_accvgpr_read_b32 v63, a63
    v_accvgpr_read_b32 v64, a64
    v_accvgpr_read_b32 v65, a65
    v_accvgpr_read_b32 v66, a66
    v_accvgpr_read_b32 v67, a67
    v_accvgpr_read_b32 v68, a72
    v_accvgpr_read_b32 v69, a73
    v_accvgpr_read_b32 v70, a74
    v_accvgpr_read_b32 v71, a75
    v_accvgpr_read_b32 v72, a76
    v_accvgpr_read_b32 v73, a77
    v_accvgpr_read_b32 v74, a78
    v_accvgpr_read_b32 v75, a79
    v_accvgpr_read_b32 v76, a80
    v_accvgpr_read_b32 v77, a81
    v_accvgpr_read_b32 v78, a82
    v_accvgpr_read_b32 v79, a83
    s_branch interleave_layers__mha_block__dense_activation_silu__prompt_kernel_att_x1
interleave_layers__mha_block__dense_activation_silu__prompt_kernel_att_x0:
    ds_write_b128 v8, a[56:59] offset:0
    ds_write_b128 v8, a[60:63] offset:1024
    ds_write_b128 v8, a[64:67] offset:2048
    ds_write_b128 v8, a[72:75] offset:3072
    ds_write_b128 v8, a[76:79] offset:4096
    ds_write_b128 v8, a[80:83] offset:5120
    v_accvgpr_read_b32 v56, a24
    v_accvgpr_read_b32 v57, a25
    v_accvgpr_read_b32 v58, a26
    v_accvgpr_read_b32 v59, a27
    v_accvgpr_read_b32 v60, a28
    v_accvgpr_read_b32 v61, a29
    v_accvgpr_read_b32 v62, a30
    v_accvgpr_read_b32 v63, a31
    v_accvgpr_read_b32 v64, a32
    v_accvgpr_read_b32 v65, a33
    v_accvgpr_read_b32 v66, a34
    v_accvgpr_read_b32 v67, a35
    v_accvgpr_read_b32 v68, a40
    v_accvgpr_read_b32 v69, a41
    v_accvgpr_read_b32 v70, a42
    v_accvgpr_read_b32 v71, a43
    v_accvgpr_read_b32 v72, a44
    v_accvgpr_read_b32 v73, a45
    v_accvgpr_read_b32 v74, a46
    v_accvgpr_read_b32 v75, a47
    v_accvgpr_read_b32 v76, a48
    v_accvgpr_read_b32 v77, a49
    v_accvgpr_read_b32 v78, a50
    v_accvgpr_read_b32 v79, a51
interleave_layers__mha_block__dense_activation_silu__prompt_kernel_att_x1:
    s_waitcnt lgkmcnt(0)
    s_barrier
    ds_read_b128 v[80:83], v9 offset:0
    ds_read_b128 v[84:87], v9 offset:1024
    ds_read_b128 v[88:91], v9 offset:2048
    ds_read_b128 v[92:95], v9 offset:3072
    ds_read_b128 v[96:99], v9 offset:4096
    ds_read_b128 v[100:103], v9 offset:5120
    s_mul_i32 s57, s19, 5
    s_lshl_b32 s58, s20, 1
    s_add_u32 s58, s58, s57
    v_add_u32 v134, s58, v3
    v_mul_u32_u24 v134, 32768, v134
    v_lshl_add_u32 v134, v2, 4, v134
    s_add_u32 s57, s57, 4
    s_mul_i32 s57, s57, 32768
    s_lshl_b32 s58, s69, 1
    s_add_u32 s58, s58, s45
    s_lshl_b32 s58, s58, 9
    s_add_u32 s57, s57, s58
    v_cmp_eq_u32 vcc, 0, v3
    s_waitcnt lgkmcnt(0)
    v_pk_add_f32 v[56:57], v[56:57], v[80:81]
    v_pk_add_f32 v[58:59], v[58:59], v[82:83]
    v_pk_add_f32 v[60:61], v[60:61], v[84:85]
    v_pk_add_f32 v[62:63], v[62:63], v[86:87]
    v_pk_add_f32 v[64:65], v[64:65], v[88:89]
    v_pk_add_f32 v[66:67], v[66:67], v[90:91]
    v_mov_b32 v128, v64
    v_mov_b32 v129, v64
    v_add_f32 v131, abs(v56), abs(v57)
    v_add_f32 v132, abs(v64), abs(v65)
    v_permlane32_swap_b32 v128, v129
    v_rcp_f32 v130, v129
    v_add_f32 v131, v131, abs(v58)
    v_add_f32 v131, v131, abs(v59)
    v_add_f32 v131, v131, abs(v60)
    v_add_f32 v131, v131, abs(v61)
    v_add_f32 v131, v131, abs(v62)
    v_add_f32 v131, v131, abs(v63)
    v_add_f32 v132, v132, abs(v66)
    v_add_f32 v132, v132, abs(v67)
    v_cndmask_b32 v132, 0, v132, vcc
    v_add_f32 v131, v131, v132
    s_mov_b32 s59, 0x7f000000
    v_cmp_ngt_f32 s[60:61], s59, v131
    s_mov_b32 s59, 0x21800000
    v_cmp_nle_f32 s[62:63], s59, v129
    s_mov_b32 s59, 0x5d800000
    v_cmp_nge_f32 s[64:65], s59, v129
    v_pk_mul_f32 v[56:57], v[56:57], v[130:131] op_sel_hi:[1,0]
    v_pk_mul_f32 v[58:59], v[58:59], v[130:131] op_sel_hi:[1,0]
    v_pk_mul_f32 v[60:61], v[60:61], v[130:131] op_sel_hi:[1,0]
    v_pk_mul_f32 v[62:63], v[62:63], v[130:131] op_sel_hi:[1,0]
    v_pk_mul_f32 v[64:65], v[64:65], v[130:131] op_sel_hi:[1,0]
    v_pk_mul_f32 v[66:67], v[66:67], v[130:131] op_sel_hi:[1,0]
    s_or_b64 s[60:61], s[60:61], s[62:63]
    s_or_b64 s[60:61], s[60:61], s[64:65]
    s_mov_b64 s[66:67], s[60:61]
    v_cvt_pk_bf16_f32 v104, v56, v57
    v_cvt_pk_bf16_f32 v105, v58, v59
    v_cvt_pk_bf16_f32 v106, v60, v61
    v_cvt_pk_bf16_f32 v107, v62, v63
    v_cvt_pk_bf16_f32 v108, v64, v65
    v_cvt_pk_bf16_f32 v109, v66, v67
    buffer_store_dwordx4 v[104:107], v134, s[40:43], s58 offen offset:0 sc1
    s_mov_b64 exec, s[24:25]
    buffer_store_dwordx2 v[108:109], v5, s[40:43], s57 offen offset:0 sc1
    s_mov_b64 exec, -1
    v_pk_add_f32 v[68:69], v[68:69], v[92:93]
    v_pk_add_f32 v[70:71], v[70:71], v[94:95]
    v_pk_add_f32 v[72:73], v[72:73], v[96:97]
    v_pk_add_f32 v[74:75], v[74:75], v[98:99]
    v_pk_add_f32 v[76:77], v[76:77], v[100:101]
    v_pk_add_f32 v[78:79], v[78:79], v[102:103]
    v_mov_b32 v128, v76
    v_mov_b32 v129, v76
    v_add_f32 v131, abs(v68), abs(v69)
    v_add_f32 v132, abs(v76), abs(v77)
    v_permlane32_swap_b32 v128, v129
    v_rcp_f32 v130, v129
    v_add_f32 v131, v131, abs(v70)
    v_add_f32 v131, v131, abs(v71)
    v_add_f32 v131, v131, abs(v72)
    v_add_f32 v131, v131, abs(v73)
    v_add_f32 v131, v131, abs(v74)
    v_add_f32 v131, v131, abs(v75)
    v_add_f32 v132, v132, abs(v78)
    v_add_f32 v132, v132, abs(v79)
    v_cndmask_b32 v132, 0, v132, vcc
    v_add_f32 v131, v131, v132
    s_mov_b32 s59, 0x7f000000
    v_cmp_ngt_f32 s[60:61], s59, v131
    s_mov_b32 s59, 0x21800000
    v_cmp_nle_f32 s[62:63], s59, v129
    s_mov_b32 s59, 0x5d800000
    v_cmp_nge_f32 s[64:65], s59, v129
    v_pk_mul_f32 v[68:69], v[68:69], v[130:131] op_sel_hi:[1,0]
    v_pk_mul_f32 v[70:71], v[70:71], v[130:131] op_sel_hi:[1,0]
    v_pk_mul_f32 v[72:73], v[72:73], v[130:131] op_sel_hi:[1,0]
    v_pk_mul_f32 v[74:75], v[74:75], v[130:131] op_sel_hi:[1,0]
    v_pk_mul_f32 v[76:77], v[76:77], v[130:131] op_sel_hi:[1,0]
    v_pk_mul_f32 v[78:79], v[78:79], v[130:131] op_sel_hi:[1,0]
    s_or_b64 s[60:61], s[60:61], s[62:63]
    s_or_b64 s[60:61], s[60:61], s[64:65]
    s_or_b64 s[66:67], s[66:67], s[60:61]
    v_cvt_pk_bf16_f32 v112, v68, v69
    v_cvt_pk_bf16_f32 v113, v70, v71
    v_cvt_pk_bf16_f32 v114, v72, v73
    v_cvt_pk_bf16_f32 v115, v74, v75
    v_cvt_pk_bf16_f32 v116, v76, v77
    v_cvt_pk_bf16_f32 v117, v78, v79
    buffer_store_dwordx4 v[112:115], v134, s[40:43], s58 offen offset:512 sc1
    s_mov_b64 exec, s[24:25]
    buffer_store_dwordx2 v[116:117], v5, s[40:43], s57 offen offset:512 sc1
    s_mov_b64 exec, -1
    s_cmp_lg_u64 s[66:67], 0
    s_cselect_b32 s59, 1, 0
    s_cmp_lg_u32 s21, 0
    s_cselect_b32 s59, 0, s59
    v_mov_b32 v132, s59
    s_lshl_b32 s57, s16, 2
    s_add_u32 s57, s57, 131072
    v_mov_b32 v133, s57
    ds_write_b32 v133, v132
    s_waitcnt vmcnt(0) lgkmcnt(0)
    s_barrier
    v_mov_b32 v133, 131072
    ds_read_b128 v[134:137], v133
    s_waitcnt lgkmcnt(0)
    v_or_b32 v134, v134, v135
    v_or_b32 v136, v136, v137
    v_or_b32 v134, v134, v136
    s_nop 0
    v_readfirstlane_b32 s59, v134
    s_nop 3
    s_cmp_eq_u32 s59, 0
    s_cbranch_scc1 interleave_layers__mha_block__dense_activation_silu__prompt_kernel_att_fin
    s_barrier
    s_mov_b32 s53, s50
    s_mov_b32 s54, s51
    s_mov_b32 s55, s52
    v_mov_b32 v56, 0xff800000
    v_mov_b32 v57, 0xff800000
    v_mov_b32 v58, 0xff800000
    v_mov_b32 v59, 0xff800000
    s_mov_b32 s56, 32
interleave_layers__mha_block__dense_activation_silu__prompt_kernel_att_mxloop:
    buffer_load_dwordx4 a[88:91], v4, s[32:35], s53 offen sc1
    s_mov_b64 exec, s[24:25]
    buffer_load_dwordx2 a[92:93], v5, s[32:35], s55 offen sc1
    s_mov_b64 exec, -1
    s_add_u32 s53, s53, 1024
    s_add_u32 s54, s54, 1280
    s_add_u32 s55, s55, 512
    s_waitcnt vmcnt(0)
    v_mfma_f32_32x32x16_bf16 v[16:31], a[88:91], a[0:3], 0
    v_mfma_f32_32x32x8_bf16 v[16:31], a[92:93], a[4:5], v[16:31]
    s_nop 7
    s_nop 3
    v_max3_f32 v56, v56, v16, v17
    v_max3_f32 v56, v56, v18, v19
    v_max3_f32 v56, v56, v20, v21
    v_max3_f32 v56, v56, v22, v23
    v_max3_f32 v56, v56, v24, v25
    v_max3_f32 v56, v56, v26, v27
    v_max3_f32 v56, v56, v28, v29
    v_max3_f32 v56, v56, v30, v31
    v_mfma_f32_32x32x16_bf16 v[16:31], a[88:91], a[6:9], 0
    v_mfma_f32_32x32x8_bf16 v[16:31], a[92:93], a[10:11], v[16:31]
    s_nop 7
    s_nop 3
    v_max3_f32 v57, v57, v16, v17
    v_max3_f32 v57, v57, v18, v19
    v_max3_f32 v57, v57, v20, v21
    v_max3_f32 v57, v57, v22, v23
    v_max3_f32 v57, v57, v24, v25
    v_max3_f32 v57, v57, v26, v27
    v_max3_f32 v57, v57, v28, v29
    v_max3_f32 v57, v57, v30, v31
    v_mfma_f32_32x32x16_bf16 v[16:31], a[88:91], a[12:15], 0
    v_mfma_f32_32x32x8_bf16 v[16:31], a[92:93], a[16:17], v[16:31]
    s_nop 7
    s_nop 3
    v_max3_f32 v58, v58, v16, v17
    v_max3_f32 v58, v58, v18, v19
    v_max3_f32 v58, v58, v20, v21
    v_max3_f32 v58, v58, v22, v23
    v_max3_f32 v58, v58, v24, v25
    v_max3_f32 v58, v58, v26, v27
    v_max3_f32 v58, v58, v28, v29
    v_max3_f32 v58, v58, v30, v31
    v_mfma_f32_32x32x16_bf16 v[16:31], a[88:91], a[18:21], 0
    v_mfma_f32_32x32x8_bf16 v[16:31], a[92:93], a[22:23], v[16:31]
    s_nop 7
    s_nop 3
    v_max3_f32 v59, v59, v16, v17
    v_max3_f32 v59, v59, v18, v19
    v_max3_f32 v59, v59, v20, v21
    v_max3_f32 v59, v59, v22, v23
    v_max3_f32 v59, v59, v24, v25
    v_max3_f32 v59, v59, v26, v27
    v_max3_f32 v59, v59, v28, v29
    v_max3_f32 v59, v59, v30, v31
    s_sub_u32 s56, s56, 1
    s_cmp_lg_u32 s56, 0
    s_cbranch_scc1 interleave_layers__mha_block__dense_activation_silu__prompt_kernel_att_mxloop
    v_mov_b32 v128, v56
    v_mov_b32 v129, v56
    s_nop 1
    v_permlane32_swap_b32 v128, v129
    v_max_f32 v56, v128, v129
    v_mov_b32 v128, v57
    v_mov_b32 v129, v57
    s_nop 1
    v_permlane32_swap_b32 v128, v129
    v_max_f32 v57, v128, v129
    v_mov_b32 v128, v58
    v_mov_b32 v129, v58
    s_nop 1
    v_permlane32_swap_b32 v128, v129
    v_max_f32 v58, v128, v129
    v_mov_b32 v128, v59
    v_mov_b32 v129, v59
    s_nop 1
    v_permlane32_swap_b32 v128, v129
    v_max_f32 v59, v128, v129
    s_lshl_b32 s57, s16, 9
    s_add_u32 s57, s57, 126976
    v_lshl_add_u32 v128, v2, 2, s57
    ds_write_b32 v128, v56 offset:0
    ds_write_b32 v128, v57 offset:128
    ds_write_b32 v128, v58 offset:256
    ds_write_b32 v128, v59 offset:384
    s_waitcnt lgkmcnt(0)
    s_barrier
    s_xor_b32 s57, s16, 2
    s_lshl_b32 s57, s57, 9
    s_add_u32 s57, s57, 126976
    v_lshl_add_u32 v128, v2, 2, s57
    ds_read_b32 v16, v128 offset:0
    ds_read_b32 v17, v128 offset:128
    ds_read_b32 v18, v128 offset:256
    ds_read_b32 v19, v128 offset:384
    s_waitcnt lgkmcnt(0)
    v_cmp_ne_u32 vcc, 0, v3
    v_max_f32 v129, v56, v16
    v_sub_f32 v129, 0, v129
    v_and_b32 v130, 0xffff0000, v129
    v_sub_f32 v129, v129, v130
    v_and_b32 v131, 0xffff0000, v129
    v_sub_f32 v129, v129, v131
    v_lshrrev_b32 v130, 16, v130
    v_or_b32 v130, v130, v131
    v_lshrrev_b32 v129, 16, v129
    v_accvgpr_read_b32 v132, a4
    v_accvgpr_read_b32 v133, a5
    v_cndmask_b32 v132, v132, v130, vcc
    v_cndmask_b32 v133, v133, v129, vcc
    v_accvgpr_write_b32 a4, v132
    v_accvgpr_write_b32 a5, v133
    v_max_f32 v129, v57, v17
    v_sub_f32 v129, 0, v129
    v_and_b32 v130, 0xffff0000, v129
    v_sub_f32 v129, v129, v130
    v_and_b32 v131, 0xffff0000, v129
    v_sub_f32 v129, v129, v131
    v_lshrrev_b32 v130, 16, v130
    v_or_b32 v130, v130, v131
    v_lshrrev_b32 v129, 16, v129
    v_accvgpr_read_b32 v132, a10
    v_accvgpr_read_b32 v133, a11
    v_cndmask_b32 v132, v132, v130, vcc
    v_cndmask_b32 v133, v133, v129, vcc
    v_accvgpr_write_b32 a10, v132
    v_accvgpr_write_b32 a11, v133
    v_max_f32 v129, v58, v18
    v_sub_f32 v129, 0, v129
    v_and_b32 v130, 0xffff0000, v129
    v_sub_f32 v129, v129, v130
    v_and_b32 v131, 0xffff0000, v129
    v_sub_f32 v129, v129, v131
    v_lshrrev_b32 v130, 16, v130
    v_or_b32 v130, v130, v131
    v_lshrrev_b32 v129, 16, v129
    v_accvgpr_read_b32 v132, a16
    v_accvgpr_read_b32 v133, a17
    v_cndmask_b32 v132, v132, v130, vcc
    v_cndmask_b32 v133, v133, v129, vcc
    v_accvgpr_write_b32 a16, v132
    v_accvgpr_write_b32 a17, v133
    v_max_f32 v129, v59, v19
    v_sub_f32 v129, 0, v129
    v_and_b32 v130, 0xffff0000, v129
    v_sub_f32 v129, v129, v130
    v_and_b32 v131, 0xffff0000, v129
    v_sub_f32 v129, v129, v131
    v_lshrrev_b32 v130, 16, v130
    v_or_b32 v130, v130, v131
    v_lshrrev_b32 v129, 16, v129
    v_accvgpr_read_b32 v132, a22
    v_accvgpr_read_b32 v133, a23
    v_cndmask_b32 v132, v132, v130, vcc
    v_cndmask_b32 v133, v133, v129, vcc
    v_accvgpr_write_b32 a22, v132
    v_accvgpr_write_b32 a23, v133
    s_mov_b32 s21, 1
    s_barrier
    s_branch interleave_layers__mha_block__dense_activation_silu__prompt_kernel_att_main
interleave_layers__mha_block__dense_activation_silu__prompt_kernel_att_fin:
    s_cmp_lg_u32 s16, 0
    s_cbranch_scc1 arr_done_9
    s_add_u32 s100, s18, 16
    s_lshl_b32 s100, s100, 7
    s_add_u32 s100, s100, s97
    v_mov_b32 v250, s100
    v_mov_b32 v251, 1
    s_mov_b64 exec, 1
    global_atomic_add v250, v251, s[98:99] sc1
    s_mov_b64 exec, -1
arr_done_9:
    s_and_b32 s20, s12, 3
    s_lshl_b32 s20, s20, 3
    s_and_b32 s21, s13, 7
    s_add_u32 s17, s20, s21
    s_lshr_b32 s20, s12, 2
    s_lshl_b32 s20, s20, 2
    s_lshr_b32 s21, s13, 3
    s_add_u32 s18, s20, s21
    s_lshr_b32 s19, s17, 1
    v_and_b32 v1, 63, v0
    v_lshlrev_b32 v4, 4, v1
    v_and_b32 v2, 15, v0
    v_bfe_u32 v3, v0, 4, 2
    v_mov_b32 v8, v4
    v_add_u32 v9, 0x10000, v4
    v_add_u32 v10, 0x20000, v4
    v_add_u32 v16, s79, v4
    v_add_u32 v17, 0x10000, v16
    v_add_u32 v18, 0x20000, v16
    v_mul_u32_u24 v5, 32768, v3
    v_lshl_add_u32 v5, v2, 4, v5
    s_lshl_b32 s19, s17, 6
    s_lshl_b32 s20, s16, 4
    s_add_u32 s22, s19, s20
    v_add_u32 v12, s22, v2
    s_mul_i32 s20, s18, 10
    v_add_u32 v13, s20, v3
    v_mul_u32_u24 v13, 32768, v13
    v_lshl_add_u32 v6, v12, 4, v13
    v_lshrrev_b32 v13, 1, v3
    v_add_u32 v13, s20, v13
    v_add_u32 v13, 8, v13
    v_mul_u32_u24 v13, 32768, v13
    v_lshl_add_u32 v13, v12, 4, v13
    v_and_b32 v14, 1, v3
    v_lshl_add_u32 v7, v14, 3, v13
    s_mov_b32 s23, 131072
    s_lshl_b32 s44, s22, 4
    s_lshr_b32 s19, s17, 1
    s_add_u32 s24, s6, 38539264
    s_addc_u32 s25, s7, 0
    s_add_u32 s100, s6, 7835648
    s_addc_u32 s101, s7, 0
    s_cmp_eq_u32 s14, 0
    s_cselect_b32 s24, s100, s24
    s_cselect_b32 s25, s101, s25
    s_and_b32 s25, s25, 0xffff
    s_mov_b32 s26, 2621440
    s_mov_b32 s27, 0x20000
    s_add_u32 s28, s15, 35917824
    s_add_u32 s28, s28, s6
    s_addc_u32 s29, s7, 0
    s_and_b32 s29, s29, 0xffff
    s_mov_b32 s30, 2621440
    s_mov_b32 s31, 0x20000
    s_add_u32 s40, s15, 41160704
    s_add_u32 s40, s40, s6
    s_addc_u32 s41, s7, 0
    s_and_b32 s41, s41, 0xffff
    s_mov_b32 s42, 131072
    s_mov_b32 s43, 0x20000
    s_add_u32 s32, s15, 26218496
    s_add_u32 s32, s32, s6
    s_addc_u32 s33, s7, 0
    s_and_b32 s33, s33, 0xffff
    s_mov_b32 s34, 2621440
    s_mov_b32 s35, 0x20000
    buffer_load_dwordx4 v[20:23], v6, s[24:27], 0 offen sc1
    buffer_load_dwordx4 v[24:27], v6, s[24:27], s23 offen sc1
    buffer_load_dwordx2 v[28:29], v7, s[24:27], 0 offen sc1
    s_add_u32 s80, s76, 2457600
    buffer_load_dwordx4 a[96:99], v249, s[72:75], s80 offen offset:0 sc1
    buffer_load_dwordx4 a[100:103], v249, s[72:75], s80 offen offset:1024 sc1
    buffer_load_dwordx4 a[104:107], v249, s[72:75], s80 offen offset:2048 sc1
    buffer_load_dwordx4 a[108:111], v249, s[72:75], s80 offen offset:3072 sc1
    s_add_u32 s80, s76, 2461696
    buffer_load_dwordx4 a[112:115], v249, s[72:75], s80 offen offset:0 sc1
    buffer_load_dwordx4 a[116:119], v249, s[72:75], s80 offen offset:1024 sc1
    buffer_load_dwordx4 a[120:123], v249, s[72:75], s80 offen offset:2048 sc1
    buffer_load_dwordx4 a[124:127], v249, s[72:75], s80 offen offset:3072 sc1
    s_add_u32 s80, s76, 2465792
    buffer_load_dwordx4 a[128:131], v249, s[72:75], s80 offen offset:0 sc1
    buffer_load_dwordx4 a[132:135], v249, s[72:75], s80 offen offset:1024 sc1
    buffer_load_dwordx4 a[136:139], v249, s[72:75], s80 offen offset:2048 sc1
    buffer_load_dwordx4 a[140:143], v249, s[72:75], s80 offen offset:3072 sc1
    s_add_u32 s80, s76, 2469888
    buffer_load_dwordx4 a[144:147], v249, s[72:75], s80 offen offset:0 sc1
    buffer_load_dwordx4 a[148:151], v249, s[72:75], s80 offen offset:1024 sc1
    buffer_load_dwordx4 a[152:155], v249, s[72:75], s80 offen offset:2048 sc1
    buffer_load_dwordx4 a[156:159], v249, s[72:75], s80 offen offset:3072 sc1
    s_add_u32 s80, s76, 2473984
    buffer_load_dwordx4 a[160:163], v249, s[72:75], s80 offen offset:0 sc1
    buffer_load_dwordx4 a[164:167], v249, s[72:75], s80 offen offset:1024 sc1
    buffer_load_dwordx4 a[168:171], v249, s[72:75], s80 offen offset:2048 sc1
    buffer_load_dwordx4 a[172:175], v249, s[72:75], s80 offen offset:3072 sc1
    s_lshr_b32 s21, s17, 2
    s_cmp_lg_u32 s16, 0
    s_cbranch_scc1 we_done_10
    s_add_u32 s100, s21, 16
    s_lshl_b32 s100, s100, 7
    s_add_u32 s100, s100, s97
    v_mov_b32 v250, s100
    s_mov_b64 exec, 1
    global_load_dword v251, v250, s[98:99] sc1
    s_mov_b64 exec, -1
we_done_10:
    v_add_u32 v12, s22, v2
    v_lshlrev_b32 v156, 3, v12
    v_mov_b32 v13, 0x7ffffff0
    v_cmp_eq_u32 vcc, 0, v3
    v_mul_u32_u24 v12, 1280, v12
    v_lshl_add_u32 v157, v3, 4, v12
    v_cndmask_b32 v156, v13, v156, vcc
    v_lshl_add_u32 v158, v3, 3, v12
    s_waitcnt vmcnt(20)
    v_lshlrev_b32 v112, 16, v20
    v_and_b32 v113, 0xffff0000, v20
    v_lshlrev_b32 v114, 16, v21
    v_and_b32 v115, 0xffff0000, v21
    v_lshlrev_b32 v116, 16, v22
    v_and_b32 v117, 0xffff0000, v22
    v_lshlrev_b32 v118, 16, v23
    v_and_b32 v119, 0xffff0000, v23
    v_lshlrev_b32 v120, 16, v24
    v_and_b32 v121, 0xffff0000, v24
    v_lshlrev_b32 v122, 16, v25
    v_and_b32 v123, 0xffff0000, v25
    v_lshlrev_b32 v124, 16, v26
    v_and_b32 v125, 0xffff0000, v26
    v_lshlrev_b32 v126, 16, v27
    v_and_b32 v127, 0xffff0000, v27
    v_lshlrev_b32 v128, 16, v28
    v_and_b32 v129, 0xffff0000, v28
    v_lshlrev_b32 v130, 16, v29
    v_and_b32 v131, 0xffff0000, v29
    s_lshr_b32 s21, s17, 2
    s_cmp_lg_u32 s16, 0
    s_cbranch_scc1 wt_done_11
    s_add_u32 s100, s21, 16
    s_lshl_b32 s100, s100, 7
    s_add_u32 s100, s100, s97
    v_mov_b32 v250, s100
    s_mov_b32 s101, 0
    s_mov_b64 exec, 1
    s_waitcnt vmcnt(0)
    v_cmp_le_u32 vcc, 32, v251
    s_nop 0
    s_cmp_eq_u64 vcc, exec
    s_cbranch_scc1 wt_ok_11
wt_poll_11:
    global_load_dword v251, v250, s[98:99] sc1
    s_add_u32 s101, s101, 1
    s_waitcnt vmcnt(0)
    v_cmp_le_u32 vcc, 32, v251
    s_cmp_ge_u32 s101, 262144
    s_cbranch_scc1 wt_ok_11
    s_cmp_eq_u64 vcc, exec
    s_cbranch_scc1 wt_ok_11
    s_sleep 1
    s_branch wt_poll_11
wt_ok_11:
    s_mov_b64 exec, -1
wt_done_11:
    s_barrier
    s_add_u32 s49, s44, 0
    buffer_load_dwordx4 a[0:3], v5, s[32:35], s49 offen sc1
    s_add_u32 s49, s44, 131072
    buffer_load_dwordx4 a[4:7], v5, s[32:35], s49 offen sc1
    s_add_u32 s49, s44, 262144
    buffer_load_dwordx4 a[8:11], v5, s[32:35], s49 offen sc1
    s_add_u32 s49, s44, 393216
    buffer_load_dwordx4 a[12:15], v5, s[32:35], s49 offen sc1
    s_add_u32 s49, s44, 524288
    buffer_load_dwordx4 a[16:19], v5, s[32:35], s49 offen sc1
    s_add_u32 s49, s44, 655360
    buffer_load_dwordx4 a[20:23], v5, s[32:35], s49 offen sc1
    s_add_u32 s49, s44, 786432
    buffer_load_dwordx4 a[24:27], v5, s[32:35], s49 offen sc1
    s_add_u32 s49, s44, 917504
    buffer_load_dwordx4 a[28:31], v5, s[32:35], s49 offen sc1
    s_add_u32 s49, s44, 1048576
    buffer_load_dwordx4 a[32:35], v5, s[32:35], s49 offen sc1
    s_add_u32 s49, s44, 1179648
    buffer_load_dwordx4 a[36:39], v5, s[32:35], s49 offen sc1
    s_add_u32 s49, s44, 1310720
    buffer_load_dwordx4 a[40:43], v5, s[32:35], s49 offen sc1
    s_add_u32 s49, s44, 1441792
    buffer_load_dwordx4 a[44:47], v5, s[32:35], s49 offen sc1
    s_waitcnt vmcnt(8)
    ds_read_b128 v[32:35], v8 offset:0
    ds_read_b128 v[36:39], v8 offset:1024
    ds_read_b128 v[40:43], v8 offset:2048
    ds_read_b128 v[44:47], v8 offset:3072
    ds_read_b128 v[48:51], v8 offset:4096
    ds_read_b128 v[52:55], v8 offset:5120
    ds_read_b128 v[56:59], v8 offset:6144
    ds_read_b128 v[60:63], v8 offset:7168
    ds_read_b128 v[64:67], v8 offset:8192
    ds_read_b128 v[68:71], v8 offset:9216
    s_waitcnt lgkmcnt(5)
    v_mfma_f32_16x16x32_bf16 v[92:95], v[32:35], a[0:3], 0
    ds_read_b128 v[72:75], v8 offset:10240
    s_add_u32 s49, s44, 1572864
    buffer_load_dwordx4 a[48:51], v5, s[32:35], s49 offen sc1
    v_mfma_f32_16x16x32_bf16 v[96:99], v[36:39], a[0:3], 0
    ds_read_b128 v[76:79], v8 offset:11264
    v_mfma_f32_16x16x32_bf16 v[100:103], v[40:43], a[0:3], 0
    ds_read_b128 v[80:83], v8 offset:12288
    s_add_u32 s49, s44, 1703936
    buffer_load_dwordx4 a[52:55], v5, s[32:35], s49 offen sc1
    v_mfma_f32_16x16x32_bf16 v[104:107], v[44:47], a[0:3], 0
    ds_read_b128 v[84:87], v8 offset:13312
    v_mfma_f32_16x16x32_bf16 v[108:111], v[48:51], a[0:3], 0
    ds_read_b128 v[88:91], v8 offset:14336
    s_waitcnt lgkmcnt(5)
    v_mfma_f32_16x16x32_bf16 v[92:95], v[52:55], a[4:7], v[92:95]
    ds_read_b128 v[32:35], v8 offset:15360
    s_add_u32 s49, s44, 1835008
    buffer_load_dwordx4 a[56:59], v5, s[32:35], s49 offen sc1
    v_mfma_f32_16x16x32_bf16 v[96:99], v[56:59], a[4:7], v[96:99]
    ds_read_b128 v[36:39], v8 offset:16384
    v_mfma_f32_16x16x32_bf16 v[100:103], v[60:63], a[4:7], v[100:103]
    ds_read_b128 v[40:43], v8 offset:17408
    s_add_u32 s49, s44, 1966080
    buffer_load_dwordx4 a[60:63], v5, s[32:35], s49 offen sc1
    v_mfma_f32_16x16x32_bf16 v[104:107], v[64:67], a[4:7], v[104:107]
    ds_read_b128 v[44:47], v8 offset:18432
    v_mfma_f32_16x16x32_bf16 v[108:111], v[68:71], a[4:7], v[108:111]
    ds_read_b128 v[48:51], v8 offset:19456
    s_waitcnt lgkmcnt(5)
    v_mfma_f32_16x16x32_bf16 v[92:95], v[72:75], a[8:11], v[92:95]
    ds_read_b128 v[52:55], v8 offset:20480
    v_mfma_f32_16x16x32_bf16 v[96:99], v[76:79], a[8:11], v[96:99]
    ds_read_b128 v[56:59], v8 offset:21504
    v_mfma_f32_16x16x32_bf16 v[100:103], v[80:83], a[8:11], v[100:103]
    ds_read_b128 v[60:63], v8 offset:22528
    v_mfma_f32_16x16x32_bf16 v[104:107], v[84:87], a[8:11], v[104:107]
    ds_read_b128 v[64:67], v8 offset:23552
    v_mfma_f32_16x16x32_bf16 v[108:111], v[88:91], a[8:11], v[108:111]
    ds_read_b128 v[68:71], v8 offset:24576
    s_waitcnt lgkmcnt(5)
    v_mfma_f32_16x16x32_bf16 v[92:95], v[32:35], a[12:15], v[92:95]
    ds_read_b128 v[72:75], v8 offset:25600
    v_mfma_f32_16x16x32_bf16 v[96:99], v[36:39], a[12:15], v[96:99]
    ds_read_b128 v[76:79], v8 offset:26624
    v_mfma_f32_16x16x32_bf16 v[100:103], v[40:43], a[12:15], v[100:103]
    ds_read_b128 v[80:83], v8 offset:27648
    v_mfma_f32_16x16x32_bf16 v[104:107], v[44:47], a[12:15], v[104:107]
    ds_read_b128 v[84:87], v8 offset:28672
    v_mfma_f32_16x16x32_bf16 v[108:111], v[48:51], a[12:15], v[108:111]
    ds_read_b128 v[88:91], v8 offset:29696
    s_waitcnt vmcnt(8)
    s_waitcnt lgkmcnt(5)
    v_mfma_f32_16x16x32_bf16 v[92:95], v[52:55], a[16:19], v[92:95]
    ds_read_b128 v[32:35], v8 offset:30720
    s_add_u32 s49, s44, 2097152
    buffer_load_dwordx4 a[64:67], v5, s[32:35], s49 offen sc1
    v_mfma_f32_16x16x32_bf16 v[96:99], v[56:59], a[16:19], v[96:99]
    ds_read_b128 v[36:39], v8 offset:31744
    v_mfma_f32_16x16x32_bf16 v[100:103], v[60:63], a[16:19], v[100:103]
    ds_read_b128 v[40:43], v8 offset:32768
    s_add_u32 s49, s44, 2228224
    buffer_load_dwordx4 a[68:71], v5, s[32:35], s49 offen sc1
    v_mfma_f32_16x16x32_bf16 v[104:107], v[64:67], a[16:19], v[104:107]
    ds_read_b128 v[44:47], v8 offset:33792
    v_mfma_f32_16x16x32_bf16 v[108:111], v[68:71], a[16:19], v[108:111]
    ds_read_b128 v[48:51], v8 offset:34816
    s_waitcnt lgkmcnt(5)
    v_mfma_f32_16x16x32_bf16 v[92:95], v[72:75], a[20:23], v[92:95]
    ds_read_b128 v[52:55], v8 offset:35840
    s_add_u32 s49, s44, 2359296
    buffer_load_dwordx4 a[72:75], v5, s[32:35], s49 offen sc1
    v_mfma_f32_16x16x32_bf16 v[96:99], v[76:79], a[20:23], v[96:99]
    ds_read_b128 v[56:59], v8 offset:36864
    v_mfma_f32_16x16x32_bf16 v[100:103], v[80:83], a[20:23], v[100:103]
    ds_read_b128 v[60:63], v8 offset:37888
    s_add_u32 s49, s44, 2490368
    buffer_load_dwordx4 a[76:79], v5, s[32:35], s49 offen sc1
    v_mfma_f32_16x16x32_bf16 v[104:107], v[84:87], a[20:23], v[104:107]
    ds_read_b128 v[64:67], v8 offset:38912
    v_mfma_f32_16x16x32_bf16 v[108:111], v[88:91], a[20:23], v[108:111]
    ds_read_b128 v[68:71], v8 offset:39936
    s_waitcnt lgkmcnt(5)
    v_mfma_f32_16x16x32_bf16 v[92:95], v[32:35], a[24:27], v[92:95]
    ds_read_b128 v[72:75], v8 offset:40960
    v_mfma_f32_16x16x32_bf16 v[96:99], v[36:39], a[24:27], v[96:99]
    ds_read_b128 v[76:79], v8 offset:41984
    v_mfma_f32_16x16x32_bf16 v[100:103], v[40:43], a[24:27], v[100:103]
    ds_read_b128 v[80:83], v8 offset:43008
    v_mfma_f32_16x16x32_bf16 v[104:107], v[44:47], a[24:27], v[104:107]
    ds_read_b128 v[84:87], v8 offset:44032
    v_mfma_f32_16x16x32_bf16 v[108:111], v[48:51], a[24:27], v[108:111]
    ds_read_b128 v[88:91], v8 offset:45056
    s_waitcnt lgkmcnt(5)
    v_mfma_f32_16x16x32_bf16 v[92:95], v[52:55], a[28:31], v[92:95]
    ds_read_b128 v[32:35], v8 offset:46080
    v_mfma_f32_16x16x32_bf16 v[96:99], v[56:59], a[28:31], v[96:99]
    ds_read_b128 v[36:39], v8 offset:47104
    v_mfma_f32_16x16x32_bf16 v[100:103], v[60:63], a[28:31], v[100:103]
    ds_read_b128 v[40:43], v8 offset:48128
    v_mfma_f32_16x16x32_bf16 v[104:107], v[64:67], a[28:31], v[104:107]
    ds_read_b128 v[44:47], v8 offset:49152
    v_mfma_f32_16x16x32_bf16 v[108:111], v[68:71], a[28:31], v[108:111]
    ds_read_b128 v[48:51], v8 offset:50176
    s_waitcnt vmcnt(8)
    s_waitcnt lgkmcnt(5)
    v_mfma_f32_16x16x32_bf16 v[92:95], v[72:75], a[32:35], v[92:95]
    ds_read_b128 v[52:55], v8 offset:51200
    v_mfma_f32_16x16x32_bf16 v[96:99], v[76:79], a[32:35], v[96:99]
    ds_read_b128 v[56:59], v8 offset:52224
    v_mfma_f32_16x16x32_bf16 v[100:103], v[80:83], a[32:35], v[100:103]
    ds_read_b128 v[60:63], v8 offset:53248
    v_mfma_f32_16x16x32_bf16 v[104:107], v[84:87], a[32:35], v[104:107]
    ds_read_b128 v[64:67], v8 offset:54272
    v_mfma_f32_16x16x32_bf16 v[108:111], v[88:91], a[32:35], v[108:111]
    ds_read_b128 v[68:71], v8 offset:55296
    s_waitcnt lgkmcnt(5)
    v_mfma_f32_16x16x32_bf16 v[92:95], v[32:35], a[36:39], v[92:95]
    ds_read_b128 v[72:75], v8 offset:56320
    v_mfma_f32_16x16x32_bf16 v[96:99], v[36:39], a[36:39], v[96:99]
    ds_read_b128 v[76:79], v8 offset:57344
    v_mfma_f32_16x16x32_bf16 v[100:103], v[40:43], a[36:39], v[100:103]
    ds_read_b128 v[80:83], v8 offset:58368
    v_mfma_f32_16x16x32_bf16 v[104:107], v[44:47], a[36:39], v[104:107]
    ds_read_b128 v[84:87], v8 offset:59392
    v_mfma_f32_16x16x32_bf16 v[108:111], v[48:51], a[36:39], v[108:111]
    ds_read_b128 v[88:91], v8 offset:60416
    s_waitcnt lgkmcnt(5)
    v_mfma_f32_16x16x32_bf16 v[92:95], v[52:55], a[40:43], v[92:95]
    ds_read_b128 v[32:35], v8 offset:61440
    v_mfma_f32_16x16x32_bf16 v[96:99], v[56:59], a[40:43], v[96:99]
    ds_read_b128 v[36:39], v8 offset:62464
    v_mfma_f32_16x16x32_bf16 v[100:103], v[60:63], a[40:43], v[100:103]
    ds_read_b128 v[40:43], v8 offset:63488
    v_mfma_f32_16x16x32_bf16 v[104:107], v[64:67], a[40:43], v[104:107]
    ds_read_b128 v[44:47], v8 offset:64512
    v_mfma_f32_16x16x32_bf16 v[108:111], v[68:71], a[40:43], v[108:111]
    ds_read_b128 v[48:51], v9 offset:0
    s_waitcnt lgkmcnt(5)
    v_mfma_f32_16x16x32_bf16 v[92:95], v[72:75], a[44:47], v[92:95]
    ds_read_b128 v[52:55], v9 offset:1024
    v_mfma_f32_16x16x32_bf16 v[96:99], v[76:79], a[44:47], v[96:99]
    ds_read_b128 v[56:59], v9 offset:2048
    v_mfma_f32_16x16x32_bf16 v[100:103], v[80:83], a[44:47], v[100:103]
    ds_read_b128 v[60:63], v9 offset:3072
    v_mfma_f32_16x16x32_bf16 v[104:107], v[84:87], a[44:47], v[104:107]
    ds_read_b128 v[64:67], v9 offset:4096
    v_mfma_f32_16x16x32_bf16 v[108:111], v[88:91], a[44:47], v[108:111]
    ds_read_b128 v[68:71], v9 offset:5120
    s_waitcnt vmcnt(4)
    s_waitcnt lgkmcnt(5)
    v_mfma_f32_16x16x32_bf16 v[92:95], v[32:35], a[48:51], v[92:95]
    ds_read_b128 v[72:75], v9 offset:6144
    v_mfma_f32_16x16x32_bf16 v[96:99], v[36:39], a[48:51], v[96:99]
    ds_read_b128 v[76:79], v9 offset:7168
    v_mfma_f32_16x16x32_bf16 v[100:103], v[40:43], a[48:51], v[100:103]
    ds_read_b128 v[80:83], v9 offset:8192
    v_mfma_f32_16x16x32_bf16 v[104:107], v[44:47], a[48:51], v[104:107]
    ds_read_b128 v[84:87], v9 offset:9216
    v_mfma_f32_16x16x32_bf16 v[108:111], v[48:51], a[48:51], v[108:111]
    ds_read_b128 v[88:91], v9 offset:10240
    s_waitcnt lgkmcnt(5)
    v_mfma_f32_16x16x32_bf16 v[92:95], v[52:55], a[52:55], v[92:95]
    ds_read_b128 v[32:35], v9 offset:11264
    v_mfma_f32_16x16x32_bf16 v[96:99], v[56:59], a[52:55], v[96:99]
    ds_read_b128 v[36:39], v9 offset:12288
    v_mfma_f32_16x16x32_bf16 v[100:103], v[60:63], a[52:55], v[100:103]
    ds_read_b128 v[40:43], v9 offset:13312
    v_mfma_f32_16x16x32_bf16 v[104:107], v[64:67], a[52:55], v[104:107]
    ds_read_b128 v[44:47], v9 offset:14336
    v_mfma_f32_16x16x32_bf16 v[108:111], v[68:71], a[52:55], v[108:111]
    ds_read_b128 v[48:51], v9 offset:15360
    s_waitcnt lgkmcnt(5)
    v_mfma_f32_16x16x32_bf16 v[92:95], v[72:75], a[56:59], v[92:95]
    ds_read_b128 v[52:55], v9 offset:16384
    v_mfma_f32_16x16x32_bf16 v[96:99], v[76:79], a[56:59], v[96:99]
    ds_read_b128 v[56:59], v9 offset:17408
    v_mfma_f32_16x16x32_bf16 v[100:103], v[80:83], a[56:59], v[100:103]
    ds_read_b128 v[60:63], v9 offset:18432
    v_mfma_f32_16x16x32_bf16 v[104:107], v[84:87], a[56:59], v[104:107]
    ds_read_b128 v[64:67], v9 offset:19456
    v_mfma_f32_16x16x32_bf16 v[108:111], v[88:91], a[56:59], v[108:111]
    ds_read_b128 v[68:71], v9 offset:20480
    s_waitcnt lgkmcnt(5)
    v_mfma_f32_16x16x32_bf16 v[92:95], v[32:35], a[60:63], v[92:95]
    ds_read_b128 v[72:75], v9 offset:21504
    v_mfma_f32_16x16x32_bf16 v[96:99], v[36:39], a[60:63], v[96:99]
    ds_read_b128 v[76:79], v9 offset:22528
    v_mfma_f32_16x16x32_bf16 v[100:103], v[40:43], a[60:63], v[100:103]
    ds_read_b128 v[80:83], v9 offset:23552
    v_mfma_f32_16x16x32_bf16 v[104:107], v[44:47], a[60:63], v[104:107]
    ds_read_b128 v[84:87], v9 offset:24576
    v_mfma_f32_16x16x32_bf16 v[108:111], v[48:51], a[60:63], v[108:111]
    ds_read_b128 v[88:91], v9 offset:25600
    s_waitcnt vmcnt(0)
    s_waitcnt lgkmcnt(5)
    v_mfma_f32_16x16x32_bf16 v[92:95], v[52:55], a[64:67], v[92:95]
    ds_read_b128 v[32:35], v9 offset:26624
    v_mfma_f32_16x16x32_bf16 v[96:99], v[56:59], a[64:67], v[96:99]
    ds_read_b128 v[36:39], v9 offset:27648
    v_mfma_f32_16x16x32_bf16 v[100:103], v[60:63], a[64:67], v[100:103]
    ds_read_b128 v[40:43], v9 offset:28672
    v_mfma_f32_16x16x32_bf16 v[104:107], v[64:67], a[64:67], v[104:107]
    ds_read_b128 v[44:47], v9 offset:29696
    v_mfma_f32_16x16x32_bf16 v[108:111], v[68:71], a[64:67], v[108:111]
    ds_read_b128 v[48:51], v9 offset:30720
    s_waitcnt lgkmcnt(5)
    v_mfma_f32_16x16x32_bf16 v[92:95], v[72:75], a[68:71], v[92:95]
    ds_read_b128 v[52:55], v9 offset:31744
    v_mfma_f32_16x16x32_bf16 v[96:99], v[76:79], a[68:71], v[96:99]
    ds_read_b128 v[56:59], v9 offset:32768
    v_mfma_f32_16x16x32_bf16 v[100:103], v[80:83], a[68:71], v[100:103]
    ds_read_b128 v[60:63], v9 offset:33792
    v_mfma_f32_16x16x32_bf16 v[104:107], v[84:87], a[68:71], v[104:107]
    ds_read_b128 v[64:67], v9 offset:34816
    v_mfma_f32_16x16x32_bf16 v[108:111], v[88:91], a[68:71], v[108:111]
    ds_read_b128 v[68:71], v9 offset:35840
    s_waitcnt lgkmcnt(5)
    v_mfma_f32_16x16x32_bf16 v[92:95], v[32:35], a[72:75], v[92:95]
    v_mfma_f32_16x16x32_bf16 v[96:99], v[36:39], a[72:75], v[96:99]
    v_mfma_f32_16x16x32_bf16 v[100:103], v[40:43], a[72:75], v[100:103]
    v_mfma_f32_16x16x32_bf16 v[104:107], v[44:47], a[72:75], v[104:107]
    v_mfma_f32_16x16x32_bf16 v[108:111], v[48:51], a[72:75], v[108:111]
    s_waitcnt lgkmcnt(0)
    v_mfma_f32_16x16x32_bf16 v[92:95], v[52:55], a[76:79], v[92:95]
    v_mfma_f32_16x16x32_bf16 v[96:99], v[56:59], a[76:79], v[96:99]
    v_mfma_f32_16x16x32_bf16 v[100:103], v[60:63], a[76:79], v[100:103]
    v_mfma_f32_16x16x32_bf16 v[104:107], v[64:67], a[76:79], v[104:107]
    v_mfma_f32_16x16x32_bf16 v[108:111], v[68:71], a[76:79], v[108:111]
    s_nop 7
    v_pk_add_f32 v[112:113], v[112:113], v[92:93]
    v_pk_add_f32 v[114:115], v[114:115], v[94:95]
    v_pk_add_f32 v[116:117], v[116:117], v[96:97]
    v_pk_add_f32 v[118:119], v[118:119], v[98:99]
    v_pk_add_f32 v[120:121], v[120:121], v[100:101]
    v_pk_add_f32 v[122:123], v[122:123], v[102:103]
    v_pk_add_f32 v[124:125], v[124:125], v[104:105]
    v_pk_add_f32 v[126:127], v[126:127], v[106:107]
    v_pk_add_f32 v[128:129], v[128:129], v[108:109]
    v_pk_add_f32 v[130:131], v[130:131], v[110:111]
    v_cvt_pk_bf16_f32 v136, v112, v113
    v_cvt_pk_bf16_f32 v137, v114, v115
    v_cvt_pk_bf16_f32 v138, v116, v117
    v_cvt_pk_bf16_f32 v139, v118, v119
    v_cvt_pk_bf16_f32 v140, v120, v121
    v_cvt_pk_bf16_f32 v141, v122, v123
    v_cvt_pk_bf16_f32 v142, v124, v125
    v_cvt_pk_bf16_f32 v143, v126, v127
    v_cvt_pk_bf16_f32 v144, v128, v129
    v_cvt_pk_bf16_f32 v145, v130, v131
    buffer_store_dwordx4 v[136:139], v6, s[28:31], 0 offen sc1
    buffer_store_dwordx4 v[140:143], v6, s[28:31], s23 offen sc1
    buffer_store_dwordx2 v[144:145], v7, s[28:31], 0 offen sc1
    v_pk_add_f32 v[148:149], v[112:113], v[114:115]
    v_pk_mul_f32 v[150:151], v[112:113], v[112:113]
    v_pk_fma_f32 v[150:151], v[114:115], v[114:115], v[150:151]
    v_pk_add_f32 v[148:149], v[148:149], v[116:117]
    v_pk_fma_f32 v[150:151], v[116:117], v[116:117], v[150:151]
    v_pk_add_f32 v[148:149], v[148:149], v[118:119]
    v_pk_fma_f32 v[150:151], v[118:119], v[118:119], v[150:151]
    v_pk_add_f32 v[148:149], v[148:149], v[120:121]
    v_pk_fma_f32 v[150:151], v[120:121], v[120:121], v[150:151]
    v_pk_add_f32 v[148:149], v[148:149], v[122:123]
    v_pk_fma_f32 v[150:151], v[122:123], v[122:123], v[150:151]
    v_pk_add_f32 v[148:149], v[148:149], v[124:125]
    v_pk_fma_f32 v[150:151], v[124:125], v[124:125], v[150:151]
    v_pk_add_f32 v[148:149], v[148:149], v[126:127]
    v_pk_fma_f32 v[150:151], v[126:127], v[126:127], v[150:151]
    v_pk_add_f32 v[148:149], v[148:149], v[128:129]
    v_pk_fma_f32 v[150:151], v[128:129], v[128:129], v[150:151]
    v_pk_add_f32 v[148:149], v[148:149], v[130:131]
    v_pk_fma_f32 v[150:151], v[130:131], v[130:131], v[150:151]
    v_add_f32 v152, v148, v149
    v_add_f32 v153, v150, v151
    v_mov_b32 v154, v152
    v_mov_b32 v155, v153
    s_nop 1
    v_permlane32_swap_b32 v152, v154
    v_permlane32_swap_b32 v153, v155
    v_add_f32 v152, v152, v154
    v_add_f32 v153, v153, v155
    v_mov_b32 v154, v152
    v_mov_b32 v155, v153
    s_nop 1
    v_permlane16_swap_b32 v152, v154
    v_permlane16_swap_b32 v153, v155
    v_add_f32 v152, v152, v154
    v_add_f32 v153, v153, v155
    s_lshl_b32 s49, s18, 14
    buffer_store_dwordx2 v[152:153], v156, s[40:43], s49 offen sc1
    s_waitcnt vmcnt(0) lgkmcnt(0)
    s_barrier
    s_cmp_lg_u32 s16, 0
    s_cbranch_scc1 arr_done_12
    s_add_u32 s100, s19, 24
    s_lshl_b32 s100, s100, 7
    s_add_u32 s100, s100, s97
    v_mov_b32 v250, s100
    v_mov_b32 v251, 1
    s_mov_b64 exec, 1
    global_atomic_add v250, v251, s[98:99] sc1
    s_mov_b64 exec, -1
arr_done_12:
    s_and_b32 s20, s12, 3
    s_lshl_b32 s20, s20, 2
    s_and_b32 s21, s13, 3
    s_add_u32 s17, s20, s21
    s_lshr_b32 s20, s12, 2
    s_lshl_b32 s20, s20, 3
    s_lshr_b32 s21, s13, 2
    s_add_u32 s18, s20, s21
    s_cmp_ge_u32 s18, 14
    s_cbranch_scc1 interleave_layers__mha_block__dense_activation_silu__prompt_kernel_up_idle
    s_lshl_b32 s19, s18, 2
    s_add_u32 s19, s19, s16
    v_and_b32 v1, 63, v0
    v_and_b32 v2, 31, v0
    v_lshlrev_b32 v6, 4, v1
    s_add_u32 s32, s6, 7761920
    s_addc_u32 s33, s7, 0
    s_and_b32 s33, s33, 0xffff
    s_mov_b32 s34, 55296
    s_mov_b32 s35, 0x20000
    v_bfe_u32 v3, v0, 5, 1
    s_lshl_b32 s37, s19, 5
    v_add_u32 v7, s37, v2
    v_lshlrev_b32 v7, 2, v7
    v_mul_u32_u24 v22, 27648, v3
    v_add_u32 v7, v7, v22
    s_movk_i32 s59, 6912
    s_movk_i32 s60, 13824
    s_movk_i32 s61, 20736
    s_add_u32 s80, s76, 2478080
    buffer_load_dwordx4 a[176:179], v249, s[72:75], s80 offen offset:0 sc1
    buffer_load_dwordx4 a[180:183], v249, s[72:75], s80 offen offset:1024 sc1
    buffer_load_dwordx4 a[184:187], v249, s[72:75], s80 offen offset:2048 sc1
    buffer_load_dwordx4 a[188:191], v249, s[72:75], s80 offen offset:3072 sc1
    s_add_u32 s80, s76, 2482176
    buffer_load_dwordx4 a[192:195], v249, s[72:75], s80 offen offset:0 sc1
    buffer_load_dwordx4 a[196:199], v249, s[72:75], s80 offen offset:1024 sc1
    buffer_load_dwordx4 a[200:203], v249, s[72:75], s80 offen offset:2048 sc1
    buffer_load_dwordx4 a[204:207], v249, s[72:75], s80 offen offset:3072 sc1
    s_add_u32 s80, s76, 2486272
    buffer_load_dwordx4 a[208:211], v249, s[72:75], s80 offen offset:0 sc1
    buffer_load_dwordx4 a[212:215], v249, s[72:75], s80 offen offset:1024 sc1
    buffer_load_dwordx4 a[216:219], v249, s[72:75], s80 offen offset:2048 sc1
    buffer_load_dwordx4 a[220:223], v249, s[72:75], s80 offen offset:3072 sc1
    buffer_load_dword v152, v7, s[32:35], 0 offen sc1
    buffer_load_dword v153, v7, s[32:35], s59 offen sc1
    buffer_load_dword v154, v7, s[32:35], s60 offen sc1
    buffer_load_dword v155, v7, s[32:35], s61 offen sc1
    v_lshlrev_b32 v20, 11, v3
    v_lshl_add_u32 v8, v2, 4, v20
    v_add_u32 v9, 0x10000, v8
    v_add_u32 v10, 0x20000, v8
    s_cmp_lg_u32 s16, 0
    s_cbranch_scc1 we_done_13
    s_add_u32 s100, s17, 24
    s_lshl_b32 s100, s100, 7
    s_add_u32 s100, s100, s97
    v_mov_b32 v250, s100
    s_mov_b64 exec, 1
    global_load_dword v251, v250, s[98:99] sc1
    s_mov_b64 exec, -1
we_done_13:
    s_add_u32 s20, s15, 35917824
    s_add_u32 s20, s20, s6
    s_addc_u32 s21, s7, 0
    s_and_b32 s21, s21, 0xffff
    s_mov_b32 s22, 2621440
    s_mov_b32 s23, 0x20000
    s_add_u32 s28, s15, 41160704
    s_add_u32 s28, s28, s6
    s_addc_u32 s29, s7, 0
    s_and_b32 s29, s29, 0xffff
    s_mov_b32 s30, 131072
    s_mov_b32 s31, 0x20000
    s_lshl_b32 s36, s17, 7
    s_lshl_b32 s37, s16, 5
    s_add_u32 s36, s36, s37
    v_add_u32 v20, s36, v2
    v_lshlrev_b32 v20, 3, v20
    v_lshlrev_b32 v4, 16, v3
    v_add_u32 v4, v4, v20
    s_mul_i32 s38, s16, 65536
    s_lshl_b32 s37, s17, 11
    s_add_u32 s38, s38, s37
    s_lshl_b32 s40, s16, 12
    s_movk_i32 s56, 16384
    s_mov_b32 s57, 32768
    s_mov_b32 s58, 49152
    s_lshl_b32 s43, s16, 7
    v_lshl_add_u32 v28, v2, 2, s43
    v_add_u32 v28, 147456, v28
    v_lshlrev_b32 v29, 2, v2
    v_add_u32 v29, 147456, v29
    v_lshlrev_b32 v30, 4, v3
    v_add_u32 v31, 147456, v30
    v_add_u32 v30, s43, v30
    v_add_u32 v30, 148480, v30
    s_add_u32 s48, s15, 28839936
    s_add_u32 s48, s48, s6
    s_addc_u32 s49, s7, 0
    s_and_b32 s49, s49, 0xffff
    s_mov_b32 s50, 7077888
    s_mov_b32 s51, 0x20000
    s_lshl_b32 s45, s19, 2
    v_add_u32 v22, s45, v3
    v_mov_b32 v23, 32768
    v_mul_lo_u32 v22, v22, v23
    s_lshl_b32 s47, s17, 11
    v_lshl_add_u32 v22, v2, 4, v22
    v_add_u32 v168, s47, v22
    v_add_u32 v170, 65536, v168
    v_mov_b32 v24, 0xbfb8aa3b
    v_mov_b32 v26, 1.0
    s_cmp_lg_u32 s16, 0
    s_cbranch_scc1 wt_done_14
    s_add_u32 s100, s17, 24
    s_lshl_b32 s100, s100, 7
    s_add_u32 s100, s100, s97
    v_mov_b32 v250, s100
    s_mov_b32 s101, 0
    s_mov_b64 exec, 1
    s_waitcnt vmcnt(0)
    v_cmp_le_u32 vcc, 16, v251
    s_nop 0
    s_cmp_eq_u64 vcc, exec
    s_cbranch_scc1 wt_ok_14
wt_poll_14:
    global_load_dword v251, v250, s[98:99] sc1
    s_add_u32 s101, s101, 1
    s_waitcnt vmcnt(0)
    v_cmp_le_u32 vcc, 16, v251
    s_cmp_ge_u32 s101, 262144
    s_cbranch_scc1 wt_ok_14
    s_cmp_eq_u64 vcc, exec
    s_cbranch_scc1 wt_ok_14
    s_sleep 1
    s_branch wt_poll_14
wt_ok_14:
    s_mov_b64 exec, -1
wt_done_14:
    s_barrier
    s_add_u32 m0, s40, 0
    s_add_u32 s42, s38, 0
    buffer_load_dwordx4 v6, s[20:23], s42 offen offset:0 sc1 lds
    buffer_load_dwordx4 v6, s[20:23], s42 offen offset:1024 sc1 lds
    s_add_u32 m0, s40, 2048
    s_add_u32 s42, s38, 32768
    buffer_load_dwordx4 v6, s[20:23], s42 offen offset:0 sc1 lds
    buffer_load_dwordx4 v6, s[20:23], s42 offen offset:1024 sc1 lds
    buffer_load_dwordx2 v[144:145], v4, s[28:31], 0 offen sc1
    buffer_load_dwordx2 v[146:147], v4, s[28:31], s56 offen sc1
    buffer_load_dwordx2 v[148:149], v4, s[28:31], s57 offen sc1
    buffer_load_dwordx2 v[150:151], v4, s[28:31], s58 offen sc1
    s_add_u32 m0, s40, 16384
    s_add_u32 s42, s38, 262144
    buffer_load_dwordx4 v6, s[20:23], s42 offen offset:0 sc1 lds
    buffer_load_dwordx4 v6, s[20:23], s42 offen offset:1024 sc1 lds
    s_add_u32 m0, s40, 18432
    s_add_u32 s42, s38, 294912
    buffer_load_dwordx4 v6, s[20:23], s42 offen offset:0 sc1 lds
    buffer_load_dwordx4 v6, s[20:23], s42 offen offset:1024 sc1 lds
    s_add_u32 m0, s40, 32768
    s_add_u32 s42, s38, 524288
    buffer_load_dwordx4 v6, s[20:23], s42 offen offset:0 sc1 lds
    buffer_load_dwordx4 v6, s[20:23], s42 offen offset:1024 sc1 lds
    s_add_u32 m0, s40, 34816
    s_add_u32 s42, s38, 557056
    buffer_load_dwordx4 v6, s[20:23], s42 offen offset:0 sc1 lds
    buffer_load_dwordx4 v6, s[20:23], s42 offen offset:1024 sc1 lds
    s_waitcnt vmcnt(12)
    s_barrier
interleave_layers__mha_block__dense_activation_silu__prompt_kernel_up_loop_ct:
    ds_read_b128 v[32:35], v8 offset:0
    ds_read_b128 v[36:39], v8 offset:512
    ds_read_b128 v[40:43], v8 offset:1024
    ds_read_b128 v[44:47], v8 offset:1536
    ds_read_b128 v[48:51], v8 offset:4096
    ds_read_b128 v[52:55], v8 offset:4608
    ds_read_b128 v[56:59], v8 offset:5120
    ds_read_b128 v[60:63], v8 offset:5632
    s_waitcnt lgkmcnt(4)
    v_mfma_f32_32x32x16_bf16 v[80:95], a[96:99], v[32:35], 0
    ds_read_b128 v[64:67], v8 offset:8192
    s_add_u32 m0, s40, 49152
    s_add_u32 s42, s38, 786432
    buffer_load_dwordx4 v6, s[20:23], s42 offen offset:0 sc1 lds
    v_mfma_f32_32x32x16_bf16 v[96:111], a[96:99], v[36:39], 0
    ds_read_b128 v[68:71], v8 offset:8704
    v_mfma_f32_32x32x16_bf16 v[112:127], a[96:99], v[40:43], 0
    ds_read_b128 v[72:75], v8 offset:9216
    buffer_load_dwordx4 v6, s[20:23], s42 offen offset:1024 sc1 lds
    v_mfma_f32_32x32x16_bf16 v[128:143], a[96:99], v[44:47], 0
    ds_read_b128 v[76:79], v8 offset:9728
    s_waitcnt lgkmcnt(4)
    v_mfma_f32_32x32x16_bf16 v[80:95], a[100:103], v[48:51], v[80:95]
    ds_read_b128 v[32:35], v8 offset:12288
    s_add_u32 m0, s40, 51200
    s_add_u32 s42, s38, 819200
    buffer_load_dwordx4 v6, s[20:23], s42 offen offset:0 sc1 lds
    v_mfma_f32_32x32x16_bf16 v[96:111], a[100:103], v[52:55], v[96:111]
    ds_read_b128 v[36:39], v8 offset:12800
    v_mfma_f32_32x32x16_bf16 v[112:127], a[100:103], v[56:59], v[112:127]
    ds_read_b128 v[40:43], v8 offset:13312
    buffer_load_dwordx4 v6, s[20:23], s42 offen offset:1024 sc1 lds
    v_mfma_f32_32x32x16_bf16 v[128:143], a[100:103], v[60:63], v[128:143]
    ds_read_b128 v[44:47], v8 offset:13824
    s_waitcnt vmcnt(8)
    s_barrier
    s_waitcnt lgkmcnt(4)
    v_mfma_f32_32x32x16_bf16 v[80:95], a[104:107], v[64:67], v[80:95]
    ds_read_b128 v[48:51], v8 offset:16384
    s_add_u32 m0, s40, 65536
    s_add_u32 s42, s38, 1048576
    buffer_load_dwordx4 v6, s[20:23], s42 offen offset:0 sc1 lds
    v_mfma_f32_32x32x16_bf16 v[96:111], a[104:107], v[68:71], v[96:111]
    ds_read_b128 v[52:55], v8 offset:16896
    v_mfma_f32_32x32x16_bf16 v[112:127], a[104:107], v[72:75], v[112:127]
    ds_read_b128 v[56:59], v8 offset:17408
    buffer_load_dwordx4 v6, s[20:23], s42 offen offset:1024 sc1 lds
    v_mfma_f32_32x32x16_bf16 v[128:143], a[104:107], v[76:79], v[128:143]
    ds_read_b128 v[60:63], v8 offset:17920
    s_waitcnt lgkmcnt(4)
    v_mfma_f32_32x32x16_bf16 v[80:95], a[108:111], v[32:35], v[80:95]
    ds_read_b128 v[64:67], v8 offset:20480
    s_add_u32 m0, s40, 67584
    s_add_u32 s42, s38, 1081344
    buffer_load_dwordx4 v6, s[20:23], s42 offen offset:0 sc1 lds
    v_mfma_f32_32x32x16_bf16 v[96:111], a[108:111], v[36:39], v[96:111]
    ds_read_b128 v[68:71], v8 offset:20992
    v_add_f32 v144, v144, v146
    v_add_f32 v145, v145, v147
    v_add_f32 v148, v148, v150
    v_add_f32 v149, v149, v151
    v_mfma_f32_32x32x16_bf16 v[112:127], a[108:111], v[40:43], v[112:127]
    ds_read_b128 v[72:75], v8 offset:21504
    buffer_load_dwordx4 v6, s[20:23], s42 offen offset:1024 sc1 lds
    v_mfma_f32_32x32x16_bf16 v[128:143], a[108:111], v[44:47], v[128:143]
    ds_read_b128 v[76:79], v8 offset:22016
    v_add_f32 v144, v144, v148
    v_add_f32 v145, v145, v149
    v_add_f32 v152, v152, v153
    v_add_f32 v154, v154, v155
    s_waitcnt lgkmcnt(4)
    v_mfma_f32_32x32x16_bf16 v[80:95], a[112:115], v[48:51], v[80:95]
    ds_read_b128 v[32:35], v8 offset:24576
    s_add_u32 m0, s79, 81920
    s_add_u32 s81, s78, 0
    buffer_load_dwordx4 v249, s[72:75], s81 offen offset:0 sc1 lds
    v_mfma_f32_32x32x16_bf16 v[96:111], a[112:115], v[52:55], v[96:111]
    ds_read_b128 v[36:39], v8 offset:25088
    v_mov_b32 v146, v144
    v_mov_b32 v147, v145
    v_add_f32 v156, v152, v154
    v_add_f32 v157, v152, v154
    v_mfma_f32_32x32x16_bf16 v[112:127], a[112:115], v[56:59], v[112:127]
    ds_read_b128 v[40:43], v8 offset:25600
    buffer_load_dwordx4 v249, s[72:75], s81 offen offset:1024 sc1 lds
    v_mfma_f32_32x32x16_bf16 v[128:143], a[112:115], v[60:63], v[128:143]
    ds_read_b128 v[44:47], v8 offset:26112
    s_nop 0
    v_permlane32_swap_b32 v144, v146
    v_permlane32_swap_b32 v145, v147
    v_permlane32_swap_b32 v156, v157
    s_waitcnt lgkmcnt(4)
    v_mfma_f32_32x32x16_bf16 v[80:95], a[116:119], v[64:67], v[80:95]
    ds_read_b128 v[48:51], v8 offset:28672
    buffer_load_dwordx4 v249, s[72:75], s81 offen offset:2048 sc1 lds
    v_mfma_f32_32x32x16_bf16 v[96:111], a[116:119], v[68:71], v[96:111]
    ds_read_b128 v[52:55], v8 offset:29184
    v_add_f32 v144, v144, v146
    v_add_f32 v145, v145, v147
    v_add_f32 v156, v156, v157
    v_mul_f32 v144, 0x3acccccd, v144
    v_mfma_f32_32x32x16_bf16 v[112:127], a[116:119], v[72:75], v[112:127]
    ds_read_b128 v[56:59], v8 offset:29696
    buffer_load_dwordx4 v249, s[72:75], s81 offen offset:3072 sc1 lds
    v_mfma_f32_32x32x16_bf16 v[128:143], a[116:119], v[76:79], v[128:143]
    ds_read_b128 v[60:63], v8 offset:30208
    v_mul_f32 v145, 0x3acccccd, v145
    v_fma_f32 v145, -v144, v144, v145
    v_max_f32 v145, 0, v145
    v_add_f32 v145, 0x3727c5ac, v145
    s_waitcnt vmcnt(12)
    s_barrier
    s_waitcnt lgkmcnt(4)
    v_mfma_f32_32x32x16_bf16 v[80:95], a[120:123], v[32:35], v[80:95]
    ds_read_b128 v[64:67], v8 offset:32768
    s_add_u32 m0, s79, 86016
    s_add_u32 s81, s78, 4096
    buffer_load_dwordx4 v249, s[72:75], s81 offen offset:0 sc1 lds
    v_mfma_f32_32x32x16_bf16 v[96:111], a[120:123], v[36:39], v[96:111]
    ds_read_b128 v[68:71], v8 offset:33280
    v_rsq_f32 v145, v145
    s_nop 0
    v_mul_f32 v146, v144, v145
    v_mfma_f32_32x32x16_bf16 v[112:127], a[120:123], v[40:43], v[112:127]
    ds_read_b128 v[72:75], v8 offset:33792
    s_add_u32 m0, s40, 0
    s_add_u32 s42, s38, 1310720
    buffer_load_dwordx4 v6, s[20:23], s42 offen offset:0 sc1 lds
    v_mfma_f32_32x32x16_bf16 v[128:143], a[120:123], v[44:47], v[128:143]
    ds_read_b128 v[76:79], v8 offset:34304
    v_sub_f32 v146, 0, v146
    ds_write_b32 v28, v145
    ds_write_b32 v28, v146 offset:512
    ds_write_b32 v28, v156 offset:1024
    s_waitcnt lgkmcnt(7)
    v_mfma_f32_32x32x16_bf16 v[80:95], a[124:127], v[48:51], v[80:95]
    ds_read_b128 v[32:35], v8 offset:36864
    buffer_load_dwordx4 v6, s[20:23], s42 offen offset:1024 sc1 lds
    v_mfma_f32_32x32x16_bf16 v[96:111], a[124:127], v[52:55], v[96:111]
    ds_read_b128 v[36:39], v8 offset:37376
    v_mfma_f32_32x32x16_bf16 v[112:127], a[124:127], v[56:59], v[112:127]
    ds_read_b128 v[40:43], v8 offset:37888
    s_add_u32 m0, s40, 2048
    s_add_u32 s42, s38, 1343488
    buffer_load_dwordx4 v6, s[20:23], s42 offen offset:0 sc1 lds
    v_mfma_f32_32x32x16_bf16 v[128:143], a[124:127], v[60:63], v[128:143]
    ds_read_b128 v[44:47], v8 offset:38400
    s_waitcnt lgkmcnt(7)
    v_mfma_f32_32x32x16_bf16 v[80:95], a[128:131], v[64:67], v[80:95]
    ds_read_b128 v[48:51], v8 offset:40960
    buffer_load_dwordx4 v6, s[20:23], s42 offen offset:1024 sc1 lds
    v_mfma_f32_32x32x16_bf16 v[96:111], a[128:131], v[68:71], v[96:111]
    ds_read_b128 v[52:55], v8 offset:41472
    v_mfma_f32_32x32x16_bf16 v[112:127], a[128:131], v[72:75], v[112:127]
    ds_read_b128 v[56:59], v8 offset:41984
    s_add_u32 m0, s79, 102400
    s_add_u32 s81, s78, 20480
    buffer_load_dwordx4 v249, s[72:75], s81 offen offset:0 sc1 lds
    v_mfma_f32_32x32x16_bf16 v[128:143], a[128:131], v[76:79], v[128:143]
    ds_read_b128 v[60:63], v8 offset:42496
    s_waitcnt lgkmcnt(4)
    v_mfma_f32_32x32x16_bf16 v[80:95], a[132:135], v[32:35], v[80:95]
    ds_read_b128 v[64:67], v8 offset:45056
    buffer_load_dwordx4 v249, s[72:75], s81 offen offset:1024 sc1 lds
    v_mfma_f32_32x32x16_bf16 v[96:111], a[132:135], v[36:39], v[96:111]
    ds_read_b128 v[68:71], v8 offset:45568
    v_mfma_f32_32x32x16_bf16 v[112:127], a[132:135], v[40:43], v[112:127]
    ds_read_b128 v[72:75], v8 offset:46080
    buffer_load_dwordx4 v249, s[72:75], s81 offen offset:2048 sc1 lds
    v_mfma_f32_32x32x16_bf16 v[128:143], a[132:135], v[44:47], v[128:143]
    ds_read_b128 v[76:79], v8 offset:46592
    s_waitcnt vmcnt(16)
    s_barrier
    s_waitcnt lgkmcnt(4)
    v_mfma_f32_32x32x16_bf16 v[80:95], a[136:139], v[48:51], v[80:95]
    ds_read_b128 v[32:35], v8 offset:49152
    buffer_load_dwordx4 v249, s[72:75], s81 offen offset:3072 sc1 lds
    v_mfma_f32_32x32x16_bf16 v[96:111], a[136:139], v[52:55], v[96:111]
    ds_read_b128 v[36:39], v8 offset:49664
    v_mfma_f32_32x32x16_bf16 v[112:127], a[136:139], v[56:59], v[112:127]
    ds_read_b128 v[40:43], v8 offset:50176
    s_add_u32 m0, s79, 106496
    s_add_u32 s81, s78, 24576
    buffer_load_dwordx4 v249, s[72:75], s81 offen offset:0 sc1 lds
    v_mfma_f32_32x32x16_bf16 v[128:143], a[136:139], v[60:63], v[128:143]
    ds_read_b128 v[44:47], v8 offset:50688
    s_waitcnt lgkmcnt(4)
    v_mfma_f32_32x32x16_bf16 v[80:95], a[140:143], v[64:67], v[80:95]
    ds_read_b128 v[48:51], v8 offset:53248
    s_add_u32 m0, s40, 16384
    s_add_u32 s42, s38, 1572864
    buffer_load_dwordx4 v6, s[20:23], s42 offen offset:0 sc1 lds
    v_mfma_f32_32x32x16_bf16 v[96:111], a[140:143], v[68:71], v[96:111]
    ds_read_b128 v[52:55], v8 offset:53760
    v_mfma_f32_32x32x16_bf16 v[112:127], a[140:143], v[72:75], v[112:127]
    ds_read_b128 v[56:59], v8 offset:54272
    buffer_load_dwordx4 v6, s[20:23], s42 offen offset:1024 sc1 lds
    v_mfma_f32_32x32x16_bf16 v[128:143], a[140:143], v[76:79], v[128:143]
    ds_read_b128 v[60:63], v8 offset:54784
    s_waitcnt lgkmcnt(4)
    v_mfma_f32_32x32x16_bf16 v[80:95], a[144:147], v[32:35], v[80:95]
    ds_read_b128 v[64:67], v8 offset:57344
    s_add_u32 m0, s40, 18432
    s_add_u32 s42, s38, 1605632
    buffer_load_dwordx4 v6, s[20:23], s42 offen offset:0 sc1 lds
    v_mfma_f32_32x32x16_bf16 v[96:111], a[144:147], v[36:39], v[96:111]
    ds_read_b128 v[68:71], v8 offset:57856
    v_mfma_f32_32x32x16_bf16 v[112:127], a[144:147], v[40:43], v[112:127]
    ds_read_b128 v[72:75], v8 offset:58368
    buffer_load_dwordx4 v6, s[20:23], s42 offen offset:1024 sc1 lds
    v_mfma_f32_32x32x16_bf16 v[128:143], a[144:147], v[44:47], v[128:143]
    ds_read_b128 v[76:79], v8 offset:58880
    s_waitcnt lgkmcnt(4)
    v_mfma_f32_32x32x16_bf16 v[80:95], a[148:151], v[48:51], v[80:95]
    ds_read_b128 v[32:35], v8 offset:61440
    s_add_u32 m0, s79, 122880
    s_add_u32 s81, s78, 40960
    buffer_load_dwordx4 v249, s[72:75], s81 offen offset:0 sc1 lds
    v_mfma_f32_32x32x16_bf16 v[96:111], a[148:151], v[52:55], v[96:111]
    ds_read_b128 v[36:39], v8 offset:61952
    v_mfma_f32_32x32x16_bf16 v[112:127], a[148:151], v[56:59], v[112:127]
    ds_read_b128 v[40:43], v8 offset:62464
    buffer_load_dwordx4 v249, s[72:75], s81 offen offset:1024 sc1 lds
    v_mfma_f32_32x32x16_bf16 v[128:143], a[148:151], v[60:63], v[128:143]
    ds_read_b128 v[44:47], v8 offset:62976
    s_waitcnt vmcnt(20)
    s_barrier
    s_waitcnt lgkmcnt(4)
    v_mfma_f32_32x32x16_bf16 v[80:95], a[152:155], v[64:67], v[80:95]
    ds_read_b128 v[48:51], v9 offset:0
    buffer_load_dwordx4 v249, s[72:75], s81 offen offset:2048 sc1 lds
    v_mfma_f32_32x32x16_bf16 v[96:111], a[152:155], v[68:71], v[96:111]
    ds_read_b128 v[52:55], v9 offset:512
    v_mfma_f32_32x32x16_bf16 v[112:127], a[152:155], v[72:75], v[112:127]
    ds_read_b128 v[56:59], v9 offset:1024
    buffer_load_dwordx4 v249, s[72:75], s81 offen offset:3072 sc1 lds
    v_mfma_f32_32x32x16_bf16 v[128:143], a[152:155], v[76:79], v[128:143]
    ds_read_b128 v[60:63], v9 offset:1536
    s_waitcnt lgkmcnt(4)
    v_mfma_f32_32x32x16_bf16 v[80:95], a[156:159], v[32:35], v[80:95]
    ds_read_b128 v[64:67], v9 offset:4096
    s_add_u32 m0, s79, 126976
    s_add_u32 s81, s78, 45056
    buffer_load_dwordx4 v249, s[72:75], s81 offen offset:0 sc1 lds
    v_mfma_f32_32x32x16_bf16 v[96:111], a[156:159], v[36:39], v[96:111]
    ds_read_b128 v[68:71], v9 offset:4608
    ds_read_b32 v144, v29 offset:0
    ds_read_b32 v145, v29 offset:512
    ds_read_b32 v146, v29 offset:128
    ds_read_b32 v147, v29 offset:640
    v_mfma_f32_32x32x16_bf16 v[112:127], a[156:159], v[40:43], v[112:127]
    ds_read_b128 v[72:75], v9 offset:5120
    s_add_u32 m0, s40, 32768
    s_add_u32 s42, s38, 1835008
    buffer_load_dwordx4 v6, s[20:23], s42 offen offset:0 sc1 lds
    v_mfma_f32_32x32x16_bf16 v[128:143], a[156:159], v[44:47], v[128:143]
    ds_read_b128 v[76:79], v9 offset:5632
    ds_read_b32 v148, v29 offset:256
    ds_read_b32 v149, v29 offset:768
    ds_read_b32 v150, v29 offset:384
    ds_read_b32 v151, v29 offset:896
    s_waitcnt lgkmcnt(12)
    v_mfma_f32_32x32x16_bf16 v[80:95], a[160:163], v[48:51], v[80:95]
    ds_read_b128 v[32:35], v9 offset:8192
    buffer_load_dwordx4 v6, s[20:23], s42 offen offset:1024 sc1 lds
    v_mfma_f32_32x32x16_bf16 v[96:111], a[160:163], v[52:55], v[96:111]
    ds_read_b128 v[36:39], v9 offset:8704
    ds_read_b128 v[152:155], v30 offset:0
    ds_read_b128 v[156:159], v30 offset:32
    ds_read_b128 v[160:163], v30 offset:64
    ds_read_b128 v[164:167], v30 offset:96
    v_mfma_f32_32x32x16_bf16 v[112:127], a[160:163], v[56:59], v[112:127]
    ds_read_b128 v[40:43], v9 offset:9216
    s_add_u32 m0, s40, 34816
    s_add_u32 s42, s38, 1867776
    buffer_load_dwordx4 v6, s[20:23], s42 offen offset:0 sc1 lds
    v_mfma_f32_32x32x16_bf16 v[128:143], a[160:163], v[60:63], v[128:143]
    ds_read_b128 v[44:47], v9 offset:9728
    s_waitcnt lgkmcnt(12)
    v_mfma_f32_32x32x16_bf16 v[80:95], a[164:167], v[64:67], v[80:95]
    ds_read_b128 v[48:51], v9 offset:12288
    buffer_load_dwordx4 v6, s[20:23], s42 offen offset:1024 sc1 lds
    v_mfma_f32_32x32x16_bf16 v[96:111], a[164:167], v[68:71], v[96:111]
    ds_read_b128 v[52:55], v9 offset:12800
    s_waitcnt lgkmcnt(4)
    v_mul_f32 v144, v24, v144
    v_mul_f32 v145, v24, v145
    v_mul_f32 v146, v24, v146
    v_mfma_f32_32x32x16_bf16 v[112:127], a[164:167], v[72:75], v[112:127]
    ds_read_b128 v[56:59], v9 offset:13312
    s_add_u32 s80, s76, 2490368
    buffer_load_dwordx4 a[224:227], v249, s[72:75], s80 offen offset:0 sc1
    v_mfma_f32_32x32x16_bf16 v[128:143], a[164:167], v[76:79], v[128:143]
    ds_read_b128 v[60:63], v9 offset:13824
    v_mul_f32 v147, v24, v147
    v_mul_f32 v148, v24, v148
    v_mul_f32 v149, v24, v149
    v_mul_f32 v150, v24, v150
    s_waitcnt vmcnt(19)
    s_barrier
    s_waitcnt lgkmcnt(4)
    v_mfma_f32_32x32x16_bf16 v[80:95], a[168:171], v[32:35], v[80:95]
    ds_read_b128 v[64:67], v8 offset:0
    buffer_load_dwordx4 a[228:231], v249, s[72:75], s80 offen offset:1024 sc1
    v_mfma_f32_32x32x16_bf16 v[96:111], a[168:171], v[36:39], v[96:111]
    ds_read_b128 v[68:71], v8 offset:512
    v_mul_f32 v151, v24, v151
    v_mfma_f32_32x32x16_bf16 v[112:127], a[168:171], v[40:43], v[112:127]
    ds_read_b128 v[72:75], v8 offset:1024
    buffer_load_dwordx4 a[232:235], v249, s[72:75], s80 offen offset:2048 sc1
    v_mfma_f32_32x32x16_bf16 v[128:143], a[168:171], v[44:47], v[128:143]
    ds_read_b128 v[76:79], v8 offset:1536
    s_waitcnt lgkmcnt(4)
    v_mfma_f32_32x32x16_bf16 v[80:95], a[172:175], v[48:51], v[80:95]
    ds_read_b128 v[32:35], v8 offset:4096
    buffer_load_dwordx4 a[236:239], v249, s[72:75], s80 offen offset:3072 sc1
    v_mfma_f32_32x32x16_bf16 v[96:111], a[172:175], v[52:55], v[96:111]
    ds_read_b128 v[36:39], v8 offset:4608
    v_mfma_f32_32x32x16_bf16 v[112:127], a[172:175], v[56:59], v[112:127]
    ds_read_b128 v[40:43], v8 offset:5120
    s_add_u32 m0, s40, 49152
    s_add_u32 s42, s38, 2097152
    buffer_load_dwordx4 v6, s[20:23], s42 offen offset:0 sc1 lds
    v_mfma_f32_32x32x16_bf16 v[128:143], a[172:175], v[60:63], v[128:143]
    ds_read_b128 v[44:47], v8 offset:5632
    s_waitcnt lgkmcnt(4)
    v_mfma_f32_32x32x16_bf16 v[80:95], a[176:179], v[64:67], v[80:95]
    ds_read_b128 v[48:51], v8 offset:8192
    buffer_load_dwordx4 v6, s[20:23], s42 offen offset:1024 sc1 lds
    v_mfma_f32_32x32x16_bf16 v[96:111], a[176:179], v[68:71], v[96:111]
    ds_read_b128 v[52:55], v8 offset:8704
    v_mfma_f32_32x32x16_bf16 v[112:127], a[176:179], v[72:75], v[112:127]
    ds_read_b128 v[56:59], v8 offset:9216
    s_add_u32 m0, s40, 51200
    s_add_u32 s42, s38, 2129920
    buffer_load_dwordx4 v6, s[20:23], s42 offen offset:0 sc1 lds
    v_mfma_f32_32x32x16_bf16 v[128:143], a[176:179], v[76:79], v[128:143]
    ds_read_b128 v[60:63], v8 offset:9728
    s_waitcnt lgkmcnt(4)
    v_mfma_f32_32x32x16_bf16 v[80:95], a[180:183], v[32:35], v[80:95]
    ds_read_b128 v[64:67], v8 offset:12288
    buffer_load_dwordx4 v6, s[20:23], s42 offen offset:1024 sc1 lds
    v_mfma_f32_32x32x16_bf16 v[96:111], a[180:183], v[36:39], v[96:111]
    ds_read_b128 v[68:71], v8 offset:12800
    v_mfma_f32_32x32x16_bf16 v[112:127], a[180:183], v[40:43], v[112:127]
    ds_read_b128 v[72:75], v8 offset:13312
    s_add_u32 s80, s76, 2494464
    buffer_load_dwordx4 a[240:243], v249, s[72:75], s80 offen offset:0 sc1
    v_mfma_f32_32x32x16_bf16 v[128:143], a[180:183], v[44:47], v[128:143]
    ds_read_b128 v[76:79], v8 offset:13824
    s_waitcnt vmcnt(18)
    s_barrier
    s_waitcnt lgkmcnt(4)
    v_mfma_f32_32x32x16_bf16 v[80:95], a[184:187], v[48:51], v[80:95]
    ds_read_b128 v[32:35], v8 offset:16384
    buffer_load_dwordx4 a[244:247], v249, s[72:75], s80 offen offset:1024 sc1
    v_mfma_f32_32x32x16_bf16 v[96:111], a[184:187], v[52:55], v[96:111]
    ds_read_b128 v[36:39], v8 offset:16896
    v_mfma_f32_32x32x16_bf16 v[112:127], a[184:187], v[56:59], v[112:127]
    ds_read_b128 v[40:43], v8 offset:17408
    buffer_load_dwordx4 a[248:251], v249, s[72:75], s80 offen offset:2048 sc1
    v_mfma_f32_32x32x16_bf16 v[128:143], a[184:187], v[60:63], v[128:143]
    ds_read_b128 v[44:47], v8 offset:17920
    s_waitcnt lgkmcnt(4)
    v_mfma_f32_32x32x16_bf16 v[80:95], a[188:191], v[64:67], v[80:95]
    ds_read_b128 v[48:51], v8 offset:20480
    buffer_load_dwordx4 a[252:255], v249, s[72:75], s80 offen offset:3072 sc1
    v_mfma_f32_32x32x16_bf16 v[96:111], a[188:191], v[68:71], v[96:111]
    ds_read_b128 v[52:55], v8 offset:20992
    v_mfma_f32_32x32x16_bf16 v[112:127], a[188:191], v[72:75], v[112:127]
    ds_read_b128 v[56:59], v8 offset:21504
    s_add_u32 m0, s40, 65536
    s_add_u32 s42, s38, 2359296
    buffer_load_dwordx4 v6, s[20:23], s42 offen offset:0 sc1 lds
    v_mfma_f32_32x32x16_bf16 v[128:143], a[188:191], v[76:79], v[128:143]
    ds_read_b128 v[60:63], v8 offset:22016
    s_waitcnt lgkmcnt(4)
    v_mfma_f32_32x32x16_bf16 v[80:95], a[192:195], v[32:35], v[80:95]
    ds_read_b128 v[64:67], v8 offset:24576
    buffer_load_dwordx4 v6, s[20:23], s42 offen offset:1024 sc1 lds
    v_mfma_f32_32x32x16_bf16 v[96:111], a[192:195], v[36:39], v[96:111]
    ds_read_b128 v[68:71], v8 offset:25088
    v_mfma_f32_32x32x16_bf16 v[112:127], a[192:195], v[40:43], v[112:127]
    ds_read_b128 v[72:75], v8 offset:25600
    s_add_u32 m0, s40, 67584
    s_add_u32 s42, s38, 2392064
    buffer_load_dwordx4 v6, s[20:23], s42 offen offset:0 sc1 lds
    v_mfma_f32_32x32x16_bf16 v[128:143], a[192:195], v[44:47], v[128:143]
    ds_read_b128 v[76:79], v8 offset:26112
    s_waitcnt lgkmcnt(4)
    v_mfma_f32_32x32x16_bf16 v[80:95], a[196:199], v[48:51], v[80:95]
    ds_read_b128 v[32:35], v8 offset:28672
    buffer_load_dwordx4 v6, s[20:23], s42 offen offset:1024 sc1 lds
    v_mfma_f32_32x32x16_bf16 v[96:111], a[196:199], v[52:55], v[96:111]
    ds_read_b128 v[36:39], v8 offset:29184
    v_mfma_f32_32x32x16_bf16 v[112:127], a[196:199], v[56:59], v[112:127]
    ds_read_b128 v[40:43], v8 offset:29696
    v_mfma_f32_32x32x16_bf16 v[128:143], a[196:199], v[60:63], v[128:143]
    ds_read_b128 v[44:47], v8 offset:30208
    s_waitcnt vmcnt(16)
    s_barrier
    s_waitcnt lgkmcnt(4)
    v_mfma_f32_32x32x16_bf16 v[80:95], a[200:203], v[64:67], v[80:95]
    ds_read_b128 v[48:51], v8 offset:32768
    v_mfma_f32_32x32x16_bf16 v[96:111], a[200:203], v[68:71], v[96:111]
    ds_read_b128 v[52:55], v8 offset:33280
    v_mfma_f32_32x32x16_bf16 v[112:127], a[200:203], v[72:75], v[112:127]
    ds_read_b128 v[56:59], v8 offset:33792
    v_mfma_f32_32x32x16_bf16 v[128:143], a[200:203], v[76:79], v[128:143]
    ds_read_b128 v[60:63], v8 offset:34304
    s_waitcnt lgkmcnt(4)
    v_mfma_f32_32x32x16_bf16 v[80:95], a[204:207], v[32:35], v[80:95]
    ds_read_b128 v[64:67], v8 offset:36864
    v_mfma_f32_32x32x16_bf16 v[96:111], a[204:207], v[36:39], v[96:111]
    ds_read_b128 v[68:71], v8 offset:37376
    v_mfma_f32_32x32x16_bf16 v[112:127], a[204:207], v[40:43], v[112:127]
    ds_read_b128 v[72:75], v8 offset:37888
    v_mfma_f32_32x32x16_bf16 v[128:143], a[204:207], v[44:47], v[128:143]
    ds_read_b128 v[76:79], v8 offset:38400
    s_waitcnt lgkmcnt(4)
    v_mfma_f32_32x32x16_bf16 v[80:95], a[208:211], v[48:51], v[80:95]
    ds_read_b128 v[32:35], v8 offset:40960
    v_mfma_f32_32x32x16_bf16 v[96:111], a[208:211], v[52:55], v[96:111]
    ds_read_b128 v[36:39], v8 offset:41472
    v_mfma_f32_32x32x16_bf16 v[112:127], a[208:211], v[56:59], v[112:127]
    ds_read_b128 v[40:43], v8 offset:41984
    v_mfma_f32_32x32x16_bf16 v[128:143], a[208:211], v[60:63], v[128:143]
    ds_read_b128 v[44:47], v8 offset:42496
    s_waitcnt lgkmcnt(4)
    v_mfma_f32_32x32x16_bf16 v[80:95], a[212:215], v[64:67], v[80:95]
    ds_read_b128 v[48:51], v8 offset:45056
    v_mfma_f32_32x32x16_bf16 v[96:111], a[212:215], v[68:71], v[96:111]
    ds_read_b128 v[52:55], v8 offset:45568
    v_mfma_f32_32x32x16_bf16 v[112:127], a[212:215], v[72:75], v[112:127]
    ds_read_b128 v[56:59], v8 offset:46080
    v_mfma_f32_32x32x16_bf16 v[128:143], a[212:215], v[76:79], v[128:143]
    ds_read_b128 v[60:63], v8 offset:46592
    s_waitcnt vmcnt(8)
    s_barrier
    s_waitcnt lgkmcnt(4)
    v_mfma_f32_32x32x16_bf16 v[80:95], a[216:219], v[32:35], v[80:95]
    ds_read_b128 v[64:67], v8 offset:49152
    v_mfma_f32_32x32x16_bf16 v[96:111], a[216:219], v[36:39], v[96:111]
    ds_read_b128 v[68:71], v8 offset:49664
    v_mfma_f32_32x32x16_bf16 v[112:127], a[216:219], v[40:43], v[112:127]
    ds_read_b128 v[72:75], v8 offset:50176
    v_mfma_f32_32x32x16_bf16 v[128:143], a[216:219], v[44:47], v[128:143]
    ds_read_b128 v[76:79], v8 offset:50688
    s_waitcnt lgkmcnt(4)
    v_mfma_f32_32x32x16_bf16 v[80:95], a[220:223], v[48:51], v[80:95]
    ds_read_b128 v[32:35], v8 offset:53248
    v_mfma_f32_32x32x16_bf16 v[96:111], a[220:223], v[52:55], v[96:111]
    ds_read_b128 v[36:39], v8 offset:53760
    v_mfma_f32_32x32x16_bf16 v[112:127], a[220:223], v[56:59], v[112:127]
    ds_read_b128 v[40:43], v8 offset:54272
    v_mfma_f32_32x32x16_bf16 v[128:143], a[220:223], v[60:63], v[128:143]
    ds_read_b128 v[44:47], v8 offset:54784
    s_waitcnt lgkmcnt(4)
    v_mfma_f32_32x32x16_bf16 v[80:95], a[224:227], v[64:67], v[80:95]
    ds_read_b128 v[48:51], v8 offset:57344
    v_mfma_f32_32x32x16_bf16 v[96:111], a[224:227], v[68:71], v[96:111]
    ds_read_b128 v[52:55], v8 offset:57856
    v_mfma_f32_32x32x16_bf16 v[112:127], a[224:227], v[72:75], v[112:127]
    ds_read_b128 v[56:59], v8 offset:58368
    v_mfma_f32_32x32x16_bf16 v[128:143], a[224:227], v[76:79], v[128:143]
    ds_read_b128 v[60:63], v8 offset:58880
    s_waitcnt lgkmcnt(4)
    v_mfma_f32_32x32x16_bf16 v[80:95], a[228:231], v[32:35], v[80:95]
    ds_read_b128 v[64:67], v8 offset:61440
    v_mfma_f32_32x32x16_bf16 v[96:111], a[228:231], v[36:39], v[96:111]
    ds_read_b128 v[68:71], v8 offset:61952
    v_mfma_f32_32x32x16_bf16 v[112:127], a[228:231], v[40:43], v[112:127]
    ds_read_b128 v[72:75], v8 offset:62464
    v_mfma_f32_32x32x16_bf16 v[128:143], a[228:231], v[44:47], v[128:143]
    ds_read_b128 v[76:79], v8 offset:62976
    s_waitcnt vmcnt(0)
    s_barrier
    s_waitcnt lgkmcnt(4)
    v_mfma_f32_32x32x16_bf16 v[80:95], a[232:235], v[48:51], v[80:95]
    ds_read_b128 v[32:35], v9 offset:0
    v_mfma_f32_32x32x16_bf16 v[96:111], a[232:235], v[52:55], v[96:111]
    ds_read_b128 v[36:39], v9 offset:512
    v_mfma_f32_32x32x16_bf16 v[112:127], a[232:235], v[56:59], v[112:127]
    ds_read_b128 v[40:43], v9 offset:1024
    v_mfma_f32_32x32x16_bf16 v[128:143], a[232:235], v[60:63], v[128:143]
    ds_read_b128 v[44:47], v9 offset:1536
    s_waitcnt lgkmcnt(4)
    v_mfma_f32_32x32x16_bf16 v[80:95], a[236:239], v[64:67], v[80:95]
    ds_read_b128 v[48:51], v9 offset:4096
    v_mfma_f32_32x32x16_bf16 v[96:111], a[236:239], v[68:71], v[96:111]
    ds_read_b128 v[52:55], v9 offset:4608
    v_mfma_f32_32x32x16_bf16 v[112:127], a[236:239], v[72:75], v[112:127]
    ds_read_b128 v[56:59], v9 offset:5120
    v_mfma_f32_32x32x16_bf16 v[128:143], a[236:239], v[76:79], v[128:143]
    ds_read_b128 v[60:63], v9 offset:5632
    s_waitcnt lgkmcnt(4)
    v_mfma_f32_32x32x16_bf16 v[80:95], a[240:243], v[32:35], v[80:95]
    ds_read_b128 v[64:67], v9 offset:8192
    v_mfma_f32_32x32x16_bf16 v[96:111], a[240:243], v[36:39], v[96:111]
    ds_read_b128 v[68:71], v9 offset:8704
    v_mfma_f32_32x32x16_bf16 v[112:127], a[240:243], v[40:43], v[112:127]
    ds_read_b128 v[72:75], v9 offset:9216
    v_mfma_f32_32x32x16_bf16 v[128:143], a[240:243], v[44:47], v[128:143]
    ds_read_b128 v[76:79], v9 offset:9728
    s_waitcnt lgkmcnt(4)
    v_mfma_f32_32x32x16_bf16 v[80:95], a[244:247], v[48:51], v[80:95]
    ds_read_b128 v[32:35], v9 offset:12288
    v_mfma_f32_32x32x16_bf16 v[96:111], a[244:247], v[52:55], v[96:111]
    ds_read_b128 v[36:39], v9 offset:12800
    v_mfma_f32_32x32x16_bf16 v[112:127], a[244:247], v[56:59], v[112:127]
    ds_read_b128 v[40:43], v9 offset:13312
    v_mfma_f32_32x32x16_bf16 v[128:143], a[244:247], v[60:63], v[128:143]
    ds_read_b128 v[44:47], v9 offset:13824
    s_waitcnt lgkmcnt(4)
    v_mfma_f32_32x32x16_bf16 v[80:95], a[248:251], v[64:67], v[80:95]
    v_mfma_f32_32x32x16_bf16 v[96:111], a[248:251], v[68:71], v[96:111]
    v_mfma_f32_32x32x16_bf16 v[112:127], a[248:251], v[72:75], v[112:127]
    v_mfma_f32_32x32x16_bf16 v[128:143], a[248:251], v[76:79], v[128:143]
    s_waitcnt lgkmcnt(0)
    v_mfma_f32_32x32x16_bf16 v[80:95], a[252:255], v[32:35], v[80:95]
    v_mfma_f32_32x32x16_bf16 v[96:111], a[252:255], v[36:39], v[96:111]
    v_mfma_f32_32x32x16_bf16 v[112:127], a[252:255], v[40:43], v[112:127]
    v_mfma_f32_32x32x16_bf16 v[128:143], a[252:255], v[44:47], v[128:143]
    v_pk_mul_f32 v[176:177], v[152:153], v[144:145] op_sel:[0,1] op_sel_hi:[1,1]
    v_pk_mul_f32 v[178:179], v[154:155], v[144:145] op_sel:[0,1] op_sel_hi:[1,1]
    v_pk_mul_f32 v[180:181], v[156:157], v[144:145] op_sel:[0,1] op_sel_hi:[1,1]
    v_pk_mul_f32 v[182:183], v[158:159], v[144:145] op_sel:[0,1] op_sel_hi:[1,1]
    s_nop 4
    v_pk_fma_f32 v[176:177], v[80:81], v[144:145], v[176:177] op_sel_hi:[1,0,1]
    v_pk_fma_f32 v[178:179], v[82:83], v[144:145], v[178:179] op_sel_hi:[1,0,1]
    v_pk_fma_f32 v[180:181], v[84:85], v[144:145], v[180:181] op_sel_hi:[1,0,1]
    v_pk_fma_f32 v[182:183], v[86:87], v[144:145], v[182:183] op_sel_hi:[1,0,1]
    v_exp_f32 v184, v176
    v_exp_f32 v185, v177
    v_exp_f32 v186, v178
    v_exp_f32 v187, v179
    v_exp_f32 v188, v180
    v_exp_f32 v189, v181
    v_exp_f32 v190, v182
    v_exp_f32 v191, v183
    v_pk_fma_f32 v[184:185], v[184:185], v[24:25], v[24:25] op_sel_hi:[1,0,0]
    v_pk_fma_f32 v[186:187], v[186:187], v[24:25], v[24:25] op_sel_hi:[1,0,0]
    v_pk_fma_f32 v[188:189], v[188:189], v[24:25], v[24:25] op_sel_hi:[1,0,0]
    v_pk_fma_f32 v[190:191], v[190:191], v[24:25], v[24:25] op_sel_hi:[1,0,0]
    v_rcp_f32 v184, v184
    v_rcp_f32 v185, v185
    v_rcp_f32 v186, v186
    v_rcp_f32 v187, v187
    v_rcp_f32 v188, v188
    v_rcp_f32 v189, v189
    v_rcp_f32 v190, v190
    v_rcp_f32 v191, v191
    s_nop 0
    v_pk_mul_f32 v[176:177], v[176:177], v[184:185]
    v_pk_mul_f32 v[178:179], v[178:179], v[186:187]
    v_pk_mul_f32 v[180:181], v[180:181], v[188:189]
    v_pk_mul_f32 v[182:183], v[182:183], v[190:191]
    v_cvt_pk_bf16_f32 v192, v176, v177
    v_cvt_pk_bf16_f32 v193, v178, v179
    v_cvt_pk_bf16_f32 v194, v180, v181
    v_cvt_pk_bf16_f32 v195, v182, v183
    buffer_store_dwordx4 v[192:195], v168, s[48:51], 0 offen offset:0 sc1
    v_pk_mul_f32 v[176:177], v[160:161], v[144:145] op_sel:[0,1] op_sel_hi:[1,1]
    v_pk_mul_f32 v[178:179], v[162:163], v[144:145] op_sel:[0,1] op_sel_hi:[1,1]
    v_pk_mul_f32 v[180:181], v[164:165], v[144:145] op_sel:[0,1] op_sel_hi:[1,1]
    v_pk_mul_f32 v[182:183], v[166:167], v[144:145] op_sel:[0,1] op_sel_hi:[1,1]
    v_pk_fma_f32 v[176:177], v[88:89], v[144:145], v[176:177] op_sel_hi:[1,0,1]
    v_pk_fma_f32 v[178:179], v[90:91], v[144:145], v[178:179] op_sel_hi:[1,0,1]
    v_pk_fma_f32 v[180:181], v[92:93], v[144:145], v[180:181] op_sel_hi:[1,0,1]
    v_pk_fma_f32 v[182:183], v[94:95], v[144:145], v[182:183] op_sel_hi:[1,0,1]
    v_exp_f32 v184, v176
    v_exp_f32 v185, v177
    v_exp_f32 v186, v178
    v_exp_f32 v187, v179
    v_exp_f32 v188, v180
    v_exp_f32 v189, v181
    v_exp_f32 v190, v182
    v_exp_f32 v191, v183
    v_pk_fma_f32 v[184:185], v[184:185], v[24:25], v[24:25] op_sel_hi:[1,0,0]
    v_pk_fma_f32 v[186:187], v[186:187], v[24:25], v[24:25] op_sel_hi:[1,0,0]
    v_pk_fma_f32 v[188:189], v[188:189], v[24:25], v[24:25] op_sel_hi:[1,0,0]
    v_pk_fma_f32 v[190:191], v[190:191], v[24:25], v[24:25] op_sel_hi:[1,0,0]
    v_rcp_f32 v184, v184
    v_rcp_f32 v185, v185
    v_rcp_f32 v186, v186
    v_rcp_f32 v187, v187
    v_rcp_f32 v188, v188
    v_rcp_f32 v189, v189
    v_rcp_f32 v190, v190
    v_rcp_f32 v191, v191
    s_nop 0
    v_pk_mul_f32 v[176:177], v[176:177], v[184:185]
    v_pk_mul_f32 v[178:179], v[178:179], v[186:187]
    v_pk_mul_f32 v[180:181], v[180:181], v[188:189]
    v_pk_mul_f32 v[182:183], v[182:183], v[190:191]
    v_cvt_pk_bf16_f32 v196, v176, v177
    v_cvt_pk_bf16_f32 v197, v178, v179
    v_cvt_pk_bf16_f32 v198, v180, v181
    v_cvt_pk_bf16_f32 v199, v182, v183
    buffer_store_dwordx4 v[196:199], v170, s[48:51], 0 offen offset:0 sc1
    v_pk_mul_f32 v[176:177], v[152:153], v[146:147] op_sel:[0,1] op_sel_hi:[1,1]
    v_pk_mul_f32 v[178:179], v[154:155], v[146:147] op_sel:[0,1] op_sel_hi:[1,1]
    v_pk_mul_f32 v[180:181], v[156:157], v[146:147] op_sel:[0,1] op_sel_hi:[1,1]
    v_pk_mul_f32 v[182:183], v[158:159], v[146:147] op_sel:[0,1] op_sel_hi:[1,1]
    v_pk_fma_f32 v[176:177], v[96:97], v[146:147], v[176:177] op_sel_hi:[1,0,1]
    v_pk_fma_f32 v[178:179], v[98:99], v[146:147], v[178:179] op_sel_hi:[1,0,1]
    v_pk_fma_f32 v[180:181], v[100:101], v[146:147], v[180:181] op_sel_hi:[1,0,1]
    v_pk_fma_f32 v[182:183], v[102:103], v[146:147], v[182:183] op_sel_hi:[1,0,1]
    v_exp_f32 v184, v176
    v_exp_f32 v185, v177
    v_exp_f32 v186, v178
    v_exp_f32 v187, v179
    v_exp_f32 v188, v180
    v_exp_f32 v189, v181
    v_exp_f32 v190, v182
    v_exp_f32 v191, v183
    v_pk_fma_f32 v[184:185], v[184:185], v[24:25], v[24:25] op_sel_hi:[1,0,0]
    v_pk_fma_f32 v[186:187], v[186:187], v[24:25], v[24:25] op_sel_hi:[1,0,0]
    v_pk_fma_f32 v[188:189], v[188:189], v[24:25], v[24:25] op_sel_hi:[1,0,0]
    v_pk_fma_f32 v[190:191], v[190:191], v[24:25], v[24:25] op_sel_hi:[1,0,0]
    v_rcp_f32 v184, v184
    v_rcp_f32 v185, v185
    v_rcp_f32 v186, v186
    v_rcp_f32 v187, v187
    v_rcp_f32 v188, v188
    v_rcp_f32 v189, v189
    v_rcp_f32 v190, v190
    v_rcp_f32 v191, v191
    s_nop 0
    v_pk_mul_f32 v[176:177], v[176:177], v[184:185]
    v_pk_mul_f32 v[178:179], v[178:179], v[186:187]
    v_pk_mul_f32 v[180:181], v[180:181], v[188:189]
    v_pk_mul_f32 v[182:183], v[182:183], v[190:191]
    v_cvt_pk_bf16_f32 v192, v176, v177
    v_cvt_pk_bf16_f32 v193, v178, v179
    v_cvt_pk_bf16_f32 v194, v180, v181
    v_cvt_pk_bf16_f32 v195, v182, v183
    buffer_store_dwordx4 v[192:195], v168, s[48:51], 0 offen offset:512 sc1
    v_pk_mul_f32 v[176:177], v[160:161], v[146:147] op_sel:[0,1] op_sel_hi:[1,1]
    v_pk_mul_f32 v[178:179], v[162:163], v[146:147] op_sel:[0,1] op_sel_hi:[1,1]
    v_pk_mul_f32 v[180:181], v[164:165], v[146:147] op_sel:[0,1] op_sel_hi:[1,1]
    v_pk_mul_f32 v[182:183], v[166:167], v[146:147] op_sel:[0,1] op_sel_hi:[1,1]
    v_pk_fma_f32 v[176:177], v[104:105], v[146:147], v[176:177] op_sel_hi:[1,0,1]
    v_pk_fma_f32 v[178:179], v[106:107], v[146:147], v[178:179] op_sel_hi:[1,0,1]
    v_pk_fma_f32 v[180:181], v[108:109], v[146:147], v[180:181] op_sel_hi:[1,0,1]
    v_pk_fma_f32 v[182:183], v[110:111], v[146:147], v[182:183] op_sel_hi:[1,0,1]
    v_exp_f32 v184, v176
    v_exp_f32 v185, v177
    v_exp_f32 v186, v178
    v_exp_f32 v187, v179
    v_exp_f32 v188, v180
    v_exp_f32 v189, v181
    v_exp_f32 v190, v182
    v_exp_f32 v191, v183
    v_pk_fma_f32 v[184:185], v[184:185], v[24:25], v[24:25] op_sel_hi:[1,0,0]
    v_pk_fma_f32 v[186:187], v[186:187], v[24:25], v[24:25] op_sel_hi:[1,0,0]
    v_pk_fma_f32 v[188:189], v[188:189], v[24:25], v[24:25] op_sel_hi:[1,0,0]
    v_pk_fma_f32 v[190:191], v[190:191], v[24:25], v[24:25] op_sel_hi:[1,0,0]
    v_rcp_f32 v184, v184
    v_rcp_f32 v185, v185
    v_rcp_f32 v186, v186
    v_rcp_f32 v187, v187
    v_rcp_f32 v188, v188
    v_rcp_f32 v189, v189
    v_rcp_f32 v190, v190
    v_rcp_f32 v191, v191
    s_nop 0
    v_pk_mul_f32 v[176:177], v[176:177], v[184:185]
    v_pk_mul_f32 v[178:179], v[178:179], v[186:187]
    v_pk_mul_f32 v[180:181], v[180:181], v[188:189]
    v_pk_mul_f32 v[182:183], v[182:183], v[190:191]
    v_cvt_pk_bf16_f32 v196, v176, v177
    v_cvt_pk_bf16_f32 v197, v178, v179
    v_cvt_pk_bf16_f32 v198, v180, v181
    v_cvt_pk_bf16_f32 v199, v182, v183
    buffer_store_dwordx4 v[196:199], v170, s[48:51], 0 offen offset:512 sc1
    v_pk_mul_f32 v[176:177], v[152:153], v[148:149] op_sel:[0,1] op_sel_hi:[1,1]
    v_pk_mul_f32 v[178:179], v[154:155], v[148:149] op_sel:[0,1] op_sel_hi:[1,1]
    v_pk_mul_f32 v[180:181], v[156:157], v[148:149] op_sel:[0,1] op_sel_hi:[1,1]
    v_pk_mul_f32 v[182:183], v[158:159], v[148:149] op_sel:[0,1] op_sel_hi:[1,1]
    v_pk_fma_f32 v[176:177], v[112:113], v[148:149], v[176:177] op_sel_hi:[1,0,1]
    v_pk_fma_f32 v[178:179], v[114:115], v[148:149], v[178:179] op_sel_hi:[1,0,1]
    v_pk_fma_f32 v[180:181], v[116:117], v[148:149], v[180:181] op_sel_hi:[1,0,1]
    v_pk_fma_f32 v[182:183], v[118:119], v[148:149], v[182:183] op_sel_hi:[1,0,1]
    v_exp_f32 v184, v176
    v_exp_f32 v185, v177
    v_exp_f32 v186, v178
    v_exp_f32 v187, v179
    v_exp_f32 v188, v180
    v_exp_f32 v189, v181
    v_exp_f32 v190, v182
    v_exp_f32 v191, v183
    v_pk_fma_f32 v[184:185], v[184:185], v[24:25], v[24:25] op_sel_hi:[1,0,0]
    v_pk_fma_f32 v[186:187], v[186:187], v[24:25], v[24:25] op_sel_hi:[1,0,0]
    v_pk_fma_f32 v[188:189], v[188:189], v[24:25], v[24:25] op_sel_hi:[1,0,0]
    v_pk_fma_f32 v[190:191], v[190:191], v[24:25], v[24:25] op_sel_hi:[1,0,0]
    v_rcp_f32 v184, v184
    v_rcp_f32 v185, v185
    v_rcp_f32 v186, v186
    v_rcp_f32 v187, v187
    v_rcp_f32 v188, v188
    v_rcp_f32 v189, v189
    v_rcp_f32 v190, v190
    v_rcp_f32 v191, v191
    s_nop 0
    v_pk_mul_f32 v[176:177], v[176:177], v[184:185]
    v_pk_mul_f32 v[178:179], v[178:179], v[186:187]
    v_pk_mul_f32 v[180:181], v[180:181], v[188:189]
    v_pk_mul_f32 v[182:183], v[182:183], v[190:191]
    v_cvt_pk_bf16_f32 v192, v176, v177
    v_cvt_pk_bf16_f32 v193, v178, v179
    v_cvt_pk_bf16_f32 v194, v180, v181
    v_cvt_pk_bf16_f32 v195, v182, v183
    buffer_store_dwordx4 v[192:195], v168, s[48:51], 0 offen offset:1024 sc1
    v_pk_mul_f32 v[176:177], v[160:161], v[148:149] op_sel:[0,1] op_sel_hi:[1,1]
    v_pk_mul_f32 v[178:179], v[162:163], v[148:149] op_sel:[0,1] op_sel_hi:[1,1]
    v_pk_mul_f32 v[180:181], v[164:165], v[148:149] op_sel:[0,1] op_sel_hi:[1,1]
    v_pk_mul_f32 v[182:183], v[166:167], v[148:149] op_sel:[0,1] op_sel_hi:[1,1]
    v_pk_fma_f32 v[176:177], v[120:121], v[148:149], v[176:177] op_sel_hi:[1,0,1]
    v_pk_fma_f32 v[178:179], v[122:123], v[148:149], v[178:179] op_sel_hi:[1,0,1]
    v_pk_fma_f32 v[180:181], v[124:125], v[148:149], v[180:181] op_sel_hi:[1,0,1]
    v_pk_fma_f32 v[182:183], v[126:127], v[148:149], v[182:183] op_sel_hi:[1,0,1]
    v_exp_f32 v184, v176
    v_exp_f32 v185, v177
    v_exp_f32 v186, v178
    v_exp_f32 v187, v179
    v_exp_f32 v188, v180
    v_exp_f32 v189, v181
    v_exp_f32 v190, v182
    v_exp_f32 v191, v183
    v_pk_fma_f32 v[184:185], v[184:185], v[24:25], v[24:25] op_sel_hi:[1,0,0]
    v_pk_fma_f32 v[186:187], v[186:187], v[24:25], v[24:25] op_sel_hi:[1,0,0]
    v_pk_fma_f32 v[188:189], v[188:189], v[24:25], v[24:25] op_sel_hi:[1,0,0]
    v_pk_fma_f32 v[190:191], v[190:191], v[24:25], v[24:25] op_sel_hi:[1,0,0]
    v_rcp_f32 v184, v184
    v_rcp_f32 v185, v185
    v_rcp_f32 v186, v186
    v_rcp_f32 v187, v187
    v_rcp_f32 v188, v188
    v_rcp_f32 v189, v189
    v_rcp_f32 v190, v190
    v_rcp_f32 v191, v191
    s_nop 0
    v_pk_mul_f32 v[176:177], v[176:177], v[184:185]
    v_pk_mul_f32 v[178:179], v[178:179], v[186:187]
    v_pk_mul_f32 v[180:181], v[180:181], v[188:189]
    v_pk_mul_f32 v[182:183], v[182:183], v[190:191]
    v_cvt_pk_bf16_f32 v196, v176, v177
    v_cvt_pk_bf16_f32 v197, v178, v179
    v_cvt_pk_bf16_f32 v198, v180, v181
    v_cvt_pk_bf16_f32 v199, v182, v183
    buffer_store_dwordx4 v[196:199], v170, s[48:51], 0 offen offset:1024 sc1
    v_pk_mul_f32 v[176:177], v[152:153], v[150:151] op_sel:[0,1] op_sel_hi:[1,1]
    v_pk_mul_f32 v[178:179], v[154:155], v[150:151] op_sel:[0,1] op_sel_hi:[1,1]
    v_pk_mul_f32 v[180:181], v[156:157], v[150:151] op_sel:[0,1] op_sel_hi:[1,1]
    v_pk_mul_f32 v[182:183], v[158:159], v[150:151] op_sel:[0,1] op_sel_hi:[1,1]
    v_pk_fma_f32 v[176:177], v[128:129], v[150:151], v[176:177] op_sel_hi:[1,0,1]
    v_pk_fma_f32 v[178:179], v[130:131], v[150:151], v[178:179] op_sel_hi:[1,0,1]
    v_pk_fma_f32 v[180:181], v[132:133], v[150:151], v[180:181] op_sel_hi:[1,0,1]
    v_pk_fma_f32 v[182:183], v[134:135], v[150:151], v[182:183] op_sel_hi:[1,0,1]
    v_exp_f32 v184, v176
    v_exp_f32 v185, v177
    v_exp_f32 v186, v178
    v_exp_f32 v187, v179
    v_exp_f32 v188, v180
    v_exp_f32 v189, v181
    v_exp_f32 v190, v182
    v_exp_f32 v191, v183
    v_pk_fma_f32 v[184:185], v[184:185], v[24:25], v[24:25] op_sel_hi:[1,0,0]
    v_pk_fma_f32 v[186:187], v[186:187], v[24:25], v[24:25] op_sel_hi:[1,0,0]
    v_pk_fma_f32 v[188:189], v[188:189], v[24:25], v[24:25] op_sel_hi:[1,0,0]
    v_pk_fma_f32 v[190:191], v[190:191], v[24:25], v[24:25] op_sel_hi:[1,0,0]
    v_rcp_f32 v184, v184
    v_rcp_f32 v185, v185
    v_rcp_f32 v186, v186
    v_rcp_f32 v187, v187
    v_rcp_f32 v188, v188
    v_rcp_f32 v189, v189
    v_rcp_f32 v190, v190
    v_rcp_f32 v191, v191
    s_nop 0
    v_pk_mul_f32 v[176:177], v[176:177], v[184:185]
    v_pk_mul_f32 v[178:179], v[178:179], v[186:187]
    v_pk_mul_f32 v[180:181], v[180:181], v[188:189]
    v_pk_mul_f32 v[182:183], v[182:183], v[190:191]
    v_cvt_pk_bf16_f32 v192, v176, v177
    v_cvt_pk_bf16_f32 v193, v178, v179
    v_cvt_pk_bf16_f32 v194, v180, v181
    v_cvt_pk_bf16_f32 v195, v182, v183
    buffer_store_dwordx4 v[192:195], v168, s[48:51], 0 offen offset:1536 sc1
    v_pk_mul_f32 v[176:177], v[160:161], v[150:151] op_sel:[0,1] op_sel_hi:[1,1]
    v_pk_mul_f32 v[178:179], v[162:163], v[150:151] op_sel:[0,1] op_sel_hi:[1,1]
    v_pk_mul_f32 v[180:181], v[164:165], v[150:151] op_sel:[0,1] op_sel_hi:[1,1]
    v_pk_mul_f32 v[182:183], v[166:167], v[150:151] op_sel:[0,1] op_sel_hi:[1,1]
    v_pk_fma_f32 v[176:177], v[136:137], v[150:151], v[176:177] op_sel_hi:[1,0,1]
    v_pk_fma_f32 v[178:179], v[138:139], v[150:151], v[178:179] op_sel_hi:[1,0,1]
    v_pk_fma_f32 v[180:181], v[140:141], v[150:151], v[180:181] op_sel_hi:[1,0,1]
    v_pk_fma_f32 v[182:183], v[142:143], v[150:151], v[182:183] op_sel_hi:[1,0,1]
    v_exp_f32 v184, v176
    v_exp_f32 v185, v177
    v_exp_f32 v186, v178
    v_exp_f32 v187, v179
    v_exp_f32 v188, v180
    v_exp_f32 v189, v181
    v_exp_f32 v190, v182
    v_exp_f32 v191, v183
    v_pk_fma_f32 v[184:185], v[184:185], v[24:25], v[24:25] op_sel_hi:[1,0,0]
    v_pk_fma_f32 v[186:187], v[186:187], v[24:25], v[24:25] op_sel_hi:[1,0,0]
    v_pk_fma_f32 v[188:189], v[188:189], v[24:25], v[24:25] op_sel_hi:[1,0,0]
    v_pk_fma_f32 v[190:191], v[190:191], v[24:25], v[24:25] op_sel_hi:[1,0,0]
    v_rcp_f32 v184, v184
    v_rcp_f32 v185, v185
    v_rcp_f32 v186, v186
    v_rcp_f32 v187, v187
    v_rcp_f32 v188, v188
    v_rcp_f32 v189, v189
    v_rcp_f32 v190, v190
    v_rcp_f32 v191, v191
    s_nop 0
    v_pk_mul_f32 v[176:177], v[176:177], v[184:185]
    v_pk_mul_f32 v[178:179], v[178:179], v[186:187]
    v_pk_mul_f32 v[180:181], v[180:181], v[188:189]
    v_pk_mul_f32 v[182:183], v[182:183], v[190:191]
    v_cvt_pk_bf16_f32 v196, v176, v177
    v_cvt_pk_bf16_f32 v197, v178, v179
    v_cvt_pk_bf16_f32 v198, v180, v181
    v_cvt_pk_bf16_f32 v199, v182, v183
    buffer_store_dwordx4 v[196:199], v170, s[48:51], 0 offen offset:1536 sc1
    s_branch interleave_layers__mha_block__dense_activation_silu__prompt_kernel_up_fin
interleave_layers__mha_block__dense_activation_silu__prompt_kernel_up_idle:
    s_add_u32 m0, s79, 81920
    s_add_u32 s81, s78, 0
    buffer_load_dwordx4 v249, s[72:75], s81 offen offset:0 sc1 lds
    buffer_load_dwordx4 v249, s[72:75], s81 offen offset:1024 sc1 lds
    buffer_load_dwordx4 v249, s[72:75], s81 offen offset:2048 sc1 lds
    buffer_load_dwordx4 v249, s[72:75], s81 offen offset:3072 sc1 lds
    s_add_u32 m0, s79, 86016
    s_add_u32 s81, s78, 4096
    buffer_load_dwordx4 v249, s[72:75], s81 offen offset:0 sc1 lds
    s_add_u32 m0, s79, 102400
    s_add_u32 s81, s78, 20480
    buffer_load_dwordx4 v249, s[72:75], s81 offen offset:0 sc1 lds
    buffer_load_dwordx4 v249, s[72:75], s81 offen offset:1024 sc1 lds
    buffer_load_dwordx4 v249, s[72:75], s81 offen offset:2048 sc1 lds
    buffer_load_dwordx4 v249, s[72:75], s81 offen offset:3072 sc1 lds
    s_add_u32 m0, s79, 106496
    s_add_u32 s81, s78, 24576
    buffer_load_dwordx4 v249, s[72:75], s81 offen offset:0 sc1 lds
    s_add_u32 m0, s79, 122880
    s_add_u32 s81, s78, 40960
    buffer_load_dwordx4 v249, s[72:75], s81 offen offset:0 sc1 lds
    buffer_load_dwordx4 v249, s[72:75], s81 offen offset:1024 sc1 lds
    buffer_load_dwordx4 v249, s[72:75], s81 offen offset:2048 sc1 lds
    buffer_load_dwordx4 v249, s[72:75], s81 offen offset:3072 sc1 lds
    s_add_u32 m0, s79, 126976
    s_add_u32 s81, s78, 45056
    buffer_load_dwordx4 v249, s[72:75], s81 offen offset:0 sc1 lds
interleave_layers__mha_block__dense_activation_silu__prompt_kernel_up_fin:
    s_waitcnt vmcnt(0) lgkmcnt(0)
    s_barrier
    s_cmp_lg_u32 s16, 0
    s_cbranch_scc1 arr_done_15
    s_add_u32 s100, s17, 40
    s_lshl_b32 s100, s100, 7
    s_add_u32 s100, s100, s97
    v_mov_b32 v250, s100
    v_mov_b32 v251, 1
    s_mov_b64 exec, 1
    global_atomic_add v250, v251, s[98:99] sc1
    s_mov_b64 exec, -1
arr_done_15:
    s_and_b32 s20, s12, 3
    s_lshl_b32 s20, s20, 3
    s_and_b32 s21, s13, 7
    s_add_u32 s17, s20, s21
    s_lshr_b32 s20, s12, 2
    s_lshl_b32 s20, s20, 2
    s_lshr_b32 s21, s13, 3
    s_add_u32 s18, s20, s21
    s_lshr_b32 s19, s17, 1
    v_and_b32 v1, 63, v0
    v_lshlrev_b32 v4, 4, v1
    v_and_b32 v2, 15, v0
    v_bfe_u32 v3, v0, 4, 2
    v_mov_b32 v8, v4
    v_add_u32 v9, 0x10000, v4
    v_add_u32 v10, 0x20000, v4
    v_add_u32 v16, s79, v4
    v_add_u32 v17, 0x10000, v16
    v_add_u32 v18, 0x20000, v16
    v_mul_u32_u24 v5, 32768, v3
    v_lshl_add_u32 v5, v2, 4, v5
    s_lshl_b32 s19, s17, 6
    s_lshl_b32 s20, s16, 4
    s_add_u32 s22, s19, s20
    v_add_u32 v12, s22, v2
    s_mul_i32 s20, s18, 10
    v_add_u32 v13, s20, v3
    v_mul_u32_u24 v13, 32768, v13
    v_lshl_add_u32 v6, v12, 4, v13
    v_lshrrev_b32 v13, 1, v3
    v_add_u32 v13, s20, v13
    v_add_u32 v13, 8, v13
    v_mul_u32_u24 v13, 32768, v13
    v_lshl_add_u32 v13, v12, 4, v13
    v_and_b32 v14, 1, v3
    v_lshl_add_u32 v7, v14, 3, v13
    s_mov_b32 s23, 131072
    s_lshl_b32 s44, s22, 4
    s_lshr_b32 s19, s17, 1
    s_add_u32 s24, s15, 35917824
    s_add_u32 s24, s24, s6
    s_addc_u32 s25, s7, 0
    s_and_b32 s25, s25, 0xffff
    s_mov_b32 s26, 2621440
    s_mov_b32 s27, 0x20000
    s_add_u32 s28, s6, 38539264
    s_addc_u32 s29, s7, 0
    s_cmp_eq_u32 s14, 0
    s_cselect_b32 s28, s28, s8
    s_cselect_b32 s29, s29, s9
    s_mov_b32 s30, 2621440
    s_cselect_b32 s30, 2621440, s30
    s_and_b32 s29, s29, 0xffff
    s_mov_b32 s31, 0x20000
    s_add_u32 s40, s6, 41291776
    s_addc_u32 s41, s7, 0
    s_and_b32 s41, s41, 0xffff
    s_mov_b32 s42, 131072
    s_mov_b32 s43, 0x20000
    s_add_u32 s32, s15, 28839936
    s_add_u32 s32, s32, s6
    s_addc_u32 s33, s7, 0
    s_and_b32 s33, s33, 0xffff
    s_mov_b32 s34, 7077888
    s_mov_b32 s35, 0x20000
    buffer_load_dwordx4 v[20:23], v6, s[24:27], 0 offen sc1
    buffer_load_dwordx4 v[24:27], v6, s[24:27], s23 offen sc1
    buffer_load_dwordx2 v[28:29], v7, s[24:27], 0 offen sc1
    s_add_u32 m0, s79, 0
    s_add_u32 s81, s78, 61440
    buffer_load_dwordx4 v249, s[72:75], s81 offen offset:0 sc1 lds
    buffer_load_dwordx4 v249, s[72:75], s81 offen offset:1024 sc1 lds
    buffer_load_dwordx4 v249, s[72:75], s81 offen offset:2048 sc1 lds
    buffer_load_dwordx4 v249, s[72:75], s81 offen offset:3072 sc1 lds
    s_add_u32 m0, s79, 4096
    s_add_u32 s81, s78, 65536
    buffer_load_dwordx4 v249, s[72:75], s81 offen offset:0 sc1 lds
    s_add_u32 m0, s79, 20480
    s_add_u32 s81, s78, 81920
    buffer_load_dwordx4 v249, s[72:75], s81 offen offset:0 sc1 lds
    buffer_load_dwordx4 v249, s[72:75], s81 offen offset:1024 sc1 lds
    buffer_load_dwordx4 v249, s[72:75], s81 offen offset:2048 sc1 lds
    buffer_load_dwordx4 v249, s[72:75], s81 offen offset:3072 sc1 lds
    s_add_u32 m0, s79, 24576
    s_add_u32 s81, s78, 86016
    buffer_load_dwordx4 v249, s[72:75], s81 offen offset:0 sc1 lds
    s_add_u32 m0, s79, 40960
    s_add_u32 s81, s78, 102400
    buffer_load_dwordx4 v249, s[72:75], s81 offen offset:0 sc1 lds
    buffer_load_dwordx4 v249, s[72:75], s81 offen offset:1024 sc1 lds
    buffer_load_dwordx4 v249, s[72:75], s81 offen offset:2048 sc1 lds
    buffer_load_dwordx4 v249, s[72:75], s81 offen offset:3072 sc1 lds
    s_add_u32 m0, s79, 45056
    s_add_u32 s81, s78, 106496
    buffer_load_dwordx4 v249, s[72:75], s81 offen offset:0 sc1 lds
    s_add_u32 m0, s79, 61440
    s_add_u32 s81, s78, 122880
    buffer_load_dwordx4 v249, s[72:75], s81 offen offset:0 sc1 lds
    buffer_load_dwordx4 v249, s[72:75], s81 offen offset:1024 sc1 lds
    buffer_load_dwordx4 v249, s[72:75], s81 offen offset:2048 sc1 lds
    buffer_load_dwordx4 v249, s[72:75], s81 offen offset:3072 sc1 lds
    s_add_u32 m0, s79, 65536
    s_add_u32 s81, s78, 126976
    buffer_load_dwordx4 v249, s[72:75], s81 offen offset:0 sc1 lds
    s_cmp_lg_u32 s16, 0
    s_cbranch_scc1 we_done_16
    s_add_u32 s100, s19, 40
    s_lshl_b32 s100, s100, 7
    s_add_u32 s100, s100, s97
    v_mov_b32 v250, s100
    s_mov_b64 exec, 1
    global_load_dword v251, v250, s[98:99] sc1
    s_mov_b64 exec, -1
we_done_16:
    v_add_u32 v12, s22, v2
    v_lshlrev_b32 v156, 3, v12
    v_mov_b32 v13, 0x7ffffff0
    v_cmp_eq_u32 vcc, 0, v3
    v_mul_u32_u24 v12, 1280, v12
    v_lshl_add_u32 v157, v3, 4, v12
    v_cndmask_b32 v156, v13, v156, vcc
    v_lshl_add_u32 v158, v3, 3, v12
    s_waitcnt vmcnt(20)
    v_lshlrev_b32 v112, 16, v20
    v_and_b32 v113, 0xffff0000, v20
    v_lshlrev_b32 v114, 16, v21
    v_and_b32 v115, 0xffff0000, v21
    v_lshlrev_b32 v116, 16, v22
    v_and_b32 v117, 0xffff0000, v22
    v_lshlrev_b32 v118, 16, v23
    v_and_b32 v119, 0xffff0000, v23
    v_lshlrev_b32 v120, 16, v24
    v_and_b32 v121, 0xffff0000, v24
    v_lshlrev_b32 v122, 16, v25
    v_and_b32 v123, 0xffff0000, v25
    v_lshlrev_b32 v124, 16, v26
    v_and_b32 v125, 0xffff0000, v26
    v_lshlrev_b32 v126, 16, v27
    v_and_b32 v127, 0xffff0000, v27
    v_lshlrev_b32 v128, 16, v28
    v_and_b32 v129, 0xffff0000, v28
    v_lshlrev_b32 v130, 16, v29
    v_and_b32 v131, 0xffff0000, v29
    s_cmp_lg_u32 s16, 0
    s_cbranch_scc1 wt_done_17
    s_add_u32 s100, s19, 40
    s_lshl_b32 s100, s100, 7
    s_add_u32 s100, s100, s97
    v_mov_b32 v250, s100
    s_mov_b32 s101, 0
    s_mov_b64 exec, 1
    s_waitcnt vmcnt(0)
    v_cmp_le_u32 vcc, 16, v251
    s_nop 0
    s_cmp_eq_u64 vcc, exec
    s_cbranch_scc1 wt_ok_17
wt_poll_17:
    global_load_dword v251, v250, s[98:99] sc1
    s_add_u32 s101, s101, 1
    s_waitcnt vmcnt(0)
    v_cmp_le_u32 vcc, 16, v251
    s_cmp_ge_u32 s101, 262144
    s_cbranch_scc1 wt_ok_17
    s_cmp_eq_u64 vcc, exec
    s_cbranch_scc1 wt_ok_17
    s_sleep 1
    s_branch wt_poll_17
wt_ok_17:
    s_mov_b64 exec, -1
wt_done_17:
    s_barrier
    s_add_u32 s49, s44, 0
    buffer_load_dwordx4 a[0:3], v5, s[32:35], s49 offen sc1
    s_add_u32 s49, s44, 131072
    buffer_load_dwordx4 a[4:7], v5, s[32:35], s49 offen sc1
    s_add_u32 s49, s44, 262144
    buffer_load_dwordx4 a[8:11], v5, s[32:35], s49 offen sc1
    s_add_u32 s49, s44, 393216
    buffer_load_dwordx4 a[12:15], v5, s[32:35], s49 offen sc1
    s_add_u32 s49, s44, 524288
    buffer_load_dwordx4 a[16:19], v5, s[32:35], s49 offen sc1
    s_add_u32 s49, s44, 655360
    buffer_load_dwordx4 a[20:23], v5, s[32:35], s49 offen sc1
    s_add_u32 s49, s44, 786432
    buffer_load_dwordx4 a[24:27], v5, s[32:35], s49 offen sc1
    s_add_u32 s49, s44, 917504
    buffer_load_dwordx4 a[28:31], v5, s[32:35], s49 offen sc1
    s_add_u32 s49, s44, 1048576
    buffer_load_dwordx4 a[32:35], v5, s[32:35], s49 offen sc1
    s_add_u32 s49, s44, 1179648
    buffer_load_dwordx4 a[36:39], v5, s[32:35], s49 offen sc1
    s_add_u32 s49, s44, 1310720
    buffer_load_dwordx4 a[40:43], v5, s[32:35], s49 offen sc1
    s_add_u32 s49, s44, 1441792
    buffer_load_dwordx4 a[44:47], v5, s[32:35], s49 offen sc1
    s_waitcnt vmcnt(8)
    ds_read_b128 v[32:35], v9 offset:16384
    ds_read_b128 v[36:39], v9 offset:17408
    ds_read_b128 v[40:43], v9 offset:18432
    ds_read_b128 v[44:47], v9 offset:19456
    ds_read_b128 v[48:51], v9 offset:20480
    ds_read_b128 v[52:55], v9 offset:21504
    ds_read_b128 v[56:59], v9 offset:22528
    ds_read_b128 v[60:63], v9 offset:23552
    ds_read_b128 v[64:67], v9 offset:24576
    ds_read_b128 v[68:71], v9 offset:25600
    s_waitcnt lgkmcnt(5)
    v_mfma_f32_16x16x32_bf16 v[92:95], v[32:35], a[0:3], 0
    ds_read_b128 v[72:75], v9 offset:26624
    s_add_u32 s49, s44, 1572864
    buffer_load_dwordx4 a[48:51], v5, s[32:35], s49 offen sc1
    v_mfma_f32_16x16x32_bf16 v[96:99], v[36:39], a[0:3], 0
    ds_read_b128 v[76:79], v9 offset:27648
    v_mfma_f32_16x16x32_bf16 v[100:103], v[40:43], a[0:3], 0
    ds_read_b128 v[80:83], v9 offset:28672
    s_add_u32 s49, s44, 1703936
    buffer_load_dwordx4 a[52:55], v5, s[32:35], s49 offen sc1
    v_mfma_f32_16x16x32_bf16 v[104:107], v[44:47], a[0:3], 0
    ds_read_b128 v[84:87], v9 offset:29696
    v_mfma_f32_16x16x32_bf16 v[108:111], v[48:51], a[0:3], 0
    ds_read_b128 v[88:91], v9 offset:30720
    s_waitcnt lgkmcnt(5)
    v_mfma_f32_16x16x32_bf16 v[92:95], v[52:55], a[4:7], v[92:95]
    ds_read_b128 v[32:35], v9 offset:31744
    s_add_u32 s49, s44, 1835008
    buffer_load_dwordx4 a[56:59], v5, s[32:35], s49 offen sc1
    v_mfma_f32_16x16x32_bf16 v[96:99], v[56:59], a[4:7], v[96:99]
    ds_read_b128 v[36:39], v9 offset:32768
    v_mfma_f32_16x16x32_bf16 v[100:103], v[60:63], a[4:7], v[100:103]
    ds_read_b128 v[40:43], v9 offset:33792
    s_add_u32 s49, s44, 1966080
    buffer_load_dwordx4 a[60:63], v5, s[32:35], s49 offen sc1
    v_mfma_f32_16x16x32_bf16 v[104:107], v[64:67], a[4:7], v[104:107]
    ds_read_b128 v[44:47], v9 offset:34816
    v_mfma_f32_16x16x32_bf16 v[108:111], v[68:71], a[4:7], v[108:111]
    ds_read_b128 v[48:51], v9 offset:35840
    s_barrier
    s_waitcnt lgkmcnt(5)
    v_mfma_f32_16x16x32_bf16 v[92:95], v[72:75], a[8:11], v[92:95]
    ds_read_b128 v[52:55], v9 offset:36864
    v_mfma_f32_16x16x32_bf16 v[96:99], v[76:79], a[8:11], v[96:99]
    ds_read_b128 v[56:59], v9 offset:37888
    v_mfma_f32_16x16x32_bf16 v[100:103], v[80:83], a[8:11], v[100:103]
    ds_read_b128 v[60:63], v9 offset:38912
    v_mfma_f32_16x16x32_bf16 v[104:107], v[84:87], a[8:11], v[104:107]
    ds_read_b128 v[64:67], v9 offset:39936
    v_mfma_f32_16x16x32_bf16 v[108:111], v[88:91], a[8:11], v[108:111]
    ds_read_b128 v[68:71], v9 offset:40960
    s_waitcnt lgkmcnt(5)
    v_mfma_f32_16x16x32_bf16 v[92:95], v[32:35], a[12:15], v[92:95]
    ds_read_b128 v[72:75], v9 offset:41984
    v_mfma_f32_16x16x32_bf16 v[96:99], v[36:39], a[12:15], v[96:99]
    ds_read_b128 v[76:79], v9 offset:43008
    v_mfma_f32_16x16x32_bf16 v[100:103], v[40:43], a[12:15], v[100:103]
    ds_read_b128 v[80:83], v9 offset:44032
    v_mfma_f32_16x16x32_bf16 v[104:107], v[44:47], a[12:15], v[104:107]
    ds_read_b128 v[84:87], v9 offset:45056
    v_mfma_f32_16x16x32_bf16 v[108:111], v[48:51], a[12:15], v[108:111]
    ds_read_b128 v[88:91], v9 offset:46080
    s_waitcnt vmcnt(8)
    s_waitcnt lgkmcnt(5)
    v_mfma_f32_16x16x32_bf16 v[92:95], v[52:55], a[16:19], v[92:95]
    ds_read_b128 v[32:35], v9 offset:47104
    s_add_u32 s49, s44, 2097152
    buffer_load_dwordx4 a[64:67], v5, s[32:35], s49 offen sc1
    v_mfma_f32_16x16x32_bf16 v[96:99], v[56:59], a[16:19], v[96:99]
    ds_read_b128 v[36:39], v9 offset:48128
    v_mfma_f32_16x16x32_bf16 v[100:103], v[60:63], a[16:19], v[100:103]
    ds_read_b128 v[40:43], v9 offset:49152
    s_add_u32 s49, s44, 2228224
    buffer_load_dwordx4 a[68:71], v5, s[32:35], s49 offen sc1
    v_mfma_f32_16x16x32_bf16 v[104:107], v[64:67], a[16:19], v[104:107]
    ds_read_b128 v[44:47], v9 offset:50176
    v_mfma_f32_16x16x32_bf16 v[108:111], v[68:71], a[16:19], v[108:111]
    ds_read_b128 v[48:51], v9 offset:51200
    s_waitcnt lgkmcnt(5)
    v_mfma_f32_16x16x32_bf16 v[92:95], v[72:75], a[20:23], v[92:95]
    ds_read_b128 v[52:55], v9 offset:52224
    s_add_u32 s49, s44, 2359296
    buffer_load_dwordx4 a[72:75], v5, s[32:35], s49 offen sc1
    v_mfma_f32_16x16x32_bf16 v[96:99], v[76:79], a[20:23], v[96:99]
    ds_read_b128 v[56:59], v9 offset:53248
    v_mfma_f32_16x16x32_bf16 v[100:103], v[80:83], a[20:23], v[100:103]
    ds_read_b128 v[60:63], v9 offset:54272
    s_add_u32 s49, s44, 2490368
    buffer_load_dwordx4 a[76:79], v5, s[32:35], s49 offen sc1
    v_mfma_f32_16x16x32_bf16 v[104:107], v[84:87], a[20:23], v[104:107]
    ds_read_b128 v[64:67], v9 offset:55296
    v_mfma_f32_16x16x32_bf16 v[108:111], v[88:91], a[20:23], v[108:111]
    ds_read_b128 v[68:71], v9 offset:56320
    s_barrier
    s_waitcnt lgkmcnt(5)
    v_mfma_f32_16x16x32_bf16 v[92:95], v[32:35], a[24:27], v[92:95]
    ds_read_b128 v[72:75], v9 offset:57344
    s_add_u32 m0, s79, 81920
    s_add_u32 s81, s78, 143360
    buffer_load_dwordx4 v249, s[72:75], s81 offen offset:0 sc1 lds
    v_mfma_f32_16x16x32_bf16 v[96:99], v[36:39], a[24:27], v[96:99]
    ds_read_b128 v[76:79], v9 offset:58368
    v_mfma_f32_16x16x32_bf16 v[100:103], v[40:43], a[24:27], v[100:103]
    ds_read_b128 v[80:83], v9 offset:59392
    buffer_load_dwordx4 v249, s[72:75], s81 offen offset:1024 sc1 lds
    v_mfma_f32_16x16x32_bf16 v[104:107], v[44:47], a[24:27], v[104:107]
    ds_read_b128 v[84:87], v9 offset:60416
    v_mfma_f32_16x16x32_bf16 v[108:111], v[48:51], a[24:27], v[108:111]
    ds_read_b128 v[88:91], v9 offset:61440
    buffer_load_dwordx4 v249, s[72:75], s81 offen offset:2048 sc1 lds
    s_waitcnt lgkmcnt(5)
    v_mfma_f32_16x16x32_bf16 v[92:95], v[52:55], a[28:31], v[92:95]
    ds_read_b128 v[32:35], v9 offset:62464
    buffer_load_dwordx4 v249, s[72:75], s81 offen offset:3072 sc1 lds
    v_mfma_f32_16x16x32_bf16 v[96:99], v[56:59], a[28:31], v[96:99]
    ds_read_b128 v[36:39], v9 offset:63488
    v_mfma_f32_16x16x32_bf16 v[100:103], v[60:63], a[28:31], v[100:103]
    ds_read_b128 v[40:43], v9 offset:64512
    s_add_u32 m0, s79, 86016
    s_add_u32 s81, s78, 147456
    buffer_load_dwordx4 v249, s[72:75], s81 offen offset:0 sc1 lds
    v_mfma_f32_16x16x32_bf16 v[104:107], v[64:67], a[28:31], v[104:107]
    ds_read_b128 v[44:47], v10 offset:0
    v_mfma_f32_16x16x32_bf16 v[108:111], v[68:71], a[28:31], v[108:111]
    ds_read_b128 v[48:51], v10 offset:1024
    s_waitcnt vmcnt(13)
    s_waitcnt lgkmcnt(5)
    v_mfma_f32_16x16x32_bf16 v[92:95], v[72:75], a[32:35], v[92:95]
    ds_read_b128 v[52:55], v10 offset:2048
    s_add_u32 s49, s44, 2621440
    buffer_load_dwordx4 a[80:83], v5, s[32:35], s49 offen sc1
    v_mfma_f32_16x16x32_bf16 v[96:99], v[76:79], a[32:35], v[96:99]
    ds_read_b128 v[56:59], v10 offset:3072
    v_mfma_f32_16x16x32_bf16 v[100:103], v[80:83], a[32:35], v[100:103]
    ds_read_b128 v[60:63], v10 offset:4096
    s_add_u32 s49, s44, 2752512
    buffer_load_dwordx4 a[84:87], v5, s[32:35], s49 offen sc1
    v_mfma_f32_16x16x32_bf16 v[104:107], v[84:87], a[32:35], v[104:107]
    ds_read_b128 v[64:67], v10 offset:5120
    v_mfma_f32_16x16x32_bf16 v[108:111], v[88:91], a[32:35], v[108:111]
    ds_read_b128 v[68:71], v10 offset:6144
    s_waitcnt lgkmcnt(5)
    v_mfma_f32_16x16x32_bf16 v[92:95], v[32:35], a[36:39], v[92:95]
    ds_read_b128 v[72:75], v10 offset:7168
    s_add_u32 s49, s44, 2883584
    buffer_load_dwordx4 a[88:91], v5, s[32:35], s49 offen sc1
    v_mfma_f32_16x16x32_bf16 v[96:99], v[36:39], a[36:39], v[96:99]
    ds_read_b128 v[76:79], v10 offset:8192
    v_mfma_f32_16x16x32_bf16 v[100:103], v[40:43], a[36:39], v[100:103]
    ds_read_b128 v[80:83], v10 offset:9216
    s_add_u32 s49, s44, 3014656
    buffer_load_dwordx4 a[92:95], v5, s[32:35], s49 offen sc1
    v_mfma_f32_16x16x32_bf16 v[104:107], v[44:47], a[36:39], v[104:107]
    ds_read_b128 v[84:87], v10 offset:10240
    v_mfma_f32_16x16x32_bf16 v[108:111], v[48:51], a[36:39], v[108:111]
    ds_read_b128 v[88:91], v10 offset:11264
    s_barrier
    s_waitcnt lgkmcnt(5)
    v_mfma_f32_16x16x32_bf16 v[92:95], v[52:55], a[40:43], v[92:95]
    ds_read_b128 v[32:35], v8 offset:0
    s_add_u32 m0, s79, 102400
    s_add_u32 s81, s78, 163840
    buffer_load_dwordx4 v249, s[72:75], s81 offen offset:0 sc1 lds
    v_mfma_f32_16x16x32_bf16 v[96:99], v[56:59], a[40:43], v[96:99]
    ds_read_b128 v[36:39], v8 offset:1024
    v_mfma_f32_16x16x32_bf16 v[100:103], v[60:63], a[40:43], v[100:103]
    ds_read_b128 v[40:43], v8 offset:2048
    buffer_load_dwordx4 v249, s[72:75], s81 offen offset:1024 sc1 lds
    v_mfma_f32_16x16x32_bf16 v[104:107], v[64:67], a[40:43], v[104:107]
    ds_read_b128 v[44:47], v8 offset:3072
    v_mfma_f32_16x16x32_bf16 v[108:111], v[68:71], a[40:43], v[108:111]
    ds_read_b128 v[48:51], v8 offset:4096
    buffer_load_dwordx4 v249, s[72:75], s81 offen offset:2048 sc1 lds
    s_waitcnt lgkmcnt(5)
    v_mfma_f32_16x16x32_bf16 v[92:95], v[72:75], a[44:47], v[92:95]
    ds_read_b128 v[52:55], v8 offset:5120
    buffer_load_dwordx4 v249, s[72:75], s81 offen offset:3072 sc1 lds
    v_mfma_f32_16x16x32_bf16 v[96:99], v[76:79], a[44:47], v[96:99]
    ds_read_b128 v[56:59], v8 offset:6144
    v_mfma_f32_16x16x32_bf16 v[100:103], v[80:83], a[44:47], v[100:103]
    ds_read_b128 v[60:63], v8 offset:7168
    s_add_u32 m0, s79, 106496
    s_add_u32 s81, s78, 167936
    buffer_load_dwordx4 v249, s[72:75], s81 offen offset:0 sc1 lds
    v_mfma_f32_16x16x32_bf16 v[104:107], v[84:87], a[44:47], v[104:107]
    ds_read_b128 v[64:67], v8 offset:8192
    v_mfma_f32_16x16x32_bf16 v[108:111], v[88:91], a[44:47], v[108:111]
    ds_read_b128 v[68:71], v8 offset:9216
    s_waitcnt vmcnt(18)
    s_waitcnt lgkmcnt(5)
    v_mfma_f32_16x16x32_bf16 v[92:95], v[32:35], a[48:51], v[92:95]
    ds_read_b128 v[72:75], v8 offset:10240
    s_add_u32 s49, s44, 3145728
    buffer_load_dwordx4 a[0:3], v5, s[32:35], s49 offen sc1
    v_mfma_f32_16x16x32_bf16 v[96:99], v[36:39], a[48:51], v[96:99]
    ds_read_b128 v[76:79], v8 offset:11264
    v_mfma_f32_16x16x32_bf16 v[100:103], v[40:43], a[48:51], v[100:103]
    ds_read_b128 v[80:83], v8 offset:12288
    s_add_u32 s49, s44, 3276800
    buffer_load_dwordx4 a[4:7], v5, s[32:35], s49 offen sc1
    v_mfma_f32_16x16x32_bf16 v[104:107], v[44:47], a[48:51], v[104:107]
    ds_read_b128 v[84:87], v8 offset:13312
    v_mfma_f32_16x16x32_bf16 v[108:111], v[48:51], a[48:51], v[108:111]
    ds_read_b128 v[88:91], v8 offset:14336
    s_waitcnt lgkmcnt(5)
    v_mfma_f32_16x16x32_bf16 v[92:95], v[52:55], a[52:55], v[92:95]
    ds_read_b128 v[32:35], v8 offset:15360
    s_add_u32 s49, s44, 3407872
    buffer_load_dwordx4 a[8:11], v5, s[32:35], s49 offen sc1
    v_mfma_f32_16x16x32_bf16 v[96:99], v[56:59], a[52:55], v[96:99]
    ds_read_b128 v[36:39], v8 offset:16384
    v_mfma_f32_16x16x32_bf16 v[100:103], v[60:63], a[52:55], v[100:103]
    ds_read_b128 v[40:43], v8 offset:17408
    s_add_u32 s49, s44, 3538944
    buffer_load_dwordx4 a[12:15], v5, s[32:35], s49 offen sc1
    v_mfma_f32_16x16x32_bf16 v[104:107], v[64:67], a[52:55], v[104:107]
    ds_read_b128 v[44:47], v8 offset:18432
    v_mfma_f32_16x16x32_bf16 v[108:111], v[68:71], a[52:55], v[108:111]
    ds_read_b128 v[48:51], v8 offset:19456
    s_barrier
    s_waitcnt lgkmcnt(5)
    v_mfma_f32_16x16x32_bf16 v[92:95], v[72:75], a[56:59], v[92:95]
    ds_read_b128 v[52:55], v8 offset:20480
    s_add_u32 m0, s79, 122880
    s_add_u32 s81, s78, 184320
    buffer_load_dwordx4 v249, s[72:75], s81 offen offset:0 sc1 lds
    v_mfma_f32_16x16x32_bf16 v[96:99], v[76:79], a[56:59], v[96:99]
    ds_read_b128 v[56:59], v8 offset:21504
    v_mfma_f32_16x16x32_bf16 v[100:103], v[80:83], a[56:59], v[100:103]
    ds_read_b128 v[60:63], v8 offset:22528
    buffer_load_dwordx4 v249, s[72:75], s81 offen offset:1024 sc1 lds
    v_mfma_f32_16x16x32_bf16 v[104:107], v[84:87], a[56:59], v[104:107]
    ds_read_b128 v[64:67], v8 offset:23552
    v_mfma_f32_16x16x32_bf16 v[108:111], v[88:91], a[56:59], v[108:111]
    ds_read_b128 v[68:71], v8 offset:24576
    buffer_load_dwordx4 v249, s[72:75], s81 offen offset:2048 sc1 lds
    s_waitcnt lgkmcnt(5)
    v_mfma_f32_16x16x32_bf16 v[92:95], v[32:35], a[60:63], v[92:95]
    ds_read_b128 v[72:75], v8 offset:25600
    buffer_load_dwordx4 v249, s[72:75], s81 offen offset:3072 sc1 lds
    v_mfma_f32_16x16x32_bf16 v[96:99], v[36:39], a[60:63], v[96:99]
    ds_read_b128 v[76:79], v8 offset:26624
    v_mfma_f32_16x16x32_bf16 v[100:103], v[40:43], a[60:63], v[100:103]
    ds_read_b128 v[80:83], v8 offset:27648
    s_add_u32 m0, s79, 126976
    s_add_u32 s81, s78, 188416
    buffer_load_dwordx4 v249, s[72:75], s81 offen offset:0 sc1 lds
    v_mfma_f32_16x16x32_bf16 v[104:107], v[44:47], a[60:63], v[104:107]
    ds_read_b128 v[84:87], v8 offset:28672
    v_mfma_f32_16x16x32_bf16 v[108:111], v[48:51], a[60:63], v[108:111]
    ds_read_b128 v[88:91], v8 offset:29696
    s_waitcnt vmcnt(23)
    s_waitcnt lgkmcnt(5)
    v_mfma_f32_16x16x32_bf16 v[92:95], v[52:55], a[64:67], v[92:95]
    ds_read_b128 v[32:35], v8 offset:30720
    s_add_u32 s49, s44, 3670016
    buffer_load_dwordx4 a[16:19], v5, s[32:35], s49 offen sc1
    v_mfma_f32_16x16x32_bf16 v[96:99], v[56:59], a[64:67], v[96:99]
    ds_read_b128 v[36:39], v8 offset:31744
    v_mfma_f32_16x16x32_bf16 v[100:103], v[60:63], a[64:67], v[100:103]
    ds_read_b128 v[40:43], v8 offset:32768
    s_add_u32 s49, s44, 3801088
    buffer_load_dwordx4 a[20:23], v5, s[32:35], s49 offen sc1
    v_mfma_f32_16x16x32_bf16 v[104:107], v[64:67], a[64:67], v[104:107]
    ds_read_b128 v[44:47], v8 offset:33792
    v_mfma_f32_16x16x32_bf16 v[108:111], v[68:71], a[64:67], v[108:111]
    ds_read_b128 v[48:51], v8 offset:34816
    s_waitcnt lgkmcnt(5)
    v_mfma_f32_16x16x32_bf16 v[92:95], v[72:75], a[68:71], v[92:95]
    ds_read_b128 v[52:55], v8 offset:35840
    s_add_u32 s49, s44, 3932160
    buffer_load_dwordx4 a[24:27], v5, s[32:35], s49 offen sc1
    v_mfma_f32_16x16x32_bf16 v[96:99], v[76:79], a[68:71], v[96:99]
    ds_read_b128 v[56:59], v8 offset:36864
    v_mfma_f32_16x16x32_bf16 v[100:103], v[80:83], a[68:71], v[100:103]
    ds_read_b128 v[60:63], v8 offset:37888
    s_add_u32 s49, s44, 4063232
    buffer_load_dwordx4 a[28:31], v5, s[32:35], s49 offen sc1
    v_mfma_f32_16x16x32_bf16 v[104:107], v[84:87], a[68:71], v[104:107]
    ds_read_b128 v[64:67], v8 offset:38912
    v_mfma_f32_16x16x32_bf16 v[108:111], v[88:91], a[68:71], v[108:111]
    ds_read_b128 v[68:71], v8 offset:39936
    s_barrier
    s_waitcnt lgkmcnt(5)
    v_mfma_f32_16x16x32_bf16 v[92:95], v[32:35], a[72:75], v[92:95]
    ds_read_b128 v[72:75], v8 offset:40960
    s_add_u32 m0, s79, 0
    s_add_u32 s81, s78, 204800
    buffer_load_dwordx4 v249, s[72:75], s81 offen offset:0 sc1 lds
    v_mfma_f32_16x16x32_bf16 v[96:99], v[36:39], a[72:75], v[96:99]
    ds_read_b128 v[76:79], v8 offset:41984
    v_mfma_f32_16x16x32_bf16 v[100:103], v[40:43], a[72:75], v[100:103]
    ds_read_b128 v[80:83], v8 offset:43008
    buffer_load_dwordx4 v249, s[72:75], s81 offen offset:1024 sc1 lds
    v_mfma_f32_16x16x32_bf16 v[104:107], v[44:47], a[72:75], v[104:107]
    ds_read_b128 v[84:87], v8 offset:44032
    v_mfma_f32_16x16x32_bf16 v[108:111], v[48:51], a[72:75], v[108:111]
    ds_read_b128 v[88:91], v8 offset:45056
    buffer_load_dwordx4 v249, s[72:75], s81 offen offset:2048 sc1 lds
    s_waitcnt lgkmcnt(5)
    v_mfma_f32_16x16x32_bf16 v[92:95], v[52:55], a[76:79], v[92:95]
    ds_read_b128 v[32:35], v8 offset:46080
    buffer_load_dwordx4 v249, s[72:75], s81 offen offset:3072 sc1 lds
    v_mfma_f32_16x16x32_bf16 v[96:99], v[56:59], a[76:79], v[96:99]
    ds_read_b128 v[36:39], v8 offset:47104
    v_mfma_f32_16x16x32_bf16 v[100:103], v[60:63], a[76:79], v[100:103]
    ds_read_b128 v[40:43], v8 offset:48128
    s_add_u32 m0, s79, 4096
    s_add_u32 s81, s78, 208896
    buffer_load_dwordx4 v249, s[72:75], s81 offen offset:0 sc1 lds
    v_mfma_f32_16x16x32_bf16 v[104:107], v[64:67], a[76:79], v[104:107]
    ds_read_b128 v[44:47], v8 offset:49152
    v_mfma_f32_16x16x32_bf16 v[108:111], v[68:71], a[76:79], v[108:111]
    ds_read_b128 v[48:51], v8 offset:50176
    s_waitcnt vmcnt(23)
    s_waitcnt lgkmcnt(5)
    v_mfma_f32_16x16x32_bf16 v[92:95], v[72:75], a[80:83], v[92:95]
    ds_read_b128 v[52:55], v8 offset:51200
    s_add_u32 s49, s44, 4194304
    buffer_load_dwordx4 a[32:35], v5, s[32:35], s49 offen sc1
    v_mfma_f32_16x16x32_bf16 v[96:99], v[76:79], a[80:83], v[96:99]
    ds_read_b128 v[56:59], v8 offset:52224
    v_mfma_f32_16x16x32_bf16 v[100:103], v[80:83], a[80:83], v[100:103]
    ds_read_b128 v[60:63], v8 offset:53248
    s_add_u32 s49, s44, 4325376
    buffer_load_dwordx4 a[36:39], v5, s[32:35], s49 offen sc1
    v_mfma_f32_16x16x32_bf16 v[104:107], v[84:87], a[80:83], v[104:107]
    ds_read_b128 v[64:67], v8 offset:54272
    v_mfma_f32_16x16x32_bf16 v[108:111], v[88:91], a[80:83], v[108:111]
    ds_read_b128 v[68:71], v8 offset:55296
    s_waitcnt lgkmcnt(5)
    v_mfma_f32_16x16x32_bf16 v[92:95], v[32:35], a[84:87], v[92:95]
    ds_read_b128 v[72:75], v8 offset:56320
    s_add_u32 s49, s44, 4456448
    buffer_load_dwordx4 a[40:43], v5, s[32:35], s49 offen sc1
    v_mfma_f32_16x16x32_bf16 v[96:99], v[36:39], a[84:87], v[96:99]
    ds_read_b128 v[76:79], v8 offset:57344
    v_mfma_f32_16x16x32_bf16 v[100:103], v[40:43], a[84:87], v[100:103]
    ds_read_b128 v[80:83], v8 offset:58368
    s_add_u32 s49, s44, 4587520
    buffer_load_dwordx4 a[44:47], v5, s[32:35], s49 offen sc1
    v_mfma_f32_16x16x32_bf16 v[104:107], v[44:47], a[84:87], v[104:107]
    ds_read_b128 v[84:87], v8 offset:59392
    v_mfma_f32_16x16x32_bf16 v[108:111], v[48:51], a[84:87], v[108:111]
    ds_read_b128 v[88:91], v8 offset:60416
    s_barrier
    s_waitcnt lgkmcnt(5)
    v_mfma_f32_16x16x32_bf16 v[92:95], v[52:55], a[88:91], v[92:95]
    ds_read_b128 v[32:35], v8 offset:61440
    s_add_u32 m0, s79, 20480
    s_add_u32 s81, s78, 225280
    buffer_load_dwordx4 v249, s[72:75], s81 offen offset:0 sc1 lds
    v_mfma_f32_16x16x32_bf16 v[96:99], v[56:59], a[88:91], v[96:99]
    ds_read_b128 v[36:39], v8 offset:62464
    v_mfma_f32_16x16x32_bf16 v[100:103], v[60:63], a[88:91], v[100:103]
    ds_read_b128 v[40:43], v8 offset:63488
    buffer_load_dwordx4 v249, s[72:75], s81 offen offset:1024 sc1 lds
    v_mfma_f32_16x16x32_bf16 v[104:107], v[64:67], a[88:91], v[104:107]
    ds_read_b128 v[44:47], v8 offset:64512
    v_mfma_f32_16x16x32_bf16 v[108:111], v[68:71], a[88:91], v[108:111]
    ds_read_b128 v[48:51], v9 offset:0
    buffer_load_dwordx4 v249, s[72:75], s81 offen offset:2048 sc1 lds
    s_waitcnt lgkmcnt(5)
    v_mfma_f32_16x16x32_bf16 v[92:95], v[72:75], a[92:95], v[92:95]
    ds_read_b128 v[52:55], v9 offset:1024
    buffer_load_dwordx4 v249, s[72:75], s81 offen offset:3072 sc1 lds
    v_mfma_f32_16x16x32_bf16 v[96:99], v[76:79], a[92:95], v[96:99]
    ds_read_b128 v[56:59], v9 offset:2048
    v_mfma_f32_16x16x32_bf16 v[100:103], v[80:83], a[92:95], v[100:103]
    ds_read_b128 v[60:63], v9 offset:3072
    s_add_u32 m0, s79, 24576
    s_add_u32 s81, s78, 229376
    buffer_load_dwordx4 v249, s[72:75], s81 offen offset:0 sc1 lds
    v_mfma_f32_16x16x32_bf16 v[104:107], v[84:87], a[92:95], v[104:107]
    ds_read_b128 v[64:67], v9 offset:4096
    v_mfma_f32_16x16x32_bf16 v[108:111], v[88:91], a[92:95], v[108:111]
    ds_read_b128 v[68:71], v9 offset:5120
    s_waitcnt vmcnt(23)
    s_waitcnt lgkmcnt(5)
    v_mfma_f32_16x16x32_bf16 v[92:95], v[32:35], a[0:3], v[92:95]
    ds_read_b128 v[72:75], v9 offset:6144
    s_add_u32 s49, s44, 4718592
    buffer_load_dwordx4 a[48:51], v5, s[32:35], s49 offen sc1
    v_mfma_f32_16x16x32_bf16 v[96:99], v[36:39], a[0:3], v[96:99]
    ds_read_b128 v[76:79], v9 offset:7168
    v_mfma_f32_16x16x32_bf16 v[100:103], v[40:43], a[0:3], v[100:103]
    ds_read_b128 v[80:83], v9 offset:8192
    s_add_u32 s49, s44, 4849664
    buffer_load_dwordx4 a[52:55], v5, s[32:35], s49 offen sc1
    v_mfma_f32_16x16x32_bf16 v[104:107], v[44:47], a[0:3], v[104:107]
    ds_read_b128 v[84:87], v9 offset:9216
    v_mfma_f32_16x16x32_bf16 v[108:111], v[48:51], a[0:3], v[108:111]
    ds_read_b128 v[88:91], v9 offset:10240
    s_waitcnt lgkmcnt(5)
    v_mfma_f32_16x16x32_bf16 v[92:95], v[52:55], a[4:7], v[92:95]
    ds_read_b128 v[32:35], v9 offset:11264
    s_add_u32 s49, s44, 4980736
    buffer_load_dwordx4 a[56:59], v5, s[32:35], s49 offen sc1
    v_mfma_f32_16x16x32_bf16 v[96:99], v[56:59], a[4:7], v[96:99]
    ds_read_b128 v[36:39], v9 offset:12288
    v_mfma_f32_16x16x32_bf16 v[100:103], v[60:63], a[4:7], v[100:103]
    ds_read_b128 v[40:43], v9 offset:13312
    s_add_u32 s49, s44, 5111808
    buffer_load_dwordx4 a[60:63], v5, s[32:35], s49 offen sc1
    v_mfma_f32_16x16x32_bf16 v[104:107], v[64:67], a[4:7], v[104:107]
    ds_read_b128 v[44:47], v9 offset:14336
    v_mfma_f32_16x16x32_bf16 v[108:111], v[68:71], a[4:7], v[108:111]
    ds_read_b128 v[48:51], v9 offset:15360
    s_waitcnt vmcnt(40)
    s_barrier
    s_waitcnt lgkmcnt(5)
    v_mfma_f32_16x16x32_bf16 v[92:95], v[72:75], a[8:11], v[92:95]
    ds_read_b128 v[52:55], v9 offset:16384
    s_add_u32 m0, s79, 40960
    s_add_u32 s81, s78, 245760
    buffer_load_dwordx4 v249, s[72:75], s81 offen offset:0 sc1 lds
    v_mfma_f32_16x16x32_bf16 v[96:99], v[76:79], a[8:11], v[96:99]
    ds_read_b128 v[56:59], v9 offset:17408
    v_mfma_f32_16x16x32_bf16 v[100:103], v[80:83], a[8:11], v[100:103]
    ds_read_b128 v[60:63], v9 offset:18432
    buffer_load_dwordx4 v249, s[72:75], s81 offen offset:1024 sc1 lds
    v_mfma_f32_16x16x32_bf16 v[104:107], v[84:87], a[8:11], v[104:107]
    ds_read_b128 v[64:67], v9 offset:19456
    v_mfma_f32_16x16x32_bf16 v[108:111], v[88:91], a[8:11], v[108:111]
    ds_read_b128 v[68:71], v9 offset:20480
    buffer_load_dwordx4 v249, s[72:75], s81 offen offset:2048 sc1 lds
    s_waitcnt lgkmcnt(5)
    v_mfma_f32_16x16x32_bf16 v[92:95], v[32:35], a[12:15], v[92:95]
    ds_read_b128 v[72:75], v9 offset:21504
    buffer_load_dwordx4 v249, s[72:75], s81 offen offset:3072 sc1 lds
    v_mfma_f32_16x16x32_bf16 v[96:99], v[36:39], a[12:15], v[96:99]
    ds_read_b128 v[76:79], v9 offset:22528
    v_mfma_f32_16x16x32_bf16 v[100:103], v[40:43], a[12:15], v[100:103]
    ds_read_b128 v[80:83], v9 offset:23552
    s_add_u32 m0, s79, 45056
    s_add_u32 s81, s78, 249856
    buffer_load_dwordx4 v249, s[72:75], s81 offen offset:0 sc1 lds
    v_mfma_f32_16x16x32_bf16 v[104:107], v[44:47], a[12:15], v[104:107]
    ds_read_b128 v[84:87], v9 offset:24576
    v_mfma_f32_16x16x32_bf16 v[108:111], v[48:51], a[12:15], v[108:111]
    ds_read_b128 v[88:91], v9 offset:25600
    s_waitcnt vmcnt(23)
    s_waitcnt lgkmcnt(5)
    v_mfma_f32_16x16x32_bf16 v[92:95], v[52:55], a[16:19], v[92:95]
    ds_read_b128 v[32:35], v9 offset:26624
    s_add_u32 s49, s44, 5242880
    buffer_load_dwordx4 a[64:67], v5, s[32:35], s49 offen sc1
    v_mfma_f32_16x16x32_bf16 v[96:99], v[56:59], a[16:19], v[96:99]
    ds_read_b128 v[36:39], v9 offset:27648
    v_mfma_f32_16x16x32_bf16 v[100:103], v[60:63], a[16:19], v[100:103]
    ds_read_b128 v[40:43], v9 offset:28672
    s_add_u32 s49, s44, 5373952
    buffer_load_dwordx4 a[68:71], v5, s[32:35], s49 offen sc1
    v_mfma_f32_16x16x32_bf16 v[104:107], v[64:67], a[16:19], v[104:107]
    ds_read_b128 v[44:47], v9 offset:29696
    v_mfma_f32_16x16x32_bf16 v[108:111], v[68:71], a[16:19], v[108:111]
    ds_read_b128 v[48:51], v9 offset:30720
    s_waitcnt lgkmcnt(5)
    v_mfma_f32_16x16x32_bf16 v[92:95], v[72:75], a[20:23], v[92:95]
    ds_read_b128 v[52:55], v9 offset:31744
    s_add_u32 s49, s44, 5505024
    buffer_load_dwordx4 a[72:75], v5, s[32:35], s49 offen sc1
    v_mfma_f32_16x16x32_bf16 v[96:99], v[76:79], a[20:23], v[96:99]
    ds_read_b128 v[56:59], v9 offset:32768
    v_mfma_f32_16x16x32_bf16 v[100:103], v[80:83], a[20:23], v[100:103]
    ds_read_b128 v[60:63], v9 offset:33792
    s_add_u32 s49, s44, 5636096
    buffer_load_dwordx4 a[76:79], v5, s[32:35], s49 offen sc1
    v_mfma_f32_16x16x32_bf16 v[104:107], v[84:87], a[20:23], v[104:107]
    ds_read_b128 v[64:67], v9 offset:34816
    v_mfma_f32_16x16x32_bf16 v[108:111], v[88:91], a[20:23], v[108:111]
    ds_read_b128 v[68:71], v9 offset:35840
    s_waitcnt vmcnt(40)
    s_barrier
    s_waitcnt lgkmcnt(5)
    v_mfma_f32_16x16x32_bf16 v[92:95], v[32:35], a[24:27], v[92:95]
    ds_read_b128 v[72:75], v9 offset:36864
    s_add_u32 m0, s79, 61440
    s_add_u32 s81, s78, 266240
    buffer_load_dwordx4 v249, s[72:75], s81 offen offset:0 sc1 lds
    v_mfma_f32_16x16x32_bf16 v[96:99], v[36:39], a[24:27], v[96:99]
    ds_read_b128 v[76:79], v9 offset:37888
    v_mfma_f32_16x16x32_bf16 v[100:103], v[40:43], a[24:27], v[100:103]
    ds_read_b128 v[80:83], v9 offset:38912
    buffer_load_dwordx4 v249, s[72:75], s81 offen offset:1024 sc1 lds
    v_mfma_f32_16x16x32_bf16 v[104:107], v[44:47], a[24:27], v[104:107]
    ds_read_b128 v[84:87], v9 offset:39936
    v_mfma_f32_16x16x32_bf16 v[108:111], v[48:51], a[24:27], v[108:111]
    ds_read_b128 v[88:91], v9 offset:40960
    buffer_load_dwordx4 v249, s[72:75], s81 offen offset:2048 sc1 lds
    s_waitcnt lgkmcnt(5)
    v_mfma_f32_16x16x32_bf16 v[92:95], v[52:55], a[28:31], v[92:95]
    ds_read_b128 v[32:35], v9 offset:41984
    buffer_load_dwordx4 v249, s[72:75], s81 offen offset:3072 sc1 lds
    v_mfma_f32_16x16x32_bf16 v[96:99], v[56:59], a[28:31], v[96:99]
    ds_read_b128 v[36:39], v9 offset:43008
    v_mfma_f32_16x16x32_bf16 v[100:103], v[60:63], a[28:31], v[100:103]
    ds_read_b128 v[40:43], v9 offset:44032
    s_add_u32 m0, s79, 65536
    s_add_u32 s81, s78, 270336
    buffer_load_dwordx4 v249, s[72:75], s81 offen offset:0 sc1 lds
    v_mfma_f32_16x16x32_bf16 v[104:107], v[64:67], a[28:31], v[104:107]
    ds_read_b128 v[44:47], v9 offset:45056
    v_mfma_f32_16x16x32_bf16 v[108:111], v[68:71], a[28:31], v[108:111]
    ds_read_b128 v[48:51], v9 offset:46080
    s_waitcnt vmcnt(23)
    s_waitcnt lgkmcnt(5)
    v_mfma_f32_16x16x32_bf16 v[92:95], v[72:75], a[32:35], v[92:95]
    ds_read_b128 v[52:55], v9 offset:47104
    s_add_u32 s49, s44, 5767168
    buffer_load_dwordx4 a[80:83], v5, s[32:35], s49 offen sc1
    v_mfma_f32_16x16x32_bf16 v[96:99], v[76:79], a[32:35], v[96:99]
    ds_read_b128 v[56:59], v9 offset:48128
    v_mfma_f32_16x16x32_bf16 v[100:103], v[80:83], a[32:35], v[100:103]
    ds_read_b128 v[60:63], v9 offset:49152
    s_add_u32 s49, s44, 5898240
    buffer_load_dwordx4 a[84:87], v5, s[32:35], s49 offen sc1
    v_mfma_f32_16x16x32_bf16 v[104:107], v[84:87], a[32:35], v[104:107]
    ds_read_b128 v[64:67], v9 offset:50176
    v_mfma_f32_16x16x32_bf16 v[108:111], v[88:91], a[32:35], v[108:111]
    ds_read_b128 v[68:71], v9 offset:51200
    s_waitcnt lgkmcnt(5)
    v_mfma_f32_16x16x32_bf16 v[92:95], v[32:35], a[36:39], v[92:95]
    ds_read_b128 v[72:75], v9 offset:52224
    s_add_u32 s49, s44, 6029312
    buffer_load_dwordx4 a[88:91], v5, s[32:35], s49 offen sc1
    v_mfma_f32_16x16x32_bf16 v[96:99], v[36:39], a[36:39], v[96:99]
    ds_read_b128 v[76:79], v9 offset:53248
    v_mfma_f32_16x16x32_bf16 v[100:103], v[40:43], a[36:39], v[100:103]
    ds_read_b128 v[80:83], v9 offset:54272
    s_add_u32 s49, s44, 6160384
    buffer_load_dwordx4 a[92:95], v5, s[32:35], s49 offen sc1
    v_mfma_f32_16x16x32_bf16 v[104:107], v[44:47], a[36:39], v[104:107]
    ds_read_b128 v[84:87], v9 offset:55296
    v_mfma_f32_16x16x32_bf16 v[108:111], v[48:51], a[36:39], v[108:111]
    ds_read_b128 v[88:91], v9 offset:56320
    s_waitcnt vmcnt(40)
    s_barrier
    s_waitcnt lgkmcnt(5)
    v_mfma_f32_16x16x32_bf16 v[92:95], v[52:55], a[40:43], v[92:95]
    ds_read_b128 v[32:35], v9 offset:57344
    v_mfma_f32_16x16x32_bf16 v[96:99], v[56:59], a[40:43], v[96:99]
    ds_read_b128 v[36:39], v9 offset:58368
    v_mfma_f32_16x16x32_bf16 v[100:103], v[60:63], a[40:43], v[100:103]
    ds_read_b128 v[40:43], v9 offset:59392
    v_mfma_f32_16x16x32_bf16 v[104:107], v[64:67], a[40:43], v[104:107]
    ds_read_b128 v[44:47], v9 offset:60416
    v_mfma_f32_16x16x32_bf16 v[108:111], v[68:71], a[40:43], v[108:111]
    ds_read_b128 v[48:51], v9 offset:61440
    s_waitcnt lgkmcnt(5)
    v_mfma_f32_16x16x32_bf16 v[92:95], v[72:75], a[44:47], v[92:95]
    ds_read_b128 v[52:55], v9 offset:62464
    v_mfma_f32_16x16x32_bf16 v[96:99], v[76:79], a[44:47], v[96:99]
    ds_read_b128 v[56:59], v9 offset:63488
    v_mfma_f32_16x16x32_bf16 v[100:103], v[80:83], a[44:47], v[100:103]
    ds_read_b128 v[60:63], v9 offset:64512
    v_mfma_f32_16x16x32_bf16 v[104:107], v[84:87], a[44:47], v[104:107]
    ds_read_b128 v[64:67], v10 offset:0
    v_mfma_f32_16x16x32_bf16 v[108:111], v[88:91], a[44:47], v[108:111]
    ds_read_b128 v[68:71], v10 offset:1024
    s_waitcnt vmcnt(18)
    s_waitcnt lgkmcnt(5)
    v_mfma_f32_16x16x32_bf16 v[92:95], v[32:35], a[48:51], v[92:95]
    ds_read_b128 v[72:75], v10 offset:2048
    s_add_u32 s49, s44, 6291456
    buffer_load_dwordx4 a[0:3], v5, s[32:35], s49 offen sc1
    v_mfma_f32_16x16x32_bf16 v[96:99], v[36:39], a[48:51], v[96:99]
    ds_read_b128 v[76:79], v10 offset:3072
    v_mfma_f32_16x16x32_bf16 v[100:103], v[40:43], a[48:51], v[100:103]
    ds_read_b128 v[80:83], v10 offset:4096
    s_add_u32 s49, s44, 6422528
    buffer_load_dwordx4 a[4:7], v5, s[32:35], s49 offen sc1
    v_mfma_f32_16x16x32_bf16 v[104:107], v[44:47], a[48:51], v[104:107]
    ds_read_b128 v[84:87], v10 offset:5120
    v_mfma_f32_16x16x32_bf16 v[108:111], v[48:51], a[48:51], v[108:111]
    ds_read_b128 v[88:91], v10 offset:6144
    s_waitcnt lgkmcnt(5)
    v_mfma_f32_16x16x32_bf16 v[92:95], v[52:55], a[52:55], v[92:95]
    ds_read_b128 v[32:35], v10 offset:7168
    s_add_u32 s49, s44, 6553600
    buffer_load_dwordx4 a[8:11], v5, s[32:35], s49 offen sc1
    v_mfma_f32_16x16x32_bf16 v[96:99], v[56:59], a[52:55], v[96:99]
    ds_read_b128 v[36:39], v10 offset:8192
    v_mfma_f32_16x16x32_bf16 v[100:103], v[60:63], a[52:55], v[100:103]
    ds_read_b128 v[40:43], v10 offset:9216
    s_add_u32 s49, s44, 6684672
    buffer_load_dwordx4 a[12:15], v5, s[32:35], s49 offen sc1
    v_mfma_f32_16x16x32_bf16 v[104:107], v[64:67], a[52:55], v[104:107]
    ds_read_b128 v[44:47], v10 offset:10240
    v_mfma_f32_16x16x32_bf16 v[108:111], v[68:71], a[52:55], v[108:111]
    ds_read_b128 v[48:51], v10 offset:11264
    s_waitcnt vmcnt(35)
    s_barrier
    s_waitcnt lgkmcnt(5)
    v_mfma_f32_16x16x32_bf16 v[92:95], v[72:75], a[56:59], v[92:95]
    ds_read_b128 v[52:55], v8 offset:0
    v_mfma_f32_16x16x32_bf16 v[96:99], v[76:79], a[56:59], v[96:99]
    ds_read_b128 v[56:59], v8 offset:1024
    v_mfma_f32_16x16x32_bf16 v[100:103], v[80:83], a[56:59], v[100:103]
    ds_read_b128 v[60:63], v8 offset:2048
    v_mfma_f32_16x16x32_bf16 v[104:107], v[84:87], a[56:59], v[104:107]
    ds_read_b128 v[64:67], v8 offset:3072
    v_mfma_f32_16x16x32_bf16 v[108:111], v[88:91], a[56:59], v[108:111]
    ds_read_b128 v[68:71], v8 offset:4096
    s_waitcnt lgkmcnt(5)
    v_mfma_f32_16x16x32_bf16 v[92:95], v[32:35], a[60:63], v[92:95]
    ds_read_b128 v[72:75], v8 offset:5120
    v_mfma_f32_16x16x32_bf16 v[96:99], v[36:39], a[60:63], v[96:99]
    ds_read_b128 v[76:79], v8 offset:6144
    v_mfma_f32_16x16x32_bf16 v[100:103], v[40:43], a[60:63], v[100:103]
    ds_read_b128 v[80:83], v8 offset:7168
    v_mfma_f32_16x16x32_bf16 v[104:107], v[44:47], a[60:63], v[104:107]
    ds_read_b128 v[84:87], v8 offset:8192
    v_mfma_f32_16x16x32_bf16 v[108:111], v[48:51], a[60:63], v[108:111]
    ds_read_b128 v[88:91], v8 offset:9216
    s_waitcnt vmcnt(13)
    s_waitcnt lgkmcnt(5)
    v_mfma_f32_16x16x32_bf16 v[92:95], v[52:55], a[64:67], v[92:95]
    ds_read_b128 v[32:35], v8 offset:10240
    s_add_u32 s49, s44, 6815744
    buffer_load_dwordx4 a[16:19], v5, s[32:35], s49 offen sc1
    v_mfma_f32_16x16x32_bf16 v[96:99], v[56:59], a[64:67], v[96:99]
    ds_read_b128 v[36:39], v8 offset:11264
    v_mfma_f32_16x16x32_bf16 v[100:103], v[60:63], a[64:67], v[100:103]
    ds_read_b128 v[40:43], v8 offset:12288
    s_add_u32 s49, s44, 6946816
    buffer_load_dwordx4 a[20:23], v5, s[32:35], s49 offen sc1
    v_mfma_f32_16x16x32_bf16 v[104:107], v[64:67], a[64:67], v[104:107]
    ds_read_b128 v[44:47], v8 offset:13312
    v_mfma_f32_16x16x32_bf16 v[108:111], v[68:71], a[64:67], v[108:111]
    ds_read_b128 v[48:51], v8 offset:14336
    s_waitcnt lgkmcnt(5)
    v_mfma_f32_16x16x32_bf16 v[92:95], v[72:75], a[68:71], v[92:95]
    ds_read_b128 v[52:55], v8 offset:15360
    v_mfma_f32_16x16x32_bf16 v[96:99], v[76:79], a[68:71], v[96:99]
    ds_read_b128 v[56:59], v8 offset:16384
    v_mfma_f32_16x16x32_bf16 v[100:103], v[80:83], a[68:71], v[100:103]
    ds_read_b128 v[60:63], v8 offset:17408
    v_mfma_f32_16x16x32_bf16 v[104:107], v[84:87], a[68:71], v[104:107]
    ds_read_b128 v[64:67], v8 offset:18432
    v_mfma_f32_16x16x32_bf16 v[108:111], v[88:91], a[68:71], v[108:111]
    ds_read_b128 v[68:71], v8 offset:19456
    s_waitcnt vmcnt(28)
    s_barrier
    s_waitcnt lgkmcnt(5)
    v_mfma_f32_16x16x32_bf16 v[92:95], v[32:35], a[72:75], v[92:95]
    ds_read_b128 v[72:75], v8 offset:20480
    v_mfma_f32_16x16x32_bf16 v[96:99], v[36:39], a[72:75], v[96:99]
    ds_read_b128 v[76:79], v8 offset:21504
    v_mfma_f32_16x16x32_bf16 v[100:103], v[40:43], a[72:75], v[100:103]
    ds_read_b128 v[80:83], v8 offset:22528
    v_mfma_f32_16x16x32_bf16 v[104:107], v[44:47], a[72:75], v[104:107]
    ds_read_b128 v[84:87], v8 offset:23552
    v_mfma_f32_16x16x32_bf16 v[108:111], v[48:51], a[72:75], v[108:111]
    ds_read_b128 v[88:91], v8 offset:24576
    s_waitcnt lgkmcnt(5)
    v_mfma_f32_16x16x32_bf16 v[92:95], v[52:55], a[76:79], v[92:95]
    ds_read_b128 v[32:35], v8 offset:25600
    v_mfma_f32_16x16x32_bf16 v[96:99], v[56:59], a[76:79], v[96:99]
    ds_read_b128 v[36:39], v8 offset:26624
    v_mfma_f32_16x16x32_bf16 v[100:103], v[60:63], a[76:79], v[100:103]
    ds_read_b128 v[40:43], v8 offset:27648
    v_mfma_f32_16x16x32_bf16 v[104:107], v[64:67], a[76:79], v[104:107]
    ds_read_b128 v[44:47], v8 offset:28672
    v_mfma_f32_16x16x32_bf16 v[108:111], v[68:71], a[76:79], v[108:111]
    ds_read_b128 v[48:51], v8 offset:29696
    s_waitcnt vmcnt(6)
    s_waitcnt lgkmcnt(5)
    v_mfma_f32_16x16x32_bf16 v[92:95], v[72:75], a[80:83], v[92:95]
    ds_read_b128 v[52:55], v8 offset:30720
    v_mfma_f32_16x16x32_bf16 v[96:99], v[76:79], a[80:83], v[96:99]
    ds_read_b128 v[56:59], v8 offset:31744
    v_mfma_f32_16x16x32_bf16 v[100:103], v[80:83], a[80:83], v[100:103]
    ds_read_b128 v[60:63], v8 offset:32768
    v_mfma_f32_16x16x32_bf16 v[104:107], v[84:87], a[80:83], v[104:107]
    ds_read_b128 v[64:67], v8 offset:33792
    v_mfma_f32_16x16x32_bf16 v[108:111], v[88:91], a[80:83], v[108:111]
    ds_read_b128 v[68:71], v8 offset:34816
    s_waitcnt lgkmcnt(5)
    v_mfma_f32_16x16x32_bf16 v[92:95], v[32:35], a[84:87], v[92:95]
    ds_read_b128 v[72:75], v8 offset:35840
    v_mfma_f32_16x16x32_bf16 v[96:99], v[36:39], a[84:87], v[96:99]
    ds_read_b128 v[76:79], v8 offset:36864
    v_mfma_f32_16x16x32_bf16 v[100:103], v[40:43], a[84:87], v[100:103]
    ds_read_b128 v[80:83], v8 offset:37888
    v_mfma_f32_16x16x32_bf16 v[104:107], v[44:47], a[84:87], v[104:107]
    ds_read_b128 v[84:87], v8 offset:38912
    v_mfma_f32_16x16x32_bf16 v[108:111], v[48:51], a[84:87], v[108:111]
    ds_read_b128 v[88:91], v8 offset:39936
    s_waitcnt vmcnt(19)
    s_barrier
    s_waitcnt lgkmcnt(5)
    v_mfma_f32_16x16x32_bf16 v[92:95], v[52:55], a[88:91], v[92:95]
    ds_read_b128 v[32:35], v8 offset:40960
    v_mfma_f32_16x16x32_bf16 v[96:99], v[56:59], a[88:91], v[96:99]
    ds_read_b128 v[36:39], v8 offset:41984
    v_mfma_f32_16x16x32_bf16 v[100:103], v[60:63], a[88:91], v[100:103]
    ds_read_b128 v[40:43], v8 offset:43008
    v_mfma_f32_16x16x32_bf16 v[104:107], v[64:67], a[88:91], v[104:107]
    ds_read_b128 v[44:47], v8 offset:44032
    v_mfma_f32_16x16x32_bf16 v[108:111], v[68:71], a[88:91], v[108:111]
    ds_read_b128 v[48:51], v8 offset:45056
    s_waitcnt lgkmcnt(5)
    v_mfma_f32_16x16x32_bf16 v[92:95], v[72:75], a[92:95], v[92:95]
    ds_read_b128 v[52:55], v8 offset:46080
    v_mfma_f32_16x16x32_bf16 v[96:99], v[76:79], a[92:95], v[96:99]
    ds_read_b128 v[56:59], v8 offset:47104
    v_mfma_f32_16x16x32_bf16 v[100:103], v[80:83], a[92:95], v[100:103]
    ds_read_b128 v[60:63], v8 offset:48128
    v_mfma_f32_16x16x32_bf16 v[104:107], v[84:87], a[92:95], v[104:107]
    ds_read_b128 v[64:67], v8 offset:49152
    v_mfma_f32_16x16x32_bf16 v[108:111], v[88:91], a[92:95], v[108:111]
    ds_read_b128 v[68:71], v8 offset:50176
    s_waitcnt vmcnt(2)
    s_waitcnt lgkmcnt(5)
    v_mfma_f32_16x16x32_bf16 v[92:95], v[32:35], a[0:3], v[92:95]
    ds_read_b128 v[72:75], v8 offset:51200
    v_mfma_f32_16x16x32_bf16 v[96:99], v[36:39], a[0:3], v[96:99]
    ds_read_b128 v[76:79], v8 offset:52224
    v_mfma_f32_16x16x32_bf16 v[100:103], v[40:43], a[0:3], v[100:103]
    ds_read_b128 v[80:83], v8 offset:53248
    v_mfma_f32_16x16x32_bf16 v[104:107], v[44:47], a[0:3], v[104:107]
    ds_read_b128 v[84:87], v8 offset:54272
    v_mfma_f32_16x16x32_bf16 v[108:111], v[48:51], a[0:3], v[108:111]
    ds_read_b128 v[88:91], v8 offset:55296
    s_waitcnt lgkmcnt(5)
    v_mfma_f32_16x16x32_bf16 v[92:95], v[52:55], a[4:7], v[92:95]
    ds_read_b128 v[32:35], v8 offset:56320
    v_mfma_f32_16x16x32_bf16 v[96:99], v[56:59], a[4:7], v[96:99]
    ds_read_b128 v[36:39], v8 offset:57344
    v_mfma_f32_16x16x32_bf16 v[100:103], v[60:63], a[4:7], v[100:103]
    ds_read_b128 v[40:43], v8 offset:58368
    v_mfma_f32_16x16x32_bf16 v[104:107], v[64:67], a[4:7], v[104:107]
    ds_read_b128 v[44:47], v8 offset:59392
    v_mfma_f32_16x16x32_bf16 v[108:111], v[68:71], a[4:7], v[108:111]
    ds_read_b128 v[48:51], v8 offset:60416
    s_waitcnt vmcnt(10)
    s_barrier
    s_waitcnt lgkmcnt(5)
    v_mfma_f32_16x16x32_bf16 v[92:95], v[72:75], a[8:11], v[92:95]
    ds_read_b128 v[52:55], v8 offset:61440
    v_mfma_f32_16x16x32_bf16 v[96:99], v[76:79], a[8:11], v[96:99]
    ds_read_b128 v[56:59], v8 offset:62464
    v_mfma_f32_16x16x32_bf16 v[100:103], v[80:83], a[8:11], v[100:103]
    ds_read_b128 v[60:63], v8 offset:63488
    v_mfma_f32_16x16x32_bf16 v[104:107], v[84:87], a[8:11], v[104:107]
    ds_read_b128 v[64:67], v8 offset:64512
    v_mfma_f32_16x16x32_bf16 v[108:111], v[88:91], a[8:11], v[108:111]
    ds_read_b128 v[68:71], v9 offset:0
    s_waitcnt lgkmcnt(5)
    v_mfma_f32_16x16x32_bf16 v[92:95], v[32:35], a[12:15], v[92:95]
    ds_read_b128 v[72:75], v9 offset:1024
    v_mfma_f32_16x16x32_bf16 v[96:99], v[36:39], a[12:15], v[96:99]
    ds_read_b128 v[76:79], v9 offset:2048
    v_mfma_f32_16x16x32_bf16 v[100:103], v[40:43], a[12:15], v[100:103]
    ds_read_b128 v[80:83], v9 offset:3072
    v_mfma_f32_16x16x32_bf16 v[104:107], v[44:47], a[12:15], v[104:107]
    ds_read_b128 v[84:87], v9 offset:4096
    v_mfma_f32_16x16x32_bf16 v[108:111], v[48:51], a[12:15], v[108:111]
    ds_read_b128 v[88:91], v9 offset:5120
    s_waitcnt vmcnt(0)
    s_waitcnt lgkmcnt(5)
    v_mfma_f32_16x16x32_bf16 v[92:95], v[52:55], a[16:19], v[92:95]
    v_mfma_f32_16x16x32_bf16 v[96:99], v[56:59], a[16:19], v[96:99]
    v_mfma_f32_16x16x32_bf16 v[100:103], v[60:63], a[16:19], v[100:103]
    v_mfma_f32_16x16x32_bf16 v[104:107], v[64:67], a[16:19], v[104:107]
    v_mfma_f32_16x16x32_bf16 v[108:111], v[68:71], a[16:19], v[108:111]
    s_waitcnt lgkmcnt(0)
    v_mfma_f32_16x16x32_bf16 v[92:95], v[72:75], a[20:23], v[92:95]
    v_mfma_f32_16x16x32_bf16 v[96:99], v[76:79], a[20:23], v[96:99]
    v_mfma_f32_16x16x32_bf16 v[100:103], v[80:83], a[20:23], v[100:103]
    v_mfma_f32_16x16x32_bf16 v[104:107], v[84:87], a[20:23], v[104:107]
    v_mfma_f32_16x16x32_bf16 v[108:111], v[88:91], a[20:23], v[108:111]
    s_nop 7
    v_pk_add_f32 v[112:113], v[112:113], v[92:93]
    v_pk_add_f32 v[114:115], v[114:115], v[94:95]
    v_pk_add_f32 v[116:117], v[116:117], v[96:97]
    v_pk_add_f32 v[118:119], v[118:119], v[98:99]
    v_pk_add_f32 v[120:121], v[120:121], v[100:101]
    v_pk_add_f32 v[122:123], v[122:123], v[102:103]
    v_pk_add_f32 v[124:125], v[124:125], v[104:105]
    v_pk_add_f32 v[126:127], v[126:127], v[106:107]
    v_pk_add_f32 v[128:129], v[128:129], v[108:109]
    v_pk_add_f32 v[130:131], v[130:131], v[110:111]
    v_cvt_pk_bf16_f32 v136, v112, v113
    v_cvt_pk_bf16_f32 v137, v114, v115
    v_cvt_pk_bf16_f32 v138, v116, v117
    v_cvt_pk_bf16_f32 v139, v118, v119
    v_cvt_pk_bf16_f32 v140, v120, v121
    v_cvt_pk_bf16_f32 v141, v122, v123
    v_cvt_pk_bf16_f32 v142, v124, v125
    v_cvt_pk_bf16_f32 v143, v126, v127
    v_cvt_pk_bf16_f32 v144, v128, v129
    v_cvt_pk_bf16_f32 v145, v130, v131
    s_cmp_lg_u32 s14, 0
    s_cbranch_scc1 interleave_layers__mha_block__dense_activation_silu__prompt_kernel_dn_last
    buffer_store_dwordx4 v[136:139], v6, s[28:31], 0 offen sc1
    buffer_store_dwordx4 v[140:143], v6, s[28:31], s23 offen sc1
    buffer_store_dwordx2 v[144:145], v7, s[28:31], 0 offen sc1
    v_pk_add_f32 v[148:149], v[112:113], v[114:115]
    v_pk_mul_f32 v[150:151], v[112:113], v[112:113]
    v_pk_fma_f32 v[150:151], v[114:115], v[114:115], v[150:151]
    v_pk_add_f32 v[148:149], v[148:149], v[116:117]
    v_pk_fma_f32 v[150:151], v[116:117], v[116:117], v[150:151]
    v_pk_add_f32 v[148:149], v[148:149], v[118:119]
    v_pk_fma_f32 v[150:151], v[118:119], v[118:119], v[150:151]
    v_pk_add_f32 v[148:149], v[148:149], v[120:121]
    v_pk_fma_f32 v[150:151], v[120:121], v[120:121], v[150:151]
    v_pk_add_f32 v[148:149], v[148:149], v[122:123]
    v_pk_fma_f32 v[150:151], v[122:123], v[122:123], v[150:151]
    v_pk_add_f32 v[148:149], v[148:149], v[124:125]
    v_pk_fma_f32 v[150:151], v[124:125], v[124:125], v[150:151]
    v_pk_add_f32 v[148:149], v[148:149], v[126:127]
    v_pk_fma_f32 v[150:151], v[126:127], v[126:127], v[150:151]
    v_pk_add_f32 v[148:149], v[148:149], v[128:129]
    v_pk_fma_f32 v[150:151], v[128:129], v[128:129], v[150:151]
    v_pk_add_f32 v[148:149], v[148:149], v[130:131]
    v_pk_fma_f32 v[150:151], v[130:131], v[130:131], v[150:151]
    v_add_f32 v152, v148, v149
    v_add_f32 v153, v150, v151
    v_mov_b32 v154, v152
    v_mov_b32 v155, v153
    s_nop 1
    v_permlane32_swap_b32 v152, v154
    v_permlane32_swap_b32 v153, v155
    v_add_f32 v152, v152, v154
    v_add_f32 v153, v153, v155
    v_mov_b32 v154, v152
    v_mov_b32 v155, v153
    s_nop 1
    v_permlane16_swap_b32 v152, v154
    v_permlane16_swap_b32 v153, v155
    v_add_f32 v152, v152, v154
    v_add_f32 v153, v153, v155
    s_lshl_b32 s49, s18, 14
    buffer_store_dwordx2 v[152:153], v156, s[40:43], s49 offen sc1
    s_branch interleave_layers__mha_block__dense_activation_silu__prompt_kernel_dn_done
interleave_layers__mha_block__dense_activation_silu__prompt_kernel_dn_last:
    s_mul_i32 s49, s18, 160
    buffer_store_dwordx4 v[136:139], v157, s[28:31], s49 offen
    buffer_store_dwordx4 v[140:143], v157, s[28:31], s49 offen offset:64
    buffer_store_dwordx2 v[144:145], v158, s[28:31], s49 offen offset:128
    s_endpgm
interleave_layers__mha_block__dense_activation_silu__prompt_kernel_dn_done:
    s_waitcnt vmcnt(0) lgkmcnt(0)
    s_barrier
    s_cmp_lg_u32 s16, 0
    s_cbranch_scc1 arr_done_18
    s_add_u32 s100, s19, 56
    s_lshl_b32 s100, s100, 7
    s_add_u32 s100, s100, s97
    v_mov_b32 v250, s100
    v_mov_b32 v251, 1
    s_mov_b64 exec, 1
    global_atomic_add v250, v251, s[98:99] sc1
    s_mov_b64 exec, -1
arr_done_18:
    s_mov_b32 s14, 1
    s_mov_b32 s15, 0
    s_mov_b32 s97, 14336
    s_mov_b32 s96, 7864320
    s_branch interleave_layers__mha_block__dense_activation_silu__prompt_kernel_layer
interleave_layers__mha_block__dense_activation_silu__prompt_kernel_end:
    s_endpgm
.section .rodata,"a"
.p2align 6
.amdhsa_kernel interleave_layers__mha_block__dense_activation_silu__prompt_kernel
  .amdhsa_next_free_vgpr 512
  .amdhsa_next_free_sgpr 102
  .amdhsa_accum_offset 256
  .amdhsa_group_segment_fixed_size 0
  .amdhsa_kernarg_size 72
  .amdhsa_user_sgpr_count 2
  .amdhsa_user_sgpr_kernarg_segment_ptr 1
  .amdhsa_system_sgpr_workgroup_id_x 1
  .amdhsa_float_denorm_mode_32 3
.end_amdhsa_kernel
```
